```python
import torch

def _softmax(x, axis=-1):
    return torch.softmax(x, dim=axis)
def _gelu(x):
    return torch.nn.functional.gelu(x, approximate="tanh")
def _silu(x):
    return torch.nn.functional.silu(x)
def _sigmoid(x):
    return torch.sigmoid(x)
def _layernorm(x, axis=-1, eps=1e-5):
    m = x.mean(dim=axis, keepdim=True)
    v = x.var(dim=axis, keepdim=True, unbiased=False)
    return (x - m) / torch.sqrt(v + eps)
def _scatter_add(tgt, idx, src, axis=0):
    return tgt.clone().index_add_(axis, idx, src)
def _segment_sum(src, seg, n):
    out = torch.zeros((n,) + src.shape[1:], dtype=src.dtype)
    return out.index_add_(0, seg, src)
def _pad(x, pw):
    flat = tuple(v for pair in reversed(pw) for v in pair)
    return torch.nn.functional.pad(x, flat)

kernel_name = 'recurrent_scan__sliding_block_cached__moe_arch_mod__prompt'

def setup_inputs():

    _w = (lambda a: (lambda t: t.to(torch.bfloat16) if t.is_floating_point() else t)(torch.as_tensor(a)))
    def _A_setup():
        B, Sq, D = 1, 2048, 512
        Hq, Hkv, Sk, Dh = 32, 32, 2048, 128
        assert Hq % Hkv == 0, (Hq, Hkv)
        return {
            "x": _w((lambda *s: torch.randn(*s, dtype=torch.bfloat16) * 0.05)(B, Sq, D)),
            "k_cache": _w((lambda *s: torch.randn(*s, dtype=torch.bfloat16) * 0.8)(B, Hkv, Sk, Dh)),
            "v_cache": _w((lambda *s: torch.randn(*s, dtype=torch.bfloat16) * 0.2)(B, Hkv, Sk, Dh)),
            "wq": _w((lambda *s: torch.randn(*s, dtype=torch.bfloat16) * 0.8)(D, Hq * Dh) * (D ** -0.5)),
            "wo": _w((lambda *s: torch.randn(*s, dtype=torch.bfloat16) * 0.2)(Hq * Dh, D) * ((Hq * Dh) ** -0.5)),
        }
    _A_in = _A_setup()

    def _B_setup():
        B, S, D, F, C = 1, 2048, 512, 1376, 1
        return {
            "x": _w((lambda *s: torch.randn(*s, dtype=torch.bfloat16) * 0.05)(B, S, D)),
            "w_r": _w((lambda *s: torch.randn(*s, dtype=torch.bfloat16) * 0.2)(D)),
            "w_gate": _w((lambda *s: torch.randn(*s, dtype=torch.bfloat16) * 0.1)(D, F)),
            "w_up": _w((lambda *s: torch.randn(*s, dtype=torch.bfloat16) * 0.1)(D, F)),
            "w_down": _w((lambda *s: torch.randn(*s, dtype=torch.bfloat16) * 0.1)(F, D)),
        }
    _B_in = _B_setup()

    return {
        "A_x": _A_in["x"],
        "A_k_cache": _A_in["k_cache"],
        "A_v_cache": _A_in["v_cache"],
        "A_wq": _A_in["wq"],
        "A_wo": _A_in["wo"],
        "B_x": _B_in["x"],
        "B_w_r": _B_in["w_r"],
        "B_w_gate": _B_in["w_gate"],
        "B_w_up": _B_in["w_up"],
        "B_w_down": _B_in["w_down"],
    }

def reference(A_x, A_k_cache, A_v_cache, A_wq, A_wo, B_x, B_w_r, B_w_gate, B_w_up, B_w_down):
    def _A_ref(x, k_cache, v_cache, wq, wo):
        B, Sq, D = x.shape
        Hq, Dh = 32, 128
        Hkv, Sk = k_cache.shape[1], k_cache.shape[2]
        W = min(4096, max(256, Sk // 4))
        rep = Hq // Hkv
        q = (lambda x, *d: x.permute(*d))((x @ wq).reshape(B, Sq, Hq, Dh), 0, 2, 1, 3)
        k = (lambda x, n, axis: torch.repeat_interleave(x, n, dim=axis))(k_cache[:, :, Sk - W:, :], rep, axis=1)
        v = (lambda x, n, axis: torch.repeat_interleave(x, n, dim=axis))(v_cache[:, :, Sk - W:, :], rep, axis=1)
        scores = torch.einsum("bhqd,bhkd->bhqk", q, k) * (Dh ** -0.5)
        p = _softmax(scores, axis=-1)
        o = torch.einsum("bhqk,bhkd->bhqd", p, v)
        return (lambda x, *d: x.permute(*d))(o, 0, 2, 1, 3).reshape(B, Sq, Hq * Dh) @ wo

    def _B_ref(x, w_r, w_gate, w_up, w_down):
        B, S, D = x.shape
        C = 1
        r = x @ w_r
        idx = torch.argsort(-r, axis=-1)[:, :C]
        idx_e = (lambda x, n, axis: torch.repeat_interleave(x, n, dim=axis))(idx.reshape(B, C, 1), D, axis=2)
        x_sel = (lambda x, i, axis: torch.take_along_dim(x, i, dim=axis))(x, idx_e, axis=1)
        g = _silu(x_sel @ w_gate)
        u = x_sel @ w_up
        y = (g * u) @ w_down
        r_sel = _sigmoid((lambda x, i, axis: torch.take_along_dim(x, i, dim=axis))(r, idx, axis=1))
        y = y * r_sel.reshape(B, C, 1)
        b_off = (torch.arange(B) * S).reshape(B, 1)
        flat_idx = (idx + b_off).reshape(B * C)
        zero = (x * 0.0).reshape(B * S, D)
        upd = _scatter_add(zero, flat_idx, y.reshape(B * C, D), axis=0)
        return x + upd.reshape(B, S, D)

    x = A_x
    xn = _layernorm(x, axis=-1)
    s = _A_ref(xn, A_k_cache, A_v_cache, A_wq, A_wo)
    g = _silu(_B_ref(xn, B_w_r, B_w_gate, B_w_up, B_w_down))
    return x + s * g
```

```asm
; @launch grid=(256,1,1) block=(256,1,1) lds=163840
.amdgcn_target "amdgcn-amd-amdhsa--gfx950"
.text
.globl recurrent_scan__sliding_block_cached__moe_arch_mod__prompt_kernel
.p2align 8
.type recurrent_scan__sliding_block_cached__moe_arch_mod__prompt_kernel,@function
recurrent_scan__sliding_block_cached__moe_arch_mod__prompt_kernel:
    s_cmp_ge_u32 s2, 256
    s_cbranch_scc1 L_end
    s_load_dwordx8 s[48:55], s[0:1], 0
    s_load_dwordx2 s[68:69], s[0:1], 48
    s_load_dwordx4 s[56:59], s[0:1], 88
    s_load_dwordx2 s[76:77], s[0:1], 32
    s_load_dwordx2 s[80:81], s[0:1], 56
    s_load_dwordx2 s[84:85], s[0:1], 64
    s_load_dwordx2 s[88:89], s[0:1], 72
    s_load_dwordx2 s[92:93], s[0:1], 80
    s_getpc_b64 s[96:97]
L_pc:
    s_lshr_b32 s100, s2, 3
    s_lshl_b32 s100, s100, 11
    v_lshrrev_b32 v4, 4, v0
    v_lshl_add_u32 v4, v4, 7, s100
    v_min_u32 v4, L_code_end - L_pc, v4
    v_mov_b32 v5, s97
    v_add_co_u32 v4, vcc, s96, v4
    s_nop 1
    v_addc_co_u32 v5, vcc, 0, v5, vcc
    global_load_dword a255, v[4:5], off
    v_lshrrev_b32 v1, 6, v0
    v_and_b32 v2, 63, v0
    v_readfirstlane_b32 s32, v1
    s_and_b32 s46, s2, 7
    s_lshr_b32 s4, s2, 3
    s_and_b32 s5, s4, 3
    s_lshl_b32 s3, s46, 2
    s_add_u32 s3, s3, s5
    s_lshr_b32 s4, s4, 2
    s_add_u32 s37, s46, s4
    s_and_b32 s37, s37, 7
    v_lshrrev_b32 v3, 3, v2
    v_lshrrev_b32 v4, 4, v2
    v_and_b32 v5, 7, v2
    v_xor_b32 v5, v5, v4
    v_lshlrev_b32 v5, 4, v5
    v_lshl_add_u32 v32, v3, 10, v5
    v_xor_b32 v33, 64, v32
    v_add_u32 v33, 7168, v33
    v_add_u32 v34, 14336, v32
    v_add_u32 v35, 14336, v33
    v_and_b32 v5, 15, v2
    v_lshlrev_b32 v62, 2, v4
    v_xor_b32 v5, v5, v62
    v_lshlrev_b32 v5, 4, v5
    v_lshl_add_u32 v36, v4, 13, v5
    v_add_u32 v37, 31728, v36
    v_add_u32 v38, 63456, v36
    v_add_u32 v39, 95184, v36
    v_lshl_add_u32 v43, v4, 8, v5
    v_add_u32 v40, 48, v43
    v_add_u32 v41, 32, v43
    v_add_u32 v42, 16, v43
    s_mul_i32 s33, s32, 4160
    s_lshl_b32 s44, s32, 12
    s_lshl_b32 s45, s32, 17
    s_lshl_b32 s41, s32, 13
    s_add_u32 s41, s41, 83200
    s_lshl_b32 s5, s4, 18
    s_lshl_b32 s6, s32, 16
    s_add_u32 s5, s5, s6
    s_lshl_b32 s7, s3, 8
    s_lshl_b32 s34, s4, 8
    s_lshl_b32 s35, s3, 3
    s_add_u32 s34, s34, s35
    s_lshl_b32 s35, s32, 1
    s_add_u32 s34, s34, s35
    v_lshrrev_b32 v4, 5, v2
    v_and_b32 v3, 31, v2
    v_add_u32 v45, s34, v4
    v_lshlrev_b32 v209, 4, v3
    v_lshl_add_u32 v46, v45, 10, v209
    s_waitcnt lgkmcnt(0)
    s_mov_b32 s8, s48
    s_mov_b32 s9, s49
    s_add_u32 s8, s8, s5
    s_addc_u32 s9, s9, 0
    s_mov_b32 s10, 0x10000
    s_mov_b32 s11, 0x20000
    s_mov_b32 s12, s54
    s_mov_b32 s13, s55
    s_add_u32 s12, s12, s7
    s_addc_u32 s13, s13, 0
    s_mov_b32 s14, 0x3fe100
    s_mov_b32 s15, 0x20000
    s_lshl_b32 s38, s37, 7
    s_add_u32 s39, s38, 32768
    s_lshl_b32 s40, s37, 19
    s_add_u32 s40, s40, s45
    s_add_u32 s37, s37, 1
    s_and_b32 s37, s37, 7
    s_add_u32 m0, s33, 16640
    s_nop 0
    buffer_load_dwordx4 v36, s[12:15], s40 offen offset:0 lds
    buffer_load_dwordx4 v37, s[12:15], s40 offen offset:1040 lds
    buffer_load_dwordx4 v38, s[12:15], s40 offen offset:2080 lds
    buffer_load_dwordx4 v39, s[12:15], s40 offen offset:3120 lds
    s_add_u32 m0, s41, 0
    s_nop 0
    buffer_load_dwordx4 v32, s[8:11], s38 offen offset:0 lds
    buffer_load_dwordx4 v33, s[8:11], s38 offen offset:1024 lds
    buffer_load_dwordx4 v34, s[8:11], s38 offen offset:2048 lds
    buffer_load_dwordx4 v35, s[8:11], s38 offen offset:3072 lds
    s_add_u32 m0, s41, 4096
    s_nop 0
    buffer_load_dwordx4 v32, s[8:11], s39 offen offset:0 lds
    buffer_load_dwordx4 v33, s[8:11], s39 offen offset:1024 lds
    buffer_load_dwordx4 v34, s[8:11], s39 offen offset:2048 lds
    buffer_load_dwordx4 v35, s[8:11], s39 offen offset:3072 lds
    s_mov_b32 s64, s48
    s_mov_b32 s65, s49
    s_mov_b32 s66, 0x200000
    s_mov_b32 s67, 0x20000
    s_mov_b32 s70, 0x400
    s_mov_b32 s71, 0x20000
    s_lshl_b32 s5, s3, 19
    s_add_u32 s16, s50, 0x5ffd0
    s_addc_u32 s17, s51, 0
    s_add_u32 s16, s16, s5
    s_addc_u32 s17, s17, 0
    s_mov_b32 s18, 0x20030
    s_mov_b32 s19, 0x20000
    s_add_u32 s20, s52, 0x5ffd0
    s_addc_u32 s21, s53, 0
    s_add_u32 s20, s20, s5
    s_addc_u32 s21, s21, 0
    s_mov_b32 s22, 0x20030
    s_mov_b32 s23, 0x20000
    s_lshl_b32 s5, s4, 2
    s_add_u32 s5, s5, s32
    s_mul_i32 s5, s5, 526336
    s_lshl_b32 s6, s3, 13
    s_add_u32 s5, s5, s6
    s_add_u32 s24, s58, 0x200000
    s_addc_u32 s25, s59, 0
    s_add_u32 s24, s24, s5
    s_addc_u32 s25, s25, 0
    s_mov_b32 s26, 0x42400
    s_mov_b32 s27, 0x20000
    s_mov_b32 s28, s58
    s_mov_b32 s29, s59
    s_mov_b32 s30, 0x1900000
    s_mov_b32 s31, 0x20000
    s_mov_b32 s72, s56
    s_mov_b32 s73, s57
    s_mov_b32 s74, 0x100
    s_mov_b32 s75, 0x20000
    s_mov_b32 s78, 0x400000
    s_mov_b32 s79, 0x20000
    s_mov_b32 s82, 0x158000
    s_mov_b32 s83, 0x20000
    s_mov_b32 s86, 0x158000
    s_mov_b32 s87, 0x20000
    s_mov_b32 s90, 0x158000
    s_mov_b32 s91, 0x20000
    s_mov_b32 s94, 0x200000
    s_mov_b32 s95, 0x20000
    v_lshlrev_b32 v44, 4, v2
    v_bfe_u32 v5, v2, 1, 3
    v_xor_b32 v5, v5, v4
    v_lshlrev_b32 v62, 7, v3
    v_add_u32 v62, s41, v62
    v_xor_b32 v63, 0, v5
    v_lshl_add_u32 v28, v63, 4, v62
    v_xor_b32 v63, 2, v5
    v_lshl_add_u32 v29, v63, 4, v62
    v_xor_b32 v63, 4, v5
    v_lshl_add_u32 v30, v63, 4, v62
    v_xor_b32 v63, 6, v5
    v_lshl_add_u32 v31, v63, 4, v62
    v_bfe_u32 v5, v2, 2, 2
    v_mul_u32_u24 v62, 2080, v4
    v_lshl_add_u32 v62, v5, 8, v62
    v_bfe_u32 v63, v2, 4, 1
    v_lshl_add_u32 v62, v63, 5, v62
    v_and_b32 v63, 1, v2
    v_lshl_add_u32 v62, v63, 4, v62
    v_bfe_u32 v63, v2, 1, 1
    v_lshl_add_u32 v62, v63, 3, v62
    v_xor_b32 v63, 0, v5
    v_lshl_add_u32 v16, v63, 6, v62
    v_xor_b32 v63, 1, v5
    v_lshl_add_u32 v17, v63, 6, v62
    v_xor_b32 v63, 2, v5
    v_lshl_add_u32 v18, v63, 6, v62
    v_xor_b32 v63, 3, v5
    v_lshl_add_u32 v19, v63, 6, v62
    v_xor_b32 v5, s32, v5
    v_add_u32 v62, 16640, v62
    v_xor_b32 v63, 0, v5
    v_lshl_add_u32 v24, v63, 6, v62
    v_xor_b32 v63, 1, v5
    v_lshl_add_u32 v25, v63, 6, v62
    v_xor_b32 v63, 2, v5
    v_lshl_add_u32 v26, v63, 6, v62
    v_xor_b32 v63, 3, v5
    v_lshl_add_u32 v27, v63, 6, v62
    v_mov_b32 v240, 0x3f803f80
    v_mov_b32 v241, 0x3f803f80
    v_mov_b32 v242, 0x3f803f80
    v_mov_b32 v243, 0x3f803f80
    s_mov_b32 s47, 0xffff0000
    v_and_b32 v5, 3, v3
    v_bfe_u32 v62, v3, 2, 1
    v_bfe_u32 v63, v3, 3, 1
    v_lshl_add_u32 v62, v62, 1, v63
    v_bfe_u32 v63, v3, 4, 1
    v_lshl_add_u32 v62, v63, 2, v62
    v_mul_u32_u24 v62, 1040, v62
    v_lshl_add_u32 v62, v5, 8, v62
    v_lshl_add_u32 v62, v4, 4, v62
    v_xor_b32 v5, s32, v5
    v_xor_b32 v63, 0, v5
    v_lshl_add_u32 v8, v63, 6, v62
    v_add_u32 v12, 66560, v8
    v_add_u32 v20, 66560, v16
    v_xor_b32 v63, 1, v5
    v_lshl_add_u32 v9, v63, 6, v62
    v_add_u32 v13, 66560, v9
    v_add_u32 v21, 66560, v17
    v_xor_b32 v63, 2, v5
    v_lshl_add_u32 v10, v63, 6, v62
    v_add_u32 v14, 66560, v10
    v_add_u32 v22, 66560, v18
    v_xor_b32 v63, 3, v5
    v_lshl_add_u32 v11, v63, 6, v62
    v_add_u32 v15, 66560, v11
    v_add_u32 v23, 66560, v19
    s_mov_b32 s36, 0x47800000
    v_mov_b32 v62, 1073741824
    v_cmp_eq_u32 vcc, 0, v3
    v_lshlrev_b32 v63, 3, v45
    v_add_u32 v63, 19955712, v63
    v_cndmask_b32 v47, v62, v63, vcc
    v_cmp_eq_u32 vcc, 0, v2
    s_lshl_b32 s34, s2, 4
    s_lshl_b32 s35, s32, 2
    s_add_u32 s34, s34, s35
    s_add_u32 s34, s34, 19922944
    v_mov_b32 v63, s34
    v_cndmask_b32 v48, v62, v63, vcc
    v_cmp_eq_u32 vcc, 0, v0
    s_nop 1
    v_cndmask_b32 v49, v62, 0, vcc
    s_lshl_b32 s34, s4, 11
    s_lshl_b32 s35, s32, 9
    s_add_u32 s34, s34, s35
    s_add_u32 s34, s34, 19955712
    v_lshlrev_b32 v1, 3, v3
    v_add_u32 v1, s34, v1
    v_lshlrev_b32 v3, 2, v3
    v_lshlrev_b32 v63, 2, v0
    v_cmp_gt_u32 vcc, 64, v0
    s_cmp_eq_u32 s32, 0
    s_cselect_b32 s49, 0x01010101, 0
    v_cndmask_b32 v50, v62, v63, vcc
    s_lshl_b32 s34, s2, 10
    s_add_u32 s34, s34, 20340736
    v_cndmask_b32 v63, v62, v44, vcc
    v_mov_b32 v56, 0
    v_mov_b32 v57, 0
    v_mov_b32 v58, 0
    v_mov_b32 v59, 0
    s_mov_b32 s43, s34
    s_lshl_b32 s34, s4, 10
    s_lshl_b32 s48, s3, 2
    s_add_u32 s48, s48, s34
    s_add_u32 s48, s48, 20340736
    s_lshl_b32 s38, s37, 7
    s_add_u32 s39, s38, 32768
    s_lshl_b32 s40, s37, 19
    s_add_u32 s40, s40, s45
    s_add_u32 s37, s37, 1
    s_and_b32 s37, s37, 7
    buffer_load_dwordx4 v[192:195], v46, s[64:67], 0 offen
    buffer_load_dwordx4 v[196:199], v46, s[64:67], 0 offen offset:512
    s_add_u32 m0, s33, 33280
    s_nop 0
    buffer_load_dwordx4 v36, s[12:15], s40 offen offset:0 lds
    buffer_load_dwordx4 v37, s[12:15], s40 offen offset:1040 lds
    buffer_load_dwordx4 v38, s[12:15], s40 offen offset:2080 lds
    buffer_load_dwordx4 v39, s[12:15], s40 offen offset:3120 lds
    buffer_load_dwordx4 v[200:203], v209, s[68:71], 0 offen
    buffer_load_dwordx4 v[204:207], v209, s[68:71], 0 offen offset:512
    buffer_store_dwordx4 v[56:59], v63, s[28:31], s43 offen sc1
    s_waitcnt vmcnt(9)
    ds_read_b128 a[128:131], v28 offset:0
    ds_read_b128 a[132:135], v28 offset:4096
    ds_read_b128 a[136:139], v29 offset:0
    ds_read_b128 a[140:143], v29 offset:4096
    ds_read_b128 a[144:147], v30 offset:0
    ds_read_b128 a[148:151], v30 offset:4096
    ds_read_b128 a[152:155], v31 offset:0
    ds_read_b128 a[156:159], v31 offset:4096
    s_barrier
    ds_read_b64_tr_b16 a[192:193], v24 offset:0
    ds_read_b64_tr_b16 a[194:195], v24 offset:1040
    ds_read_b64_tr_b16 a[196:197], v25 offset:0
    ds_read_b64_tr_b16 a[198:199], v25 offset:1040
    ds_read_b64_tr_b16 a[200:201], v26 offset:0
    ds_read_b64_tr_b16 a[202:203], v26 offset:1040
    ds_read_b64_tr_b16 a[204:205], v27 offset:0
    s_waitcnt lgkmcnt(14)
    ds_read_b64_tr_b16 a[206:207], v27 offset:1040
    s_waitcnt lgkmcnt(14)
    ds_read_b64_tr_b16 a[208:209], v24 offset:4160
    s_waitcnt lgkmcnt(14)
    ds_read_b64_tr_b16 a[210:211], v24 offset:5200
    s_waitcnt lgkmcnt(8)
    v_mfma_f32_32x32x16_bf16 v[64:79], a[192:195], a[128:131], 0
    s_add_u32 m0, s41, 32768
    s_nop 0
    buffer_load_dwordx4 v32, s[8:11], s38 offen offset:0 lds
    v_mfma_f32_32x32x16_bf16 v[128:143], a[192:195], a[132:135], 0
    buffer_load_dwordx4 v33, s[8:11], s38 offen offset:1024 lds
    v_mfma_f32_32x32x16_bf16 v[224:239], v[240:243], a[192:195], 0
    ds_read_b64_tr_b16 a[212:213], v25 offset:4160
    ds_read_b64_tr_b16 a[214:215], v25 offset:5200
    buffer_load_dwordx4 v34, s[8:11], s38 offen offset:2048 lds
    s_waitcnt lgkmcnt(8)
    v_mfma_f32_32x32x16_bf16 v[80:95], a[196:199], a[128:131], 0
    buffer_load_dwordx4 v35, s[8:11], s38 offen offset:3072 lds
    v_mfma_f32_32x32x16_bf16 v[144:159], a[196:199], a[132:135], 0
    ds_read_b64_tr_b16 a[216:217], v26 offset:4160
    ds_read_b64_tr_b16 a[218:219], v26 offset:5200
    s_add_u32 m0, s41, 36864
    s_nop 0
    buffer_load_dwordx4 v32, s[8:11], s39 offen offset:0 lds
    s_waitcnt vmcnt(13)
    v_lshlrev_b32 v208, 16, v192
    s_waitcnt lgkmcnt(8)
    v_mfma_f32_32x32x16_bf16 v[96:111], a[200:203], a[128:131], 0
    buffer_load_dwordx4 v33, s[8:11], s39 offen offset:1024 lds
    v_and_b32 v209, s47, v192
    v_lshlrev_b32 v210, 16, v193
    v_and_b32 v211, s47, v193
    v_lshlrev_b32 v212, 16, v194
    v_and_b32 v213, s47, v194
    v_mfma_f32_32x32x16_bf16 v[160:175], a[200:203], a[132:135], 0
    ds_read_b64_tr_b16 a[220:221], v27 offset:4160
    ds_read_b64_tr_b16 a[222:223], v27 offset:5200
    buffer_load_dwordx4 v34, s[8:11], s39 offen offset:2048 lds
    v_lshlrev_b32 v214, 16, v195
    v_and_b32 v215, s47, v195
    s_waitcnt lgkmcnt(6)
    v_mfma_f32_32x32x16_bf16 v[112:127], a[204:207], a[128:131], 0
    buffer_load_dwordx4 v35, s[8:11], s39 offen offset:3072 lds
    s_lshl_b32 s38, s37, 7
    s_add_u32 s39, s38, 32768
    s_lshl_b32 s40, s37, 19
    s_waitcnt vmcnt(15)
    v_lshlrev_b32 v216, 16, v196
    v_and_b32 v217, s47, v196
    v_mfma_f32_32x32x16_bf16 v[176:191], a[204:207], a[132:135], 0
    ds_read_b64_tr_b16 a[224:225], v24 offset:8320
    ds_read_b64_tr_b16 a[226:227], v24 offset:9360
    s_add_u32 s40, s40, s45
    s_add_u32 s37, s37, 1
    s_and_b32 s37, s37, 7
    v_lshlrev_b32 v218, 16, v197
    v_and_b32 v219, s47, v197
    v_mfma_f32_32x32x16_bf16 v[64:79], a[208:211], a[136:139], v[64:79]
    s_add_u32 m0, s41, 0
    s_nop 0
    buffer_load_dwordx4 v32, s[8:11], s38 offen offset:0 lds
    v_lshlrev_b32 v220, 16, v198
    v_and_b32 v221, s47, v198
    v_lshlrev_b32 v222, 16, v199
    v_mfma_f32_32x32x16_bf16 v[128:143], a[208:211], a[140:143], v[128:143]
    buffer_load_dwordx4 v33, s[8:11], s38 offen offset:1024 lds
    v_and_b32 v223, s47, v199
    v_add_f32 v58, v208, v209
    v_add_f32 v55, v210, v211
    v_add_f32 v58, v58, v212
    v_add_f32 v55, v55, v213
    v_mfma_f32_32x32x16_bf16 v[224:239], v[240:243], a[208:211], v[224:239]
    ds_read_b64_tr_b16 a[228:229], v25 offset:8320
    ds_read_b64_tr_b16 a[230:231], v25 offset:9360
    buffer_load_dwordx4 v34, s[8:11], s38 offen offset:2048 lds
    v_add_f32 v58, v58, v214
    v_add_f32 v55, v55, v215
    s_waitcnt lgkmcnt(2)
    v_mfma_f32_32x32x16_bf16 v[80:95], a[212:215], a[136:139], v[80:95]
    buffer_load_dwordx4 v35, s[8:11], s38 offen offset:3072 lds
    v_add_f32 v58, v58, v216
    v_add_f32 v55, v55, v217
    v_add_f32 v58, v58, v218
    v_add_f32 v55, v55, v219
    v_add_f32 v58, v58, v220
    v_mfma_f32_32x32x16_bf16 v[144:159], a[212:215], a[140:143], v[144:159]
    ds_read_b64_tr_b16 a[232:233], v26 offset:8320
    ds_read_b64_tr_b16 a[234:235], v26 offset:9360
    s_add_u32 m0, s41, 4096
    s_nop 0
    buffer_load_dwordx4 v32, s[8:11], s39 offen offset:0 lds
    v_add_f32 v55, v55, v221
    v_mfma_f32_32x32x16_bf16 v[96:111], a[216:219], a[136:139], v[96:111]
    buffer_load_dwordx4 v33, s[8:11], s39 offen offset:1024 lds
    v_add_f32 v58, v58, v222
    v_add_f32 v55, v55, v223
    v_add_f32 v58, v58, v55
    s_nop 1
    v_add_f32_dpp v58, v58, v58 quad_perm:[1,0,3,2] row_mask:0xf bank_mask:0xf
    s_nop 1
    v_add_f32_dpp v58, v58, v58 quad_perm:[2,3,0,1] row_mask:0xf bank_mask:0xf
    v_mfma_f32_32x32x16_bf16 v[160:175], a[216:219], a[140:143], v[160:175]
    ds_read_b64_tr_b16 a[236:237], v27 offset:8320
    ds_read_b64_tr_b16 a[238:239], v27 offset:9360
    buffer_load_dwordx4 v34, s[8:11], s39 offen offset:2048 lds
    v_add_f32_dpp v58, v58, v58 row_half_mirror row_mask:0xf bank_mask:0xf
    s_nop 1
    v_add_f32_dpp v58, v58, v58 row_mirror row_mask:0xf bank_mask:0xf
    v_mfma_f32_32x32x16_bf16 v[112:127], a[220:223], a[136:139], v[112:127]
    buffer_load_dwordx4 v35, s[8:11], s39 offen offset:3072 lds
    v_mov_b32 v55, v58
    s_nop 1
    v_permlane16_swap_b32 v58, v55
    v_add_f32 v58, v58, v55
    v_mul_f32 v58, 0x3b000000, v58
    v_sub_f32 v56, v208, v58
    v_mfma_f32_32x32x16_bf16 v[176:191], a[220:223], a[140:143], v[176:191]
    ds_read_b64_tr_b16 a[240:241], v24 offset:12480
    ds_read_b64_tr_b16 a[242:243], v24 offset:13520
    s_add_u32 m0, s33, 49920
    s_nop 0
    buffer_load_dwordx4 v36, s[12:15], s40 offen offset:0 lds
    v_sub_f32 v57, v209, v58
    v_mfma_f32_32x32x16_bf16 v[64:79], a[224:227], a[144:147], v[64:79]
    buffer_load_dwordx4 v37, s[12:15], s40 offen offset:1040 lds
    v_mul_f32 v59, v56, v56
    v_mul_f32 v55, v57, v57
    v_sub_f32 v56, v210, v58
    v_sub_f32 v57, v211, v58
    v_fmac_f32 v59, v56, v56
    v_mfma_f32_32x32x16_bf16 v[128:143], a[224:227], a[148:151], v[128:143]
    buffer_load_dwordx4 v38, s[12:15], s40 offen offset:2080 lds
    v_fmac_f32 v55, v57, v57
    v_sub_f32 v56, v212, v58
    v_sub_f32 v57, v213, v58
    v_fmac_f32 v59, v56, v56
    v_fmac_f32 v55, v57, v57
    v_mfma_f32_32x32x16_bf16 v[224:239], v[240:243], a[224:227], v[224:239]
    ds_read_b64_tr_b16 a[244:245], v25 offset:12480
    ds_read_b64_tr_b16 a[246:247], v25 offset:13520
    buffer_load_dwordx4 v39, s[12:15], s40 offen offset:3120 lds
    v_sub_f32 v56, v214, v58
    v_sub_f32 v57, v215, v58
    s_waitcnt lgkmcnt(3)
    v_mfma_f32_32x32x16_bf16 v[80:95], a[228:231], a[144:147], v[80:95]
    v_fmac_f32 v59, v56, v56
    v_fmac_f32 v55, v57, v57
    v_sub_f32 v56, v216, v58
    v_sub_f32 v57, v217, v58
    v_fmac_f32 v59, v56, v56
    v_fmac_f32 v55, v57, v57
    v_sub_f32 v56, v218, v58
    v_sub_f32 v57, v219, v58
    v_mfma_f32_32x32x16_bf16 v[144:159], a[228:231], a[148:151], v[144:159]
    ds_read_b64_tr_b16 a[248:249], v26 offset:12480
    ds_read_b64_tr_b16 a[250:251], v26 offset:13520
    v_fmac_f32 v59, v56, v56
    v_fmac_f32 v55, v57, v57
    v_sub_f32 v56, v220, v58
    v_sub_f32 v57, v221, v58
    v_fmac_f32 v59, v56, v56
    v_mfma_f32_32x32x16_bf16 v[96:111], a[232:235], a[144:147], v[96:111]
    v_fmac_f32 v55, v57, v57
    v_sub_f32 v56, v222, v58
    v_sub_f32 v57, v223, v58
    v_fmac_f32 v59, v56, v56
    v_fmac_f32 v55, v57, v57
    v_add_f32 v59, v59, v55
    s_nop 1
    v_add_f32_dpp v59, v59, v59 quad_perm:[1,0,3,2] row_mask:0xf bank_mask:0xf
    s_nop 1
    v_add_f32_dpp v59, v59, v59 quad_perm:[2,3,0,1] row_mask:0xf bank_mask:0xf
    v_mfma_f32_32x32x16_bf16 v[160:175], a[232:235], a[148:151], v[160:175]
    ds_read_b64_tr_b16 a[252:253], v27 offset:12480
    ds_read_b64_tr_b16 a[254:255], v27 offset:13520
    v_add_f32_dpp v59, v59, v59 row_half_mirror row_mask:0xf bank_mask:0xf
    s_nop 1
    v_add_f32_dpp v59, v59, v59 row_mirror row_mask:0xf bank_mask:0xf
    v_mov_b32 v55, v59
    s_nop 1
    v_permlane16_swap_b32 v59, v55
    v_add_f32 v59, v59, v55
    v_mfma_f32_32x32x16_bf16 v[112:127], a[236:239], a[144:147], v[112:127]
    v_mul_f32 v59, 0x3b000000, v59
    v_cvt_pk_bf16_f32 v58, v58, v58
    v_lshlrev_b32 v58, 16, v58
    v_cvt_pk_bf16_f32 v59, v59, v59
    v_lshlrev_b32 v59, 16, v59
    v_add_f32 v59, 0x3727c5ac, v59
    v_cvt_pk_bf16_f32 v59, v59, v59
    v_lshlrev_b32 v59, 16, v59
    v_mfma_f32_32x32x16_bf16 v[176:191], a[236:239], a[148:151], v[176:191]
    s_waitcnt vmcnt(23)
    s_barrier
    ds_read_b64_tr_b16 a[192:193], v24 offset:16640
    ds_read_b64_tr_b16 a[194:195], v24 offset:17680
    v_sqrt_f32 v59, v59
    v_mov_b32 v54, 0
    v_cvt_pk_bf16_f32 v59, v59, v59
    s_waitcnt lgkmcnt(4)
    v_mfma_f32_32x32x16_bf16 v[64:79], a[240:243], a[152:155], v[64:79]
    v_lshlrev_b32 v59, 16, v59
    v_rcp_f32 v59, v59
    v_mov_b32 v55, 0
    buffer_store_dwordx2 v[58:59], v47, s[28:31], 0 offen sc1
    v_sub_f32 v208, v208, v58
    v_mfma_f32_32x32x16_bf16 v[128:143], a[240:243], a[156:159], v[128:143]
    ds_read_b64_tr_b16 a[196:197], v25 offset:16640
    ds_read_b64_tr_b16 a[198:199], v25 offset:17680
    v_sub_f32 v209, v209, v58
    v_cvt_pk_bf16_f32 v208, v208, v209
    v_and_b32 v209, s47, v208
    v_lshlrev_b32 v208, 16, v208
    v_mul_f32 v208, v208, v59
    v_mul_f32 v209, v209, v59
    v_mfma_f32_32x32x16_bf16 v[224:239], v[240:243], a[240:243], v[224:239]
    v_cvt_pk_bf16_f32 v192, v208, v209
    v_lshlrev_b32 v208, 16, v192
    v_and_b32 v209, s47, v192
    s_waitcnt vmcnt(23)
    v_lshlrev_b32 v56, 16, v200
    v_and_b32 v57, s47, v200
    v_fmac_f32 v54, v208, v56
    v_fmac_f32 v55, v209, v57
    v_mfma_f32_32x32x16_bf16 v[80:95], a[244:247], a[152:155], v[80:95]
    ds_read_b64_tr_b16 a[200:201], v26 offset:16640
    ds_read_b64_tr_b16 a[202:203], v26 offset:17680
    s_waitcnt vmcnt(13)
    ds_read_b128 a[160:163], v28 offset:32768
    v_sub_f32 v210, v210, v58
    v_sub_f32 v211, v211, v58
    v_cvt_pk_bf16_f32 v210, v210, v211
    v_and_b32 v211, s47, v210
    v_mfma_f32_32x32x16_bf16 v[144:159], a[244:247], a[156:159], v[144:159]
    ds_read_b128 a[164:167], v28 offset:36864
    v_lshlrev_b32 v210, 16, v210
    v_mul_f32 v210, v210, v59
    v_mul_f32 v211, v211, v59
    v_cvt_pk_bf16_f32 v193, v210, v211
    v_lshlrev_b32 v210, 16, v193
    v_and_b32 v211, s47, v193
    v_mfma_f32_32x32x16_bf16 v[96:111], a[248:251], a[152:155], v[96:111]
    ds_read_b64_tr_b16 a[204:205], v27 offset:16640
    ds_read_b64_tr_b16 a[206:207], v27 offset:17680
    ds_read_b128 a[168:171], v29 offset:32768
    v_lshlrev_b32 v56, 16, v201
    v_and_b32 v57, s47, v201
    v_fmac_f32 v54, v210, v56
    v_fmac_f32 v55, v211, v57
    v_sub_f32 v212, v212, v58
    v_mfma_f32_32x32x16_bf16 v[160:175], a[248:251], a[156:159], v[160:175]
    ds_read_b128 a[172:175], v29 offset:36864
    v_sub_f32 v213, v213, v58
    v_cvt_pk_bf16_f32 v212, v212, v213
    v_and_b32 v213, s47, v212
    v_lshlrev_b32 v212, 16, v212
    v_mul_f32 v212, v212, v59
    v_mul_f32 v213, v213, v59
    s_waitcnt lgkmcnt(5)
    v_mfma_f32_32x32x16_bf16 v[112:127], a[252:255], a[152:155], v[112:127]
    ds_read_b64_tr_b16 a[208:209], v24 offset:20800
    ds_read_b64_tr_b16 a[210:211], v24 offset:21840
    v_cvt_pk_bf16_f32 v194, v212, v213
    v_lshlrev_b32 v212, 16, v194
    v_and_b32 v213, s47, v194
    v_lshlrev_b32 v56, 16, v202
    v_and_b32 v57, s47, v202
    v_fmac_f32 v54, v212, v56
    v_mfma_f32_32x32x16_bf16 v[176:191], a[252:255], a[156:159], v[176:191]
    v_fmac_f32 v55, v213, v57
    v_sub_f32 v214, v214, v58
    v_sub_f32 v215, v215, v58
    v_cvt_pk_bf16_f32 v214, v214, v215
    v_and_b32 v215, s47, v214
    v_lshlrev_b32 v214, 16, v214
    v_mul_f32 v214, v214, v59
    v_mfma_f32_32x32x16_bf16 v[64:79], a[192:195], a[160:163], v[64:79]
    ds_read_b64_tr_b16 a[212:213], v25 offset:20800
    ds_read_b64_tr_b16 a[214:215], v25 offset:21840
    ds_read_b128 a[176:179], v30 offset:32768
    v_mul_f32 v215, v215, v59
    v_cvt_pk_bf16_f32 v195, v214, v215
    v_lshlrev_b32 v214, 16, v195
    v_and_b32 v215, s47, v195
    v_lshlrev_b32 v56, 16, v203
    s_waitcnt lgkmcnt(4)
    v_mfma_f32_32x32x16_bf16 v[128:143], a[192:195], a[164:167], v[128:143]
    ds_read_b128 a[180:183], v30 offset:36864
    v_and_b32 v57, s47, v203
    v_fmac_f32 v54, v214, v56
    v_fmac_f32 v55, v215, v57
    buffer_store_dwordx4 v[192:195], v46, s[28:31], 0 offen sc1
    v_mfma_f32_32x32x16_bf16 v[80:95], a[196:199], a[160:163], v[80:95]
    ds_read_b64_tr_b16 a[216:217], v26 offset:20800
    ds_read_b64_tr_b16 a[218:219], v26 offset:21840
    ds_read_b128 a[184:187], v31 offset:32768
    v_sub_f32 v216, v216, v58
    v_sub_f32 v217, v217, v58
    v_cvt_pk_bf16_f32 v216, v216, v217
    v_and_b32 v217, s47, v216
    v_lshlrev_b32 v216, 16, v216
    v_mfma_f32_32x32x16_bf16 v[144:159], a[196:199], a[164:167], v[144:159]
    ds_read_b128 a[188:191], v31 offset:36864
    v_mul_f32 v216, v216, v59
    v_mul_f32 v217, v217, v59
    v_cvt_pk_bf16_f32 v196, v216, v217
    v_lshlrev_b32 v216, 16, v196
    v_and_b32 v217, s47, v196
    v_lshlrev_b32 v56, 16, v204
    v_mfma_f32_32x32x16_bf16 v[96:111], a[200:203], a[160:163], v[96:111]
    ds_read_b64_tr_b16 a[220:221], v27 offset:20800
    ds_read_b64_tr_b16 a[222:223], v27 offset:21840
    s_lshl_b32 s38, s37, 7
    s_add_u32 s39, s38, 32768
    s_lshl_b32 s40, s37, 19
    v_and_b32 v57, s47, v204
    v_fmac_f32 v54, v216, v56
    v_fmac_f32 v55, v217, v57
    v_mfma_f32_32x32x16_bf16 v[160:175], a[200:203], a[164:167], v[160:175]
    s_add_u32 s40, s40, s45
    s_add_u32 s37, s37, 1
    s_and_b32 s37, s37, 7
    v_sub_f32 v218, v218, v58
    v_sub_f32 v219, v219, v58
    v_cvt_pk_bf16_f32 v218, v218, v219
    v_and_b32 v219, s47, v218
    v_mfma_f32_32x32x16_bf16 v[112:127], a[204:207], a[160:163], v[112:127]
    ds_read_b64_tr_b16 a[224:225], v24 offset:24960
    ds_read_b64_tr_b16 a[226:227], v24 offset:26000
    s_waitcnt lgkmcnt(4)
    s_add_u32 m0, s41, 32768
    s_nop 0
    buffer_load_dwordx4 v32, s[8:11], s38 offen offset:0 lds
    v_lshlrev_b32 v218, 16, v218
    v_mfma_f32_32x32x16_bf16 v[176:191], a[204:207], a[164:167], v[176:191]
    buffer_load_dwordx4 v33, s[8:11], s38 offen offset:1024 lds
    v_mul_f32 v218, v218, v59
    v_mul_f32 v219, v219, v59
    v_cvt_pk_bf16_f32 v197, v218, v219
    v_lshlrev_b32 v218, 16, v197
    v_mfma_f32_32x32x16_bf16 v[64:79], a[208:211], a[168:171], v[64:79]
    ds_read_b64_tr_b16 a[228:229], v25 offset:24960
    ds_read_b64_tr_b16 a[230:231], v25 offset:26000
    buffer_load_dwordx4 v34, s[8:11], s38 offen offset:2048 lds
    v_and_b32 v219, s47, v197
    v_lshlrev_b32 v56, 16, v205
    v_and_b32 v57, s47, v205
    v_mfma_f32_32x32x16_bf16 v[128:143], a[208:211], a[172:175], v[128:143]
    buffer_load_dwordx4 v35, s[8:11], s38 offen offset:3072 lds
    v_fmac_f32 v54, v218, v56
    v_fmac_f32 v55, v219, v57
    v_sub_f32 v220, v220, v58
    v_sub_f32 v221, v221, v58
    v_mfma_f32_32x32x16_bf16 v[80:95], a[212:215], a[168:171], v[80:95]
    ds_read_b64_tr_b16 a[232:233], v26 offset:24960
    ds_read_b64_tr_b16 a[234:235], v26 offset:26000
    s_add_u32 m0, s41, 36864
    s_nop 0
    buffer_load_dwordx4 v32, s[8:11], s39 offen offset:0 lds
    v_cvt_pk_bf16_f32 v220, v220, v221
    v_and_b32 v221, s47, v220
    v_mfma_f32_32x32x16_bf16 v[144:159], a[212:215], a[172:175], v[144:159]
    buffer_load_dwordx4 v33, s[8:11], s39 offen offset:1024 lds
    v_lshlrev_b32 v220, 16, v220
    v_mul_f32 v220, v220, v59
    v_mul_f32 v221, v221, v59
    v_cvt_pk_bf16_f32 v198, v220, v221
    v_mfma_f32_32x32x16_bf16 v[96:111], a[216:219], a[168:171], v[96:111]
    ds_read_b64_tr_b16 a[236:237], v27 offset:24960
    ds_read_b64_tr_b16 a[238:239], v27 offset:26000
    buffer_load_dwordx4 v34, s[8:11], s39 offen offset:2048 lds
    v_lshlrev_b32 v220, 16, v198
    v_and_b32 v221, s47, v198
    v_lshlrev_b32 v56, 16, v206
    v_mfma_f32_32x32x16_bf16 v[160:175], a[216:219], a[172:175], v[160:175]
    buffer_load_dwordx4 v35, s[8:11], s39 offen offset:3072 lds
    v_and_b32 v57, s47, v206
    v_fmac_f32 v54, v220, v56
    v_fmac_f32 v55, v221, v57
    v_sub_f32 v222, v222, v58
    s_waitcnt lgkmcnt(3)
    v_mfma_f32_32x32x16_bf16 v[112:127], a[220:223], a[168:171], v[112:127]
    ds_read_b64_tr_b16 a[240:241], v24 offset:29120
    ds_read_b64_tr_b16 a[242:243], v24 offset:30160
    s_add_u32 m0, s33, 66560
    s_nop 0
    buffer_load_dwordx4 v36, s[12:15], s40 offen offset:0 lds
    v_sub_f32 v223, v223, v58
    v_cvt_pk_bf16_f32 v222, v222, v223
    v_mfma_f32_32x32x16_bf16 v[176:191], a[220:223], a[172:175], v[176:191]
    buffer_load_dwordx4 v37, s[12:15], s40 offen offset:1040 lds
    v_and_b32 v223, s47, v222
    v_lshlrev_b32 v222, 16, v222
    v_mul_f32 v222, v222, v59
    v_mul_f32 v223, v223, v59
    v_mfma_f32_32x32x16_bf16 v[64:79], a[224:227], a[176:179], v[64:79]
    ds_read_b64_tr_b16 a[244:245], v25 offset:29120
    ds_read_b64_tr_b16 a[246:247], v25 offset:30160
    buffer_load_dwordx4 v38, s[12:15], s40 offen offset:2080 lds
    v_cvt_pk_bf16_f32 v199, v222, v223
    v_lshlrev_b32 v222, 16, v199
    v_and_b32 v223, s47, v199
    v_mfma_f32_32x32x16_bf16 v[128:143], a[224:227], a[180:183], v[128:143]
    buffer_load_dwordx4 v39, s[12:15], s40 offen offset:3120 lds
    v_lshlrev_b32 v56, 16, v207
    v_and_b32 v57, s47, v207
    v_fmac_f32 v54, v222, v56
    v_fmac_f32 v55, v223, v57
    v_mfma_f32_32x32x16_bf16 v[80:95], a[228:231], a[176:179], v[80:95]
    ds_read_b64_tr_b16 a[248:249], v26 offset:29120
    ds_read_b64_tr_b16 a[250:251], v26 offset:30160
    buffer_store_dwordx4 v[196:199], v46, s[28:31], 0 offen offset:512 sc1
    v_add_f32 v54, v54, v55
    s_nop 1
    v_add_f32_dpp v54, v54, v54 quad_perm:[1,0,3,2] row_mask:0xf bank_mask:0xf
    s_nop 1
    v_add_f32_dpp v54, v54, v54 quad_perm:[2,3,0,1] row_mask:0xf bank_mask:0xf
    v_mfma_f32_32x32x16_bf16 v[144:159], a[228:231], a[180:183], v[144:159]
    s_nop 0
    v_add_f32_dpp v54, v54, v54 row_half_mirror row_mask:0xf bank_mask:0xf
    s_nop 1
    v_add_f32_dpp v54, v54, v54 row_mirror row_mask:0xf bank_mask:0xf
    v_mov_b32 v55, v54
    s_nop 1
    v_permlane16_swap_b32 v54, v55
    v_add_f32 v54, v54, v55
    v_cvt_pk_bf16_f32 v54, v54, v54
    v_and_b32 v54, s47, v54
    s_waitcnt lgkmcnt(2)
    v_mfma_f32_32x32x16_bf16 v[96:111], a[232:235], a[176:179], v[96:111]
    ds_read_b64_tr_b16 a[252:253], v27 offset:29120
    ds_read_b64_tr_b16 a[254:255], v27 offset:30160
    v_ashrrev_i32 v55, 31, v54
    v_or_b32 v55, 0x80000000, v55
    v_xor_b32 v54, v54, v55
    v_and_b32 v54, s47, v54
    v_sub_u32 v55, 0xffff, v45
    v_or_b32 v54, v54, v55
    v_mfma_f32_32x32x16_bf16 v[160:175], a[232:235], a[180:183], v[160:175]
    v_mov_b32 v55, v54
    s_nop 1
    v_permlane32_swap_b32 v54, v55
    v_max_u32 v54, v54, v55
    buffer_store_dword v54, v48, s[28:31], 0 offen sc1
    v_mov_b32 v55, 1
    v_mfma_f32_32x32x16_bf16 v[112:127], a[236:239], a[176:179], v[112:127]
    s_waitcnt vmcnt(16)
    s_barrier
    ds_read_b64_tr_b16 a[192:193], v24 offset:33280
    ds_read_b64_tr_b16 a[194:195], v24 offset:34320
    v_mfma_f32_32x32x16_bf16 v[176:191], a[236:239], a[180:183], v[176:191]
    s_lshl_b32 s63, s3, 12
    s_lshl_b32 s34, s32, 7
    s_add_u32 s63, s63, s34
    s_add_u32 s63, s63, 25690112
    v_mfma_f32_32x32x16_bf16 v[64:79], a[240:243], a[184:187], v[64:79]
    ds_read_b64_tr_b16 a[196:197], v25 offset:33280
    ds_read_b64_tr_b16 a[198:199], v25 offset:34320
    s_lshl_b32 s34, s4, 9
    s_add_u32 s34, s34, s63
    v_mfma_f32_32x32x16_bf16 v[128:143], a[240:243], a[188:191], v[128:143]
    buffer_store_dword v224, v3, s[28:31], s34 offen sc1
    v_lshrrev_b32 v232, 5, v2
    v_mfma_f32_32x32x16_bf16 v[80:95], a[244:247], a[184:187], v[80:95]
    ds_read_b64_tr_b16 a[200:201], v26 offset:33280
    ds_read_b64_tr_b16 a[202:203], v26 offset:34320
    ds_read_b128 a[128:131], v28 offset:0
    v_mfma_f32_32x32x16_bf16 v[144:159], a[244:247], a[188:191], v[144:159]
    ds_read_b128 a[132:135], v28 offset:4096
    v_lshlrev_b32 v232, 11, v232
    v_add_u32 v232, v232, v3
    s_waitcnt lgkmcnt(8)
    v_mfma_f32_32x32x16_bf16 v[96:111], a[248:251], a[184:187], v[96:111]
    ds_read_b64_tr_b16 a[204:205], v27 offset:33280
    ds_read_b64_tr_b16 a[206:207], v27 offset:34320
    ds_read_b128 a[136:139], v29 offset:0
    v_mfma_f32_32x32x16_bf16 v[160:175], a[248:251], a[188:191], v[160:175]
    ds_read_b128 a[140:143], v29 offset:4096
    v_mfma_f32_32x32x16_bf16 v[112:127], a[252:255], a[184:187], v[112:127]
    ds_read_b64_tr_b16 a[208:209], v24 offset:37440
    ds_read_b64_tr_b16 a[210:211], v24 offset:38480
    v_mfma_f32_32x32x16_bf16 v[176:191], a[252:255], a[188:191], v[176:191]
    s_waitcnt lgkmcnt(7)
    v_mfma_f32_32x32x16_bf16 v[64:79], a[192:195], a[128:131], v[64:79]
    ds_read_b64_tr_b16 a[212:213], v25 offset:37440
    ds_read_b64_tr_b16 a[214:215], v25 offset:38480
    ds_read_b128 a[144:147], v30 offset:0
    s_waitcnt lgkmcnt(9)
    v_mfma_f32_32x32x16_bf16 v[128:143], a[192:195], a[132:135], v[128:143]
    ds_read_b128 a[148:151], v30 offset:4096
    v_mfma_f32_32x32x16_bf16 v[80:95], a[196:199], a[128:131], v[80:95]
    ds_read_b64_tr_b16 a[216:217], v26 offset:37440
    ds_read_b64_tr_b16 a[218:219], v26 offset:38480
    ds_read_b128 a[152:155], v31 offset:0
    v_mfma_f32_32x32x16_bf16 v[144:159], a[196:199], a[132:135], v[144:159]
    ds_read_b128 a[156:159], v31 offset:4096
    v_mfma_f32_32x32x16_bf16 v[96:111], a[200:203], a[128:131], v[96:111]
    ds_read_b64_tr_b16 a[220:221], v27 offset:37440
    s_waitcnt lgkmcnt(14)
    ds_read_b64_tr_b16 a[222:223], v27 offset:38480
    s_lshl_b32 s38, s37, 7
    s_add_u32 s39, s38, 32768
    s_lshl_b32 s40, s37, 19
    v_mfma_f32_32x32x16_bf16 v[160:175], a[200:203], a[132:135], v[160:175]
    s_add_u32 s40, s40, s45
    s_add_u32 s37, s37, 1
    s_and_b32 s37, s37, 7
    s_waitcnt lgkmcnt(11)
    v_mfma_f32_32x32x16_bf16 v[112:127], a[204:207], a[128:131], v[112:127]
    ds_read_b64_tr_b16 a[224:225], v24 offset:41600
    ds_read_b64_tr_b16 a[226:227], v24 offset:42640
    s_waitcnt lgkmcnt(4)
    s_add_u32 m0, s41, 0
    s_nop 0
    buffer_load_dwordx4 v32, s[8:11], s38 offen offset:0 lds
    v_mfma_f32_32x32x16_bf16 v[176:191], a[204:207], a[132:135], v[176:191]
    buffer_load_dwordx4 v33, s[8:11], s38 offen offset:1024 lds
    v_mfma_f32_32x32x16_bf16 v[64:79], a[208:211], a[136:139], v[64:79]
    ds_read_b64_tr_b16 a[228:229], v25 offset:41600
    ds_read_b64_tr_b16 a[230:231], v25 offset:42640
    buffer_load_dwordx4 v34, s[8:11], s38 offen offset:2048 lds
    v_mfma_f32_32x32x16_bf16 v[128:143], a[208:211], a[140:143], v[128:143]
    buffer_load_dwordx4 v35, s[8:11], s38 offen offset:3072 lds
    v_mfma_f32_32x32x16_bf16 v[80:95], a[212:215], a[136:139], v[80:95]
    ds_read_b64_tr_b16 a[232:233], v26 offset:41600
    ds_read_b64_tr_b16 a[234:235], v26 offset:42640
    s_add_u32 m0, s41, 4096
    s_nop 0
    buffer_load_dwordx4 v32, s[8:11], s39 offen offset:0 lds
    v_mfma_f32_32x32x16_bf16 v[144:159], a[212:215], a[140:143], v[144:159]
    buffer_load_dwordx4 v33, s[8:11], s39 offen offset:1024 lds
    v_mfma_f32_32x32x16_bf16 v[96:111], a[216:219], a[136:139], v[96:111]
    ds_read_b64_tr_b16 a[236:237], v27 offset:41600
    ds_read_b64_tr_b16 a[238:239], v27 offset:42640
    buffer_load_dwordx4 v34, s[8:11], s39 offen offset:2048 lds
    v_mfma_f32_32x32x16_bf16 v[160:175], a[216:219], a[140:143], v[160:175]
    buffer_load_dwordx4 v35, s[8:11], s39 offen offset:3072 lds
    s_waitcnt lgkmcnt(7)
    v_mfma_f32_32x32x16_bf16 v[112:127], a[220:223], a[136:139], v[112:127]
    ds_read_b64_tr_b16 a[240:241], v24 offset:45760
    ds_read_b64_tr_b16 a[242:243], v24 offset:46800
    s_add_u32 m0, s33, 16640
    s_nop 0
    buffer_load_dwordx4 v36, s[12:15], s40 offen offset:0 lds
    v_mfma_f32_32x32x16_bf16 v[176:191], a[220:223], a[140:143], v[176:191]
    buffer_load_dwordx4 v37, s[12:15], s40 offen offset:1040 lds
    s_waitcnt lgkmcnt(7)
    v_mfma_f32_32x32x16_bf16 v[64:79], a[224:227], a[144:147], v[64:79]
    ds_read_b64_tr_b16 a[244:245], v25 offset:45760
    ds_read_b64_tr_b16 a[246:247], v25 offset:46800
    buffer_load_dwordx4 v38, s[12:15], s40 offen offset:2080 lds
    v_mfma_f32_32x32x16_bf16 v[128:143], a[224:227], a[148:151], v[128:143]
    buffer_load_dwordx4 v39, s[12:15], s40 offen offset:3120 lds
    s_waitcnt lgkmcnt(7)
    v_mfma_f32_32x32x16_bf16 v[80:95], a[228:231], a[144:147], v[80:95]
    ds_read_b64_tr_b16 a[248:249], v26 offset:45760
    ds_read_b64_tr_b16 a[250:251], v26 offset:46800
    s_add_u32 s42, s44, 0
    s_add_u32 m0, s33, 0
    s_nop 0
    buffer_load_dwordx4 v40, s[16:19], s42 offen offset:0 lds
    v_mfma_f32_32x32x16_bf16 v[144:159], a[228:231], a[148:151], v[144:159]
    buffer_load_dwordx4 v41, s[16:19], s42 offen offset:1040 lds
    s_waitcnt lgkmcnt(6)
    v_mfma_f32_32x32x16_bf16 v[96:111], a[232:235], a[144:147], v[96:111]
    ds_read_b64_tr_b16 a[252:253], v27 offset:45760
    ds_read_b64_tr_b16 a[254:255], v27 offset:46800
    buffer_load_dwordx4 v42, s[16:19], s42 offen offset:2080 lds
    v_mfma_f32_32x32x16_bf16 v[160:175], a[232:235], a[148:151], v[160:175]
    buffer_load_dwordx4 v43, s[16:19], s42 offen offset:3120 lds
    v_mfma_f32_32x32x16_bf16 v[112:127], a[236:239], a[144:147], v[112:127]
    s_waitcnt vmcnt(19)
    s_waitcnt vmcnt(16)
    s_barrier
    ds_read_b64_tr_b16 a[192:193], v24 offset:49920
    ds_read_b64_tr_b16 a[194:195], v24 offset:50960
    v_mfma_f32_32x32x16_bf16 v[176:191], a[236:239], a[148:151], v[176:191]
    s_waitcnt lgkmcnt(8)
    v_mfma_f32_32x32x16_bf16 v[64:79], a[240:243], a[152:155], v[64:79]
    ds_read_b64_tr_b16 a[196:197], v25 offset:49920
    ds_read_b64_tr_b16 a[198:199], v25 offset:50960
    v_mfma_f32_32x32x16_bf16 v[128:143], a[240:243], a[156:159], v[128:143]
    s_waitcnt lgkmcnt(8)
    v_mfma_f32_32x32x16_bf16 v[80:95], a[244:247], a[152:155], v[80:95]
    ds_read_b64_tr_b16 a[200:201], v26 offset:49920
    ds_read_b64_tr_b16 a[202:203], v26 offset:50960
    ds_read_b128 a[160:163], v28 offset:32768
    v_mfma_f32_32x32x16_bf16 v[144:159], a[244:247], a[156:159], v[144:159]
    ds_read_b128 a[164:167], v28 offset:36864
    s_waitcnt lgkmcnt(10)
    v_mfma_f32_32x32x16_bf16 v[96:111], a[248:251], a[152:155], v[96:111]
    ds_read_b64_tr_b16 a[204:205], v27 offset:49920
    ds_read_b64_tr_b16 a[206:207], v27 offset:50960
    ds_read_b128 a[168:171], v29 offset:32768
    v_mfma_f32_32x32x16_bf16 v[160:175], a[248:251], a[156:159], v[160:175]
    ds_read_b128 a[172:175], v29 offset:36864
    s_waitcnt lgkmcnt(12)
    v_mfma_f32_32x32x16_bf16 v[112:127], a[252:255], a[152:155], v[112:127]
    ds_read_b64_tr_b16 a[208:209], v24 offset:54080
    ds_read_b64_tr_b16 a[210:211], v24 offset:55120
    v_mfma_f32_32x32x16_bf16 v[176:191], a[252:255], a[156:159], v[176:191]
    s_and_b32 s62, s2, 3
    s_lshl_b32 s62, s62, 3
    s_lshl_b32 s62, 1, s62
    v_mov_b32 v5, s62
    s_and_b32 s62, s2, 0xfc
    buffer_atomic_or v5, v49, s[72:75], s62 offen
    s_waitcnt lgkmcnt(7)
    v_mfma_f32_32x32x16_bf16 v[64:79], a[192:195], a[160:163], v[64:79]
    ds_read_b64_tr_b16 a[212:213], v25 offset:54080
    ds_read_b64_tr_b16 a[214:215], v25 offset:55120
    ds_read_b128 a[176:179], v30 offset:32768
    s_waitcnt lgkmcnt(9)
    v_mfma_f32_32x32x16_bf16 v[128:143], a[192:195], a[164:167], v[128:143]
    ds_read_b128 a[180:183], v30 offset:36864
    v_mfma_f32_32x32x16_bf16 v[80:95], a[196:199], a[160:163], v[80:95]
    ds_read_b64_tr_b16 a[216:217], v26 offset:54080
    ds_read_b64_tr_b16 a[218:219], v26 offset:55120
    ds_read_b128 a[184:187], v31 offset:32768
    v_mfma_f32_32x32x16_bf16 v[144:159], a[196:199], a[164:167], v[144:159]
    ds_read_b128 a[188:191], v31 offset:36864
    v_mfma_f32_32x32x16_bf16 v[96:111], a[200:203], a[160:163], v[96:111]
    ds_read_b64_tr_b16 a[220:221], v27 offset:54080
    s_waitcnt lgkmcnt(14)
    ds_read_b64_tr_b16 a[222:223], v27 offset:55120
    s_lshl_b32 s38, s37, 7
    s_add_u32 s39, s38, 32768
    s_lshl_b32 s40, s37, 19
    v_mfma_f32_32x32x16_bf16 v[160:175], a[200:203], a[164:167], v[160:175]
    s_add_u32 s40, s40, s45
    s_add_u32 s37, s37, 1
    s_and_b32 s37, s37, 7
    s_waitcnt lgkmcnt(10)
    v_mfma_f32_32x32x16_bf16 v[112:127], a[204:207], a[160:163], v[112:127]
    ds_read_b64_tr_b16 a[224:225], v24 offset:58240
    ds_read_b64_tr_b16 a[226:227], v24 offset:59280
    s_waitcnt lgkmcnt(4)
    s_add_u32 m0, s41, 32768
    s_nop 0
    buffer_load_dwordx4 v32, s[8:11], s38 offen offset:0 lds
    v_mfma_f32_32x32x16_bf16 v[176:191], a[204:207], a[164:167], v[176:191]
    buffer_load_dwordx4 v33, s[8:11], s38 offen offset:1024 lds
    v_mfma_f32_32x32x16_bf16 v[64:79], a[208:211], a[168:171], v[64:79]
    ds_read_b64_tr_b16 a[228:229], v25 offset:58240
    ds_read_b64_tr_b16 a[230:231], v25 offset:59280
    buffer_load_dwordx4 v34, s[8:11], s38 offen offset:2048 lds
    v_mfma_f32_32x32x16_bf16 v[128:143], a[208:211], a[172:175], v[128:143]
    buffer_load_dwordx4 v35, s[8:11], s38 offen offset:3072 lds
    v_mfma_f32_32x32x16_bf16 v[80:95], a[212:215], a[168:171], v[80:95]
    ds_read_b64_tr_b16 a[232:233], v26 offset:58240
    ds_read_b64_tr_b16 a[234:235], v26 offset:59280
    s_add_u32 m0, s41, 36864
    s_nop 0
    buffer_load_dwordx4 v32, s[8:11], s39 offen offset:0 lds
    v_mfma_f32_32x32x16_bf16 v[144:159], a[212:215], a[172:175], v[144:159]
    buffer_load_dwordx4 v33, s[8:11], s39 offen offset:1024 lds
    v_mfma_f32_32x32x16_bf16 v[96:111], a[216:219], a[168:171], v[96:111]
    ds_read_b64_tr_b16 a[236:237], v27 offset:58240
    ds_read_b64_tr_b16 a[238:239], v27 offset:59280
    buffer_load_dwordx4 v34, s[8:11], s39 offen offset:2048 lds
    v_mfma_f32_32x32x16_bf16 v[160:175], a[216:219], a[172:175], v[160:175]
    buffer_load_dwordx4 v35, s[8:11], s39 offen offset:3072 lds
    s_waitcnt lgkmcnt(7)
    v_mfma_f32_32x32x16_bf16 v[112:127], a[220:223], a[168:171], v[112:127]
    ds_read_b64_tr_b16 a[240:241], v24 offset:62400
    ds_read_b64_tr_b16 a[242:243], v24 offset:63440
    s_add_u32 m0, s33, 33280
    s_nop 0
    buffer_load_dwordx4 v36, s[12:15], s40 offen offset:0 lds
    v_mfma_f32_32x32x16_bf16 v[176:191], a[220:223], a[172:175], v[176:191]
    buffer_load_dwordx4 v37, s[12:15], s40 offen offset:1040 lds
    s_waitcnt lgkmcnt(7)
    v_mfma_f32_32x32x16_bf16 v[64:79], a[224:227], a[176:179], v[64:79]
    ds_read_b64_tr_b16 a[244:245], v25 offset:62400
    ds_read_b64_tr_b16 a[246:247], v25 offset:63440
    buffer_load_dwordx4 v38, s[12:15], s40 offen offset:2080 lds
    v_mfma_f32_32x32x16_bf16 v[128:143], a[224:227], a[180:183], v[128:143]
    buffer_load_dwordx4 v39, s[12:15], s40 offen offset:3120 lds
    s_waitcnt lgkmcnt(7)
    v_mfma_f32_32x32x16_bf16 v[80:95], a[228:231], a[176:179], v[80:95]
    ds_read_b64_tr_b16 a[248:249], v26 offset:62400
    ds_read_b64_tr_b16 a[250:251], v26 offset:63440
    v_mfma_f32_32x32x16_bf16 v[144:159], a[228:231], a[180:183], v[144:159]
    s_waitcnt lgkmcnt(8)
    v_mfma_f32_32x32x16_bf16 v[96:111], a[232:235], a[176:179], v[96:111]
    ds_read_b64_tr_b16 a[252:253], v27 offset:62400
    ds_read_b64_tr_b16 a[254:255], v27 offset:63440
    v_mfma_f32_32x32x16_bf16 v[160:175], a[232:235], a[180:183], v[160:175]
    s_waitcnt lgkmcnt(8)
    v_mfma_f32_32x32x16_bf16 v[112:127], a[236:239], a[176:179], v[112:127]
    s_waitcnt vmcnt(17)
    s_barrier
    ds_read_b64_tr_b16 a[192:193], v24 offset:0
    ds_read_b64_tr_b16 a[194:195], v24 offset:1040
    v_mfma_f32_32x32x16_bf16 v[176:191], a[236:239], a[180:183], v[176:191]
    s_waitcnt lgkmcnt(8)
    v_mfma_f32_32x32x16_bf16 v[64:79], a[240:243], a[184:187], v[64:79]
    ds_read_b64_tr_b16 a[196:197], v25 offset:0
    ds_read_b64_tr_b16 a[198:199], v25 offset:1040
    v_mfma_f32_32x32x16_bf16 v[128:143], a[240:243], a[188:191], v[128:143]
    s_waitcnt lgkmcnt(8)
    v_mfma_f32_32x32x16_bf16 v[80:95], a[244:247], a[184:187], v[80:95]
    ds_read_b64_tr_b16 a[200:201], v26 offset:0
    ds_read_b64_tr_b16 a[202:203], v26 offset:1040
    ds_read_b128 a[128:131], v28 offset:0
    v_mfma_f32_32x32x16_bf16 v[144:159], a[244:247], a[188:191], v[144:159]
    ds_read_b128 a[132:135], v28 offset:4096
    s_waitcnt lgkmcnt(10)
    v_mfma_f32_32x32x16_bf16 v[96:111], a[248:251], a[184:187], v[96:111]
    ds_read_b64_tr_b16 a[204:205], v27 offset:0
    ds_read_b64_tr_b16 a[206:207], v27 offset:1040
    ds_read_b128 a[136:139], v29 offset:0
    v_mfma_f32_32x32x16_bf16 v[160:175], a[248:251], a[188:191], v[160:175]
    ds_read_b128 a[140:143], v29 offset:4096
    s_waitcnt lgkmcnt(12)
    v_mfma_f32_32x32x16_bf16 v[112:127], a[252:255], a[184:187], v[112:127]
    ds_read_b64_tr_b16 a[208:209], v24 offset:4160
    ds_read_b64_tr_b16 a[210:211], v24 offset:5200
    v_mfma_f32_32x32x16_bf16 v[176:191], a[252:255], a[188:191], v[176:191]
    s_waitcnt lgkmcnt(7)
    v_mfma_f32_32x32x16_bf16 v[64:79], a[192:195], a[128:131], v[64:79]
    ds_read_b64_tr_b16 a[212:213], v25 offset:4160
    ds_read_b64_tr_b16 a[214:215], v25 offset:5200
    ds_read_b128 a[144:147], v30 offset:0
    s_waitcnt lgkmcnt(9)
    v_mfma_f32_32x32x16_bf16 v[128:143], a[192:195], a[132:135], v[128:143]
    ds_read_b128 a[148:151], v30 offset:4096
    v_mfma_f32_32x32x16_bf16 v[80:95], a[196:199], a[128:131], v[80:95]
    ds_read_b64_tr_b16 a[216:217], v26 offset:4160
    ds_read_b64_tr_b16 a[218:219], v26 offset:5200
    ds_read_b128 a[152:155], v31 offset:0
    v_mfma_f32_32x32x16_bf16 v[144:159], a[196:199], a[132:135], v[144:159]
    ds_read_b128 a[156:159], v31 offset:4096
    v_mfma_f32_32x32x16_bf16 v[96:111], a[200:203], a[128:131], v[96:111]
    ds_read_b64_tr_b16 a[220:221], v27 offset:4160
    s_waitcnt lgkmcnt(14)
    ds_read_b64_tr_b16 a[222:223], v27 offset:5200
    s_lshl_b32 s38, s37, 7
    s_add_u32 s39, s38, 32768
    s_lshl_b32 s40, s37, 19
    v_mfma_f32_32x32x16_bf16 v[160:175], a[200:203], a[132:135], v[160:175]
    s_add_u32 s40, s40, s45
    s_add_u32 s37, s37, 1
    s_and_b32 s37, s37, 7
    s_waitcnt lgkmcnt(11)
    v_mfma_f32_32x32x16_bf16 v[112:127], a[204:207], a[128:131], v[112:127]
    ds_read_b64_tr_b16 a[224:225], v24 offset:8320
    ds_read_b64_tr_b16 a[226:227], v24 offset:9360
    s_waitcnt lgkmcnt(4)
    s_add_u32 m0, s41, 0
    s_nop 0
    buffer_load_dwordx4 v32, s[8:11], s38 offen offset:0 lds
    v_mfma_f32_32x32x16_bf16 v[176:191], a[204:207], a[132:135], v[176:191]
    buffer_load_dwordx4 v33, s[8:11], s38 offen offset:1024 lds
    v_mfma_f32_32x32x16_bf16 v[64:79], a[208:211], a[136:139], v[64:79]
    ds_read_b64_tr_b16 a[228:229], v25 offset:8320
    ds_read_b64_tr_b16 a[230:231], v25 offset:9360
    buffer_load_dwordx4 v34, s[8:11], s38 offen offset:2048 lds
    v_mfma_f32_32x32x16_bf16 v[128:143], a[208:211], a[140:143], v[128:143]
    buffer_load_dwordx4 v35, s[8:11], s38 offen offset:3072 lds
    v_mfma_f32_32x32x16_bf16 v[80:95], a[212:215], a[136:139], v[80:95]
    ds_read_b64_tr_b16 a[232:233], v26 offset:8320
    ds_read_b64_tr_b16 a[234:235], v26 offset:9360
    s_add_u32 m0, s41, 4096
    s_nop 0
    buffer_load_dwordx4 v32, s[8:11], s39 offen offset:0 lds
    v_mfma_f32_32x32x16_bf16 v[144:159], a[212:215], a[140:143], v[144:159]
    buffer_load_dwordx4 v33, s[8:11], s39 offen offset:1024 lds
    v_mfma_f32_32x32x16_bf16 v[96:111], a[216:219], a[136:139], v[96:111]
    ds_read_b64_tr_b16 a[236:237], v27 offset:8320
    ds_read_b64_tr_b16 a[238:239], v27 offset:9360
    buffer_load_dwordx4 v34, s[8:11], s39 offen offset:2048 lds
    v_mfma_f32_32x32x16_bf16 v[160:175], a[216:219], a[140:143], v[160:175]
    buffer_load_dwordx4 v35, s[8:11], s39 offen offset:3072 lds
    s_waitcnt lgkmcnt(7)
    v_mfma_f32_32x32x16_bf16 v[112:127], a[220:223], a[136:139], v[112:127]
    ds_read_b64_tr_b16 a[240:241], v24 offset:12480
    ds_read_b64_tr_b16 a[242:243], v24 offset:13520
    s_add_u32 m0, s33, 49920
    s_nop 0
    buffer_load_dwordx4 v36, s[12:15], s40 offen offset:0 lds
    v_mfma_f32_32x32x16_bf16 v[176:191], a[220:223], a[140:143], v[176:191]
    buffer_load_dwordx4 v37, s[12:15], s40 offen offset:1040 lds
    s_waitcnt lgkmcnt(7)
    v_mfma_f32_32x32x16_bf16 v[64:79], a[224:227], a[144:147], v[64:79]
    ds_read_b64_tr_b16 a[244:245], v25 offset:12480
    ds_read_b64_tr_b16 a[246:247], v25 offset:13520
    buffer_load_dwordx4 v38, s[12:15], s40 offen offset:2080 lds
    v_mfma_f32_32x32x16_bf16 v[128:143], a[224:227], a[148:151], v[128:143]
    buffer_load_dwordx4 v39, s[12:15], s40 offen offset:3120 lds
    s_waitcnt lgkmcnt(7)
    v_mfma_f32_32x32x16_bf16 v[80:95], a[228:231], a[144:147], v[80:95]
    ds_read_b64_tr_b16 a[248:249], v26 offset:12480
    ds_read_b64_tr_b16 a[250:251], v26 offset:13520
    v_mfma_f32_32x32x16_bf16 v[144:159], a[228:231], a[148:151], v[144:159]
    s_waitcnt lgkmcnt(8)
    v_mfma_f32_32x32x16_bf16 v[96:111], a[232:235], a[144:147], v[96:111]
    ds_read_b64_tr_b16 a[252:253], v27 offset:12480
    ds_read_b64_tr_b16 a[254:255], v27 offset:13520
    v_mfma_f32_32x32x16_bf16 v[160:175], a[232:235], a[148:151], v[160:175]
    s_waitcnt lgkmcnt(8)
    v_mfma_f32_32x32x16_bf16 v[112:127], a[236:239], a[144:147], v[112:127]
    s_waitcnt vmcnt(12)
    s_barrier
    ds_read_b64_tr_b16 a[192:193], v24 offset:16640
    ds_read_b64_tr_b16 a[194:195], v24 offset:17680
    v_mfma_f32_32x32x16_bf16 v[176:191], a[236:239], a[148:151], v[176:191]
    s_waitcnt lgkmcnt(8)
    v_mfma_f32_32x32x16_bf16 v[64:79], a[240:243], a[152:155], v[64:79]
    ds_read_b64_tr_b16 a[196:197], v25 offset:16640
    ds_read_b64_tr_b16 a[198:199], v25 offset:17680
    buffer_load_dword v5, v50, s[72:75], 0 offen sc1
    v_mfma_f32_32x32x16_bf16 v[128:143], a[240:243], a[156:159], v[128:143]
    s_waitcnt lgkmcnt(8)
    v_mfma_f32_32x32x16_bf16 v[80:95], a[244:247], a[152:155], v[80:95]
    ds_read_b64_tr_b16 a[200:201], v26 offset:16640
    ds_read_b64_tr_b16 a[202:203], v26 offset:17680
    ds_read_b128 a[160:163], v28 offset:32768
    v_mfma_f32_32x32x16_bf16 v[144:159], a[244:247], a[156:159], v[144:159]
    ds_read_b128 a[164:167], v28 offset:36864
    s_waitcnt lgkmcnt(10)
    v_mfma_f32_32x32x16_bf16 v[96:111], a[248:251], a[152:155], v[96:111]
    ds_read_b64_tr_b16 a[204:205], v27 offset:16640
    ds_read_b64_tr_b16 a[206:207], v27 offset:17680
    ds_read_b128 a[168:171], v29 offset:32768
    v_mfma_f32_32x32x16_bf16 v[160:175], a[248:251], a[156:159], v[160:175]
    ds_read_b128 a[172:175], v29 offset:36864
    s_waitcnt lgkmcnt(12)
    v_mfma_f32_32x32x16_bf16 v[112:127], a[252:255], a[152:155], v[112:127]
    ds_read_b64_tr_b16 a[208:209], v24 offset:20800
    ds_read_b64_tr_b16 a[210:211], v24 offset:21840
    v_mfma_f32_32x32x16_bf16 v[176:191], a[252:255], a[156:159], v[176:191]
    s_waitcnt lgkmcnt(7)
    v_mfma_f32_32x32x16_bf16 v[64:79], a[192:195], a[160:163], v[64:79]
    ds_read_b64_tr_b16 a[212:213], v25 offset:20800
    ds_read_b64_tr_b16 a[214:215], v25 offset:21840
    ds_read_b128 a[176:179], v30 offset:32768
    s_waitcnt lgkmcnt(9)
    v_mfma_f32_32x32x16_bf16 v[128:143], a[192:195], a[164:167], v[128:143]
    ds_read_b128 a[180:183], v30 offset:36864
    v_mfma_f32_32x32x16_bf16 v[80:95], a[196:199], a[160:163], v[80:95]
    ds_read_b64_tr_b16 a[216:217], v26 offset:20800
    ds_read_b64_tr_b16 a[218:219], v26 offset:21840
    ds_read_b128 a[184:187], v31 offset:32768
    v_mfma_f32_32x32x16_bf16 v[144:159], a[196:199], a[164:167], v[144:159]
    ds_read_b128 a[188:191], v31 offset:36864
    v_mfma_f32_32x32x16_bf16 v[96:111], a[200:203], a[160:163], v[96:111]
    ds_read_b64_tr_b16 a[220:221], v27 offset:20800
    s_waitcnt lgkmcnt(14)
    ds_read_b64_tr_b16 a[222:223], v27 offset:21840
    s_lshl_b32 s38, s37, 7
    s_add_u32 s39, s38, 32768
    s_lshl_b32 s40, s37, 19
    v_mfma_f32_32x32x16_bf16 v[160:175], a[200:203], a[164:167], v[160:175]
    s_add_u32 s40, s40, s45
    s_add_u32 s37, s37, 1
    s_and_b32 s37, s37, 7
    s_waitcnt lgkmcnt(11)
    v_mfma_f32_32x32x16_bf16 v[112:127], a[204:207], a[160:163], v[112:127]
    ds_read_b64_tr_b16 a[224:225], v24 offset:24960
    ds_read_b64_tr_b16 a[226:227], v24 offset:26000
    s_waitcnt lgkmcnt(4)
    s_add_u32 m0, s41, 32768
    s_nop 0
    buffer_load_dwordx4 v32, s[8:11], s38 offen offset:0 lds
    v_mfma_f32_32x32x16_bf16 v[176:191], a[204:207], a[164:167], v[176:191]
    buffer_load_dwordx4 v33, s[8:11], s38 offen offset:1024 lds
    v_mfma_f32_32x32x16_bf16 v[64:79], a[208:211], a[168:171], v[64:79]
    ds_read_b64_tr_b16 a[228:229], v25 offset:24960
    ds_read_b64_tr_b16 a[230:231], v25 offset:26000
    buffer_load_dwordx4 v34, s[8:11], s38 offen offset:2048 lds
    v_mfma_f32_32x32x16_bf16 v[128:143], a[208:211], a[172:175], v[128:143]
    buffer_load_dwordx4 v35, s[8:11], s38 offen offset:3072 lds
    v_mfma_f32_32x32x16_bf16 v[80:95], a[212:215], a[168:171], v[80:95]
    ds_read_b64_tr_b16 a[232:233], v26 offset:24960
    ds_read_b64_tr_b16 a[234:235], v26 offset:26000
    s_add_u32 m0, s41, 36864
    s_nop 0
    buffer_load_dwordx4 v32, s[8:11], s39 offen offset:0 lds
    v_mfma_f32_32x32x16_bf16 v[144:159], a[212:215], a[172:175], v[144:159]
    buffer_load_dwordx4 v33, s[8:11], s39 offen offset:1024 lds
    v_mfma_f32_32x32x16_bf16 v[96:111], a[216:219], a[168:171], v[96:111]
    ds_read_b64_tr_b16 a[236:237], v27 offset:24960
    ds_read_b64_tr_b16 a[238:239], v27 offset:26000
    buffer_load_dwordx4 v34, s[8:11], s39 offen offset:2048 lds
    v_mfma_f32_32x32x16_bf16 v[160:175], a[216:219], a[172:175], v[160:175]
    buffer_load_dwordx4 v35, s[8:11], s39 offen offset:3072 lds
    s_waitcnt lgkmcnt(7)
    v_mfma_f32_32x32x16_bf16 v[112:127], a[220:223], a[168:171], v[112:127]
    ds_read_b64_tr_b16 a[240:241], v24 offset:29120
    ds_read_b64_tr_b16 a[242:243], v24 offset:30160
    s_add_u32 m0, s33, 66560
    s_nop 0
    buffer_load_dwordx4 v36, s[12:15], s40 offen offset:0 lds
    v_mfma_f32_32x32x16_bf16 v[176:191], a[220:223], a[172:175], v[176:191]
    buffer_load_dwordx4 v37, s[12:15], s40 offen offset:1040 lds
    s_waitcnt lgkmcnt(7)
    v_mfma_f32_32x32x16_bf16 v[64:79], a[224:227], a[176:179], v[64:79]
    ds_read_b64_tr_b16 a[244:245], v25 offset:29120
    ds_read_b64_tr_b16 a[246:247], v25 offset:30160
    buffer_load_dwordx4 v38, s[12:15], s40 offen offset:2080 lds
    v_mfma_f32_32x32x16_bf16 v[128:143], a[224:227], a[180:183], v[128:143]
    buffer_load_dwordx4 v39, s[12:15], s40 offen offset:3120 lds
    s_waitcnt lgkmcnt(7)
    v_mfma_f32_32x32x16_bf16 v[80:95], a[228:231], a[176:179], v[80:95]
    ds_read_b64_tr_b16 a[248:249], v26 offset:29120
    ds_read_b64_tr_b16 a[250:251], v26 offset:30160
    v_mfma_f32_32x32x16_bf16 v[144:159], a[228:231], a[180:183], v[144:159]
    s_waitcnt lgkmcnt(8)
    v_mfma_f32_32x32x16_bf16 v[96:111], a[232:235], a[176:179], v[96:111]
    ds_read_b64_tr_b16 a[252:253], v27 offset:29120
    ds_read_b64_tr_b16 a[254:255], v27 offset:30160
    v_mfma_f32_32x32x16_bf16 v[160:175], a[232:235], a[180:183], v[160:175]
    s_waitcnt lgkmcnt(8)
    v_mfma_f32_32x32x16_bf16 v[112:127], a[236:239], a[176:179], v[112:127]
    s_waitcnt vmcnt(12)
    v_and_b32 v5, s49, v5
    v_cmp_ne_u32 vcc, s49, v5
    s_cbranch_vccnz L_spin0
L_ok0:
    s_barrier
    buffer_load_dwordx2 v[50:51], v1, s[28:31], 0 offen offset:0 sc1
    buffer_load_dwordx2 v[52:53], v1, s[28:31], 0 offen offset:256 sc1
    buffer_load_dword v224, v232, s[28:31], s63 offen offset:0 sc1
    buffer_load_dword v225, v232, s[28:31], s63 offen offset:512 sc1
    buffer_load_dword v226, v232, s[28:31], s63 offen offset:1024 sc1
    buffer_load_dword v227, v232, s[28:31], s63 offen offset:1536 sc1
    ds_read_b64_tr_b16 a[192:193], v24 offset:33280
    ds_read_b64_tr_b16 a[194:195], v24 offset:34320
    v_mfma_f32_32x32x16_bf16 v[176:191], a[236:239], a[180:183], v[176:191]
    s_waitcnt lgkmcnt(6)
    v_mfma_f32_32x32x16_bf16 v[64:79], a[240:243], a[184:187], v[64:79]
    ds_read_b64_tr_b16 a[196:197], v25 offset:33280
    ds_read_b64_tr_b16 a[198:199], v25 offset:34320
    v_mfma_f32_32x32x16_bf16 v[128:143], a[240:243], a[188:191], v[128:143]
    v_mfma_f32_32x32x16_bf16 v[80:95], a[244:247], a[184:187], v[80:95]
    ds_read_b64_tr_b16 a[200:201], v26 offset:33280
    ds_read_b64_tr_b16 a[202:203], v26 offset:34320
    ds_read_b128 a[128:131], v28 offset:0
    v_mfma_f32_32x32x16_bf16 v[144:159], a[244:247], a[188:191], v[144:159]
    ds_read_b128 a[132:135], v28 offset:4096
    s_waitcnt lgkmcnt(8)
    v_mfma_f32_32x32x16_bf16 v[96:111], a[248:251], a[184:187], v[96:111]
    ds_read_b64_tr_b16 a[204:205], v27 offset:33280
    ds_read_b64_tr_b16 a[206:207], v27 offset:34320
    ds_read_b128 a[136:139], v29 offset:0
    v_mfma_f32_32x32x16_bf16 v[160:175], a[248:251], a[188:191], v[160:175]
    ds_read_b128 a[140:143], v29 offset:4096
    v_mfma_f32_32x32x16_bf16 v[112:127], a[252:255], a[184:187], v[112:127]
    ds_read_b64_tr_b16 a[208:209], v24 offset:37440
    ds_read_b64_tr_b16 a[210:211], v24 offset:38480
    v_mfma_f32_32x32x16_bf16 v[176:191], a[252:255], a[188:191], v[176:191]
    s_waitcnt lgkmcnt(7)
    v_mfma_f32_32x32x16_bf16 v[64:79], a[192:195], a[128:131], v[64:79]
    ds_read_b64_tr_b16 a[212:213], v25 offset:37440
    ds_read_b64_tr_b16 a[214:215], v25 offset:38480
    ds_read_b128 a[144:147], v30 offset:0
    s_waitcnt lgkmcnt(9)
    v_mfma_f32_32x32x16_bf16 v[128:143], a[192:195], a[132:135], v[128:143]
    ds_read_b128 a[148:151], v30 offset:4096
    v_mfma_f32_32x32x16_bf16 v[80:95], a[196:199], a[128:131], v[80:95]
    ds_read_b64_tr_b16 a[216:217], v26 offset:37440
    ds_read_b64_tr_b16 a[218:219], v26 offset:38480
    ds_read_b128 a[152:155], v31 offset:0
    v_mfma_f32_32x32x16_bf16 v[144:159], a[196:199], a[132:135], v[144:159]
    ds_read_b128 a[156:159], v31 offset:4096
    v_mfma_f32_32x32x16_bf16 v[96:111], a[200:203], a[128:131], v[96:111]
    ds_read_b64_tr_b16 a[220:221], v27 offset:37440
    s_waitcnt lgkmcnt(14)
    ds_read_b64_tr_b16 a[222:223], v27 offset:38480
    v_mfma_f32_32x32x16_bf16 v[160:175], a[200:203], a[132:135], v[160:175]
    s_waitcnt lgkmcnt(14)
    v_mfma_f32_32x32x16_bf16 v[112:127], a[204:207], a[128:131], v[112:127]
    ds_read_b64_tr_b16 a[224:225], v24 offset:41600
    s_waitcnt lgkmcnt(14)
    ds_read_b64_tr_b16 a[226:227], v24 offset:42640
    v_mfma_f32_32x32x16_bf16 v[176:191], a[204:207], a[132:135], v[176:191]
    s_waitcnt lgkmcnt(12)
    v_mfma_f32_32x32x16_bf16 v[64:79], a[208:211], a[136:139], v[64:79]
    ds_read_b64_tr_b16 a[228:229], v25 offset:41600
    ds_read_b64_tr_b16 a[230:231], v25 offset:42640
    v_mfma_f32_32x32x16_bf16 v[128:143], a[208:211], a[140:143], v[128:143]
    s_waitcnt lgkmcnt(12)
    v_mfma_f32_32x32x16_bf16 v[80:95], a[212:215], a[136:139], v[80:95]
    ds_read_b64_tr_b16 a[232:233], v26 offset:41600
    ds_read_b64_tr_b16 a[234:235], v26 offset:42640
    v_mfma_f32_32x32x16_bf16 v[144:159], a[212:215], a[140:143], v[144:159]
    s_waitcnt lgkmcnt(10)
    v_mfma_f32_32x32x16_bf16 v[96:111], a[216:219], a[136:139], v[96:111]
    ds_read_b64_tr_b16 a[236:237], v27 offset:41600
    ds_read_b64_tr_b16 a[238:239], v27 offset:42640
    v_mfma_f32_32x32x16_bf16 v[160:175], a[216:219], a[140:143], v[160:175]
    s_waitcnt lgkmcnt(8)
    v_mfma_f32_32x32x16_bf16 v[112:127], a[220:223], a[136:139], v[112:127]
    ds_read_b64_tr_b16 a[240:241], v24 offset:45760
    ds_read_b64_tr_b16 a[242:243], v24 offset:46800
    v_mfma_f32_32x32x16_bf16 v[176:191], a[220:223], a[140:143], v[176:191]
    s_waitcnt lgkmcnt(8)
    v_mfma_f32_32x32x16_bf16 v[64:79], a[224:227], a[144:147], v[64:79]
    ds_read_b64_tr_b16 a[244:245], v25 offset:45760
    ds_read_b64_tr_b16 a[246:247], v25 offset:46800
    v_mfma_f32_32x32x16_bf16 v[128:143], a[224:227], a[148:151], v[128:143]
    s_waitcnt vmcnt(2)
    v_add_f32 v224, v224, v225
    s_waitcnt vmcnt(0)
    v_add_f32 v226, v226, v227
    s_lshl_b32 s34, s32, 7
    s_waitcnt lgkmcnt(8)
    v_mfma_f32_32x32x16_bf16 v[80:95], a[228:231], a[144:147], v[80:95]
    ds_read_b64_tr_b16 a[248:249], v26 offset:45760
    ds_read_b64_tr_b16 a[250:251], v26 offset:46800
    v_add_f32 v224, v224, v226
    v_mfma_f32_32x32x16_bf16 v[144:159], a[228:231], a[148:151], v[144:159]
    v_add_u32 v4, s34, v3
    v_mov_b32 v225, v224
    s_nop 1
    v_permlane32_swap_b32 v224, v225
    s_waitcnt lgkmcnt(8)
    v_mfma_f32_32x32x16_bf16 v[96:111], a[232:235], a[144:147], v[96:111]
    ds_read_b64_tr_b16 a[252:253], v27 offset:45760
    ds_read_b64_tr_b16 a[254:255], v27 offset:46800
    v_add_f32 v224, v224, v225
    v_mfma_f32_32x32x16_bf16 v[160:175], a[232:235], a[148:151], v[160:175]
    v_add_u32 v4, 157696, v4
    ds_write_b32 v4, v224
    s_waitcnt lgkmcnt(0)
    v_mfma_f32_32x32x16_bf16 v[112:127], a[236:239], a[144:147], v[112:127]
    s_barrier
    ds_read_b64_tr_b16 a[192:193], v24 offset:49920
    ds_read_b64_tr_b16 a[194:195], v24 offset:50960
    v_mfma_f32_32x32x16_bf16 v[176:191], a[236:239], a[148:151], v[176:191]
    ds_read_b64_tr_b16 a[196:197], v25 offset:49920
    ds_read_b64_tr_b16 a[198:199], v25 offset:50960
    s_add_u32 s42, s44, 0
    s_add_u32 m0, s33, 16640
    s_nop 0
    buffer_load_dwordx4 v40, s[20:23], s42 offen offset:0 lds
    v_mfma_f32_32x32x16_bf16 v[64:79], a[240:243], a[152:155], v[64:79]
    ds_read_b64_tr_b16 a[200:201], v26 offset:49920
    ds_read_b64_tr_b16 a[202:203], v26 offset:50960
    buffer_load_dwordx4 v41, s[20:23], s42 offen offset:1040 lds
    v_xor_b32 v5, 0, v4
    ds_read_b32 v240, v5
    v_mfma_f32_32x32x16_bf16 v[128:143], a[240:243], a[156:159], v[128:143]
    ds_read_b64_tr_b16 a[204:205], v27 offset:49920
    ds_read_b64_tr_b16 a[206:207], v27 offset:50960
    buffer_load_dwordx4 v42, s[20:23], s42 offen offset:2080 lds
    v_xor_b32 v5, 128, v4
    ds_read_b32 v244, v5
    v_mfma_f32_32x32x16_bf16 v[80:95], a[244:247], a[152:155], v[80:95]
    ds_read_b64_tr_b16 a[208:209], v24 offset:54080
    ds_read_b64_tr_b16 a[210:211], v24 offset:55120
    ds_read_b128 a[160:163], v28 offset:32768
    buffer_load_dwordx4 v43, s[20:23], s42 offen offset:3120 lds
    v_mfma_f32_32x32x16_bf16 v[144:159], a[244:247], a[156:159], v[144:159]
    ds_read_b64_tr_b16 a[212:213], v25 offset:54080
    ds_read_b64_tr_b16 a[214:215], v25 offset:55120
    s_waitcnt lgkmcnt(14)
    ds_read_b128 a[168:171], v29 offset:32768
    v_xor_b32 v5, 256, v4
    s_waitcnt lgkmcnt(14)
    ds_read_b32 v248, v5
    v_xor_b32 v5, 384, v4
    s_waitcnt lgkmcnt(14)
    ds_read_b32 v252, v5
    v_mfma_f32_32x32x16_bf16 v[96:111], a[248:251], a[152:155], v[96:111]
    s_waitcnt lgkmcnt(14)
    ds_read_b64_tr_b16 a[216:217], v26 offset:54080
    s_waitcnt lgkmcnt(14)
    ds_read_b64_tr_b16 a[218:219], v26 offset:55120
    s_waitcnt lgkmcnt(14)
    ds_read_b128 a[176:179], v30 offset:32768
    v_xor_b32 v50, 0x80000000, v50
    v_cmp_gt_u32 vcc, 32, v2
    v_mfma_f32_32x32x16_bf16 v[160:175], a[248:251], a[156:159], v[160:175]
    s_waitcnt lgkmcnt(14)
    ds_read_b64_tr_b16 a[220:221], v27 offset:54080
    s_waitcnt lgkmcnt(14)
    ds_read_b64_tr_b16 a[222:223], v27 offset:55120
    s_waitcnt lgkmcnt(14)
    ds_read_b128 a[184:187], v31 offset:32768
    v_lshrrev_b32 v33, 16, v50
    v_mul_f32 v51, 0x3e0293ee, v51
    v_mfma_f32_32x32x16_bf16 v[112:127], a[252:255], a[152:155], v[112:127]
    s_waitcnt lgkmcnt(14)
    ds_read_b64_tr_b16 a[224:225], v24 offset:58240
    s_waitcnt lgkmcnt(14)
    ds_read_b64_tr_b16 a[226:227], v24 offset:59280
    v_or_b32 v32, v50, v33
    v_mov_b32 v34, 0
    v_mov_b32 v35, 0
    v_mfma_f32_32x32x16_bf16 v[176:191], a[252:255], a[156:159], v[176:191]
    s_waitcnt lgkmcnt(14)
    ds_read_b64_tr_b16 a[228:229], v25 offset:58240
    s_waitcnt lgkmcnt(14)
    ds_read_b64_tr_b16 a[230:231], v25 offset:59280
    v_cndmask_b32 v32, 0, v32, vcc
    v_cndmask_b32 v33, 0, v33, vcc
    v_xor_b32 v52, 0x80000000, v52
    v_mfma_f32_32x32x16_bf16 v[64:79], a[192:195], a[160:163], v[64:79]
    s_waitcnt lgkmcnt(14)
    ds_read_b64_tr_b16 a[232:233], v26 offset:58240
    s_waitcnt lgkmcnt(14)
    ds_read_b64_tr_b16 a[234:235], v26 offset:59280
    s_waitcnt lgkmcnt(14)
    ds_read_b128 a[164:167], v28 offset:36864
    v_cmp_gt_u32 vcc, 32, v2
    v_lshrrev_b32 v37, 16, v52
    v_mfma_f32_32x32x16_bf16 v[80:95], a[196:199], a[160:163], v[80:95]
    s_waitcnt lgkmcnt(14)
    ds_read_b64_tr_b16 a[236:237], v27 offset:58240
    s_waitcnt lgkmcnt(14)
    ds_read_b64_tr_b16 a[238:239], v27 offset:59280
    s_waitcnt lgkmcnt(14)
    ds_read_b128 a[172:175], v29 offset:36864
    s_add_u32 s42, s44, 16384
    s_add_u32 m0, s33, 33280
    s_nop 0
    buffer_load_dwordx4 v40, s[16:19], s42 offen offset:0 lds
    v_mfma_f32_32x32x16_bf16 v[96:111], a[200:203], a[160:163], v[96:111]
    s_waitcnt lgkmcnt(14)
    ds_read_b64_tr_b16 a[240:241], v24 offset:62400
    s_waitcnt lgkmcnt(14)
    ds_read_b64_tr_b16 a[242:243], v24 offset:63440
    s_waitcnt lgkmcnt(14)
    ds_read_b128 a[180:183], v30 offset:36864
    buffer_load_dwordx4 v41, s[16:19], s42 offen offset:1040 lds
    v_mfma_f32_32x32x16_bf16 v[112:127], a[204:207], a[160:163], v[112:127]
    s_waitcnt lgkmcnt(14)
    ds_read_b64_tr_b16 a[244:245], v25 offset:62400
    s_waitcnt lgkmcnt(14)
    ds_read_b64_tr_b16 a[246:247], v25 offset:63440
    s_waitcnt lgkmcnt(14)
    ds_read_b128 a[188:191], v31 offset:36864
    buffer_load_dwordx4 v42, s[16:19], s42 offen offset:2080 lds
    v_mfma_f32_32x32x16_bf16 v[64:79], a[208:211], a[168:171], v[64:79]
    s_waitcnt lgkmcnt(14)
    ds_read_b64_tr_b16 a[248:249], v26 offset:62400
    s_waitcnt lgkmcnt(14)
    ds_read_b64_tr_b16 a[250:251], v26 offset:63440
    buffer_load_dwordx4 v43, s[16:19], s42 offen offset:3120 lds
    v_mfma_f32_32x32x16_bf16 v[80:95], a[212:215], a[168:171], v[80:95]
    s_waitcnt lgkmcnt(14)
    ds_read_b64_tr_b16 a[252:253], v27 offset:62400
    s_waitcnt lgkmcnt(14)
    ds_read_b64_tr_b16 a[254:255], v27 offset:63440
    v_mul_f32 v53, 0x3e0293ee, v53
    v_or_b32 v36, v52, v37
    v_mov_b32 v38, 0
    v_mfma_f32_32x32x16_bf16 v[96:111], a[216:219], a[168:171], v[96:111]
    v_mov_b32 v39, 0
    v_cndmask_b32 v36, 0, v36, vcc
    v_cndmask_b32 v37, 0, v37, vcc
    v_and_b32 v242, s47, v240
    v_sub_f32 v241, v240, v242
    v_mfma_f32_32x32x16_bf16 v[112:127], a[220:223], a[168:171], v[112:127]
    v_and_b32 v243, s47, v241
    v_sub_f32 v241, v241, v243
    v_lshrrev_b32 v240, 16, v242
    v_or_b32 v240, v240, v243
    v_lshrrev_b32 v241, 16, v241
    v_mfma_f32_32x32x16_bf16 v[64:79], a[224:227], a[176:179], v[64:79]
    v_mov_b32 v242, 0
    v_mov_b32 v243, 0
    v_and_b32 v246, s47, v244
    v_sub_f32 v245, v244, v246
    v_and_b32 v247, s47, v245
    v_mfma_f32_32x32x16_bf16 v[80:95], a[228:231], a[176:179], v[80:95]
    v_sub_f32 v245, v245, v247
    v_lshrrev_b32 v244, 16, v246
    v_or_b32 v244, v244, v247
    v_lshrrev_b32 v245, 16, v245
    v_mov_b32 v246, 0
    s_waitcnt lgkmcnt(0)
    v_mfma_f32_32x32x16_bf16 v[96:111], a[232:235], a[176:179], v[96:111]
    v_mov_b32 v247, 0
    v_and_b32 v250, s47, v248
    v_sub_f32 v249, v248, v250
    v_and_b32 v251, s47, v249
    v_sub_f32 v249, v249, v251
    v_mfma_f32_32x32x16_bf16 v[112:127], a[236:239], a[176:179], v[112:127]
    v_lshrrev_b32 v248, 16, v250
    v_or_b32 v248, v248, v251
    v_lshrrev_b32 v249, 16, v249
    v_mov_b32 v250, 0
    v_mov_b32 v251, 0
    v_mfma_f32_32x32x16_bf16 v[64:79], a[240:243], a[184:187], v[64:79]
    v_and_b32 v254, s47, v252
    v_sub_f32 v253, v252, v254
    v_and_b32 v255, s47, v253
    v_sub_f32 v253, v253, v255
    v_lshrrev_b32 v252, 16, v254
    v_mfma_f32_32x32x16_bf16 v[80:95], a[244:247], a[184:187], v[80:95]
    v_or_b32 v252, v252, v255
    v_lshrrev_b32 v253, 16, v253
    v_mov_b32 v254, 0
    v_mov_b32 v255, 0
    v_mfma_f32_32x32x16_bf16 v[96:111], a[248:251], a[184:187], v[96:111]
    v_mfma_f32_32x32x16_bf16 v[112:127], a[252:255], a[184:187], v[112:127]
    v_mfma_f32_32x32x16_bf16 v[64:79], v[240:243], v[32:35], v[64:79]
    v_mfma_f32_32x32x16_bf16 v[80:95], v[244:247], v[32:35], v[80:95]
    v_mfma_f32_32x32x16_bf16 v[96:111], v[248:251], v[32:35], v[96:111]
    v_mfma_f32_32x32x16_bf16 v[112:127], v[252:255], v[32:35], v[112:127]
    v_mfma_f32_32x32x16_bf16 v[128:143], a[192:195], a[164:167], v[128:143]
    v_lshrrev_b32 v60, 4, v2
    v_lshlrev_b32 v60, 8, v60
    v_mul_u32_u24 v60, 3, v60
    v_mfma_f32_32x32x16_bf16 v[144:159], a[196:199], a[164:167], v[144:159]
    v_add_u32 v60, v60, v43
    s_lshl_b32 s42, s2, 14
    s_lshl_b32 s35, s32, 8
    s_add_u32 s42, s42, s35
    v_mul_f32 v64, v51, v64
    v_mul_f32 v65, v51, v65
    v_mfma_f32_32x32x16_bf16 v[160:175], a[200:203], a[164:167], v[160:175]
    s_add_u32 m0, s41, 36864
    s_nop 0
    buffer_load_dwordx4 v60, s[76:79], s42 offen lds
    s_add_u32 s42, s42, 4096
    v_cvt_pk_bf16_f32 v192, v64, v65
    v_mul_f32 v66, v51, v66
    v_mfma_f32_32x32x16_bf16 v[176:191], a[204:207], a[164:167], v[176:191]
    s_add_u32 m0, s41, 37904
    s_nop 0
    buffer_load_dwordx4 v60, s[76:79], s42 offen lds
    s_add_u32 s42, s42, 4096
    v_mul_f32 v67, v51, v67
    v_cvt_pk_bf16_f32 v193, v66, v67
    v_mfma_f32_32x32x16_bf16 v[128:143], a[208:211], a[172:175], v[128:143]
    s_add_u32 m0, s41, 38944
    s_nop 0
    buffer_load_dwordx4 v60, s[76:79], s42 offen lds
    s_add_u32 s42, s42, 4096
    v_mul_f32 v68, v51, v68
    v_mul_f32 v69, v51, v69
    v_mfma_f32_32x32x16_bf16 v[144:159], a[212:215], a[172:175], v[144:159]
    s_add_u32 m0, s41, 39984
    s_nop 0
    buffer_load_dwordx4 v60, s[76:79], s42 offen lds
    s_add_u32 s42, s42, 4096
    v_cvt_pk_bf16_f32 v194, v68, v69
    v_mul_f32 v70, v51, v70
    v_mfma_f32_32x32x16_bf16 v[160:175], a[216:219], a[172:175], v[160:175]
    v_mul_f32 v71, v51, v71
    v_cvt_pk_bf16_f32 v195, v70, v71
    v_mul_f32 v72, v51, v72
    v_mul_f32 v73, v51, v73
    v_cvt_pk_bf16_f32 v196, v72, v73
    v_mul_f32 v74, v51, v74
    v_mul_f32 v75, v51, v75
    v_mfma_f32_32x32x16_bf16 v[176:191], a[220:223], a[172:175], v[176:191]
    v_cvt_pk_bf16_f32 v197, v74, v75
    v_mul_f32 v76, v51, v76
    v_mul_f32 v77, v51, v77
    v_cvt_pk_bf16_f32 v198, v76, v77
    v_mul_f32 v78, v51, v78
    v_mul_f32 v79, v51, v79
    v_cvt_pk_bf16_f32 v199, v78, v79
    v_mfma_f32_32x32x16_bf16 v[128:143], a[224:227], a[180:183], v[128:143]
    v_mul_f32 v80, v51, v80
    v_mul_f32 v81, v51, v81
    v_cvt_pk_bf16_f32 v200, v80, v81
    v_mul_f32 v82, v51, v82
    v_mul_f32 v83, v51, v83
    v_cvt_pk_bf16_f32 v201, v82, v83
    v_mul_f32 v84, v51, v84
    v_mfma_f32_32x32x16_bf16 v[144:159], a[228:231], a[180:183], v[144:159]
    v_mul_f32 v85, v51, v85
    v_cvt_pk_bf16_f32 v202, v84, v85
    v_mul_f32 v86, v51, v86
    v_mul_f32 v87, v51, v87
    v_cvt_pk_bf16_f32 v203, v86, v87
    v_mul_f32 v88, v51, v88
    v_mul_f32 v89, v51, v89
    v_mfma_f32_32x32x16_bf16 v[160:175], a[232:235], a[180:183], v[160:175]
    s_barrier
    ds_read_b128 a[192:195], v8 offset:0
    v_cvt_pk_bf16_f32 v204, v88, v89
    v_mul_f32 v90, v51, v90
    v_mul_f32 v91, v51, v91
    v_cvt_pk_bf16_f32 v205, v90, v91
    v_mul_f32 v92, v51, v92
    v_mfma_f32_32x32x16_bf16 v[176:191], a[236:239], a[180:183], v[176:191]
    ds_read_b128 a[196:199], v8 offset:8320
    v_mul_f32 v93, v51, v93
    v_cvt_pk_bf16_f32 v206, v92, v93
    v_mul_f32 v94, v51, v94
    v_mul_f32 v95, v51, v95
    v_cvt_pk_bf16_f32 v207, v94, v95
    v_mul_f32 v96, v51, v96
    v_mfma_f32_32x32x16_bf16 v[128:143], a[240:243], a[188:191], v[128:143]
    ds_read_b128 a[200:203], v8 offset:32
    v_mul_f32 v97, v51, v97
    v_cvt_pk_bf16_f32 v208, v96, v97
    v_mul_f32 v98, v51, v98
    v_mul_f32 v99, v51, v99
    v_cvt_pk_bf16_f32 v209, v98, v99
    v_mul_f32 v100, v51, v100
    v_mfma_f32_32x32x16_bf16 v[144:159], a[244:247], a[188:191], v[144:159]
    ds_read_b128 a[204:207], v8 offset:8352
    v_mul_f32 v101, v51, v101
    v_cvt_pk_bf16_f32 v210, v100, v101
    v_mul_f32 v102, v51, v102
    v_mul_f32 v103, v51, v103
    v_cvt_pk_bf16_f32 v211, v102, v103
    v_mul_f32 v104, v51, v104
    v_mfma_f32_32x32x16_bf16 v[160:175], a[248:251], a[188:191], v[160:175]
    ds_read_b128 a[208:211], v9 offset:0
    v_mul_f32 v105, v51, v105
    v_cvt_pk_bf16_f32 v212, v104, v105
    v_mul_f32 v106, v51, v106
    v_mul_f32 v107, v51, v107
    v_cvt_pk_bf16_f32 v213, v106, v107
    v_mul_f32 v108, v51, v108
    v_mfma_f32_32x32x16_bf16 v[176:191], a[252:255], a[188:191], v[176:191]
    ds_read_b128 a[212:215], v9 offset:8320
    v_mul_f32 v109, v51, v109
    v_cvt_pk_bf16_f32 v214, v108, v109
    v_mul_f32 v110, v51, v110
    v_mul_f32 v111, v51, v111
    v_cvt_pk_bf16_f32 v215, v110, v111
    v_mul_f32 v112, v51, v112
    v_mfma_f32_32x32x16_bf16 v[128:143], v[240:243], v[36:39], v[128:143]
    ds_read_b128 a[216:219], v9 offset:32
    v_mul_f32 v113, v51, v113
    v_cvt_pk_bf16_f32 v216, v112, v113
    v_mul_f32 v114, v51, v114
    v_mul_f32 v115, v51, v115
    v_cvt_pk_bf16_f32 v217, v114, v115
    v_mul_f32 v116, v51, v116
    v_mfma_f32_32x32x16_bf16 v[144:159], v[244:247], v[36:39], v[144:159]
    ds_read_b128 a[220:223], v9 offset:8352
    v_mul_f32 v117, v51, v117
    v_cvt_pk_bf16_f32 v218, v116, v117
    v_mul_f32 v118, v51, v118
    v_mul_f32 v119, v51, v119
    v_cvt_pk_bf16_f32 v219, v118, v119
    v_mul_f32 v120, v51, v120
    v_mfma_f32_32x32x16_bf16 v[160:175], v[248:251], v[36:39], v[160:175]
    ds_read_b128 a[224:227], v10 offset:0
    v_mul_f32 v121, v51, v121
    v_cvt_pk_bf16_f32 v220, v120, v121
    v_mul_f32 v122, v51, v122
    v_mul_f32 v123, v51, v123
    v_cvt_pk_bf16_f32 v221, v122, v123
    v_mul_f32 v124, v51, v124
    v_mfma_f32_32x32x16_bf16 v[176:191], v[252:255], v[36:39], v[176:191]
    ds_read_b128 a[228:231], v10 offset:8320
    v_mul_f32 v125, v51, v125
    v_cvt_pk_bf16_f32 v222, v124, v125
    v_mul_f32 v126, v51, v126
    v_mul_f32 v127, v51, v127
    v_cvt_pk_bf16_f32 v223, v126, v127
    s_waitcnt lgkmcnt(3)
    v_mfma_f32_32x32x16_bf16 v[64:79], a[192:195], v[192:195], 0
    ds_read_b128 a[232:235], v10 offset:32
    v_mfma_f32_32x32x16_bf16 v[96:111], a[196:199], v[192:195], 0
    ds_read_b128 a[236:239], v10 offset:8352
    v_mul_f32 v128, v53, v128
    v_mul_f32 v129, v53, v129
    v_cvt_pk_bf16_f32 v224, v128, v129
    v_mul_f32 v130, v53, v130
    v_mul_f32 v131, v53, v131
    v_cvt_pk_bf16_f32 v225, v130, v131
    v_mul_f32 v132, v53, v132
    v_mfma_f32_32x32x16_bf16 v[64:79], a[200:203], v[196:199], v[64:79]
    ds_read_b128 a[240:243], v11 offset:0
    s_add_u32 s42, s44, 16384
    s_add_u32 m0, s33, 49920
    s_nop 0
    buffer_load_dwordx4 v40, s[20:23], s42 offen offset:0 lds
    v_mul_f32 v133, v53, v133
    v_cvt_pk_bf16_f32 v226, v132, v133
    v_mfma_f32_32x32x16_bf16 v[96:111], a[204:207], v[196:199], v[96:111]
    ds_read_b128 a[244:247], v11 offset:8320
    v_mul_f32 v134, v53, v134
    v_mul_f32 v135, v53, v135
    v_cvt_pk_bf16_f32 v227, v134, v135
    v_mul_f32 v136, v53, v136
    v_mul_f32 v137, v53, v137
    v_cvt_pk_bf16_f32 v228, v136, v137
    v_mul_f32 v138, v53, v138
    v_mfma_f32_32x32x16_bf16 v[64:79], a[208:211], v[200:203], v[64:79]
    ds_read_b128 a[248:251], v11 offset:32
    v_mul_f32 v139, v53, v139
    v_cvt_pk_bf16_f32 v229, v138, v139
    v_mul_f32 v140, v53, v140
    v_mul_f32 v141, v53, v141
    v_cvt_pk_bf16_f32 v230, v140, v141
    v_mul_f32 v142, v53, v142
    v_mul_f32 v143, v53, v143
    v_mfma_f32_32x32x16_bf16 v[96:111], a[212:215], v[200:203], v[96:111]
    ds_read_b128 a[252:255], v11 offset:8352
    v_cvt_pk_bf16_f32 v231, v142, v143
    v_mul_f32 v144, v53, v144
    v_mul_f32 v145, v53, v145
    v_cvt_pk_bf16_f32 v232, v144, v145
    v_mul_f32 v146, v53, v146
    v_mul_f32 v147, v53, v147
    v_cvt_pk_bf16_f32 v233, v146, v147
    v_mfma_f32_32x32x16_bf16 v[64:79], a[216:219], v[204:207], v[64:79]
    buffer_load_dwordx4 v41, s[20:23], s42 offen offset:1040 lds
    v_mul_f32 v148, v53, v148
    v_mul_f32 v149, v53, v149
    v_cvt_pk_bf16_f32 v234, v148, v149
    v_mul_f32 v150, v53, v150
    v_mul_f32 v151, v53, v151
    s_waitcnt lgkmcnt(2)
    v_mfma_f32_32x32x16_bf16 v[96:111], a[220:223], v[204:207], v[96:111]
    v_cvt_pk_bf16_f32 v235, v150, v151
    v_mul_f32 v152, v53, v152
    v_mul_f32 v153, v53, v153
    v_cvt_pk_bf16_f32 v236, v152, v153
    v_mul_f32 v154, v53, v154
    v_mul_f32 v155, v53, v155
    v_cvt_pk_bf16_f32 v237, v154, v155
    v_mul_f32 v156, v53, v156
    v_mfma_f32_32x32x16_bf16 v[64:79], a[224:227], v[208:211], v[64:79]
    v_mul_f32 v157, v53, v157
    v_cvt_pk_bf16_f32 v238, v156, v157
    v_mul_f32 v158, v53, v158
    v_mul_f32 v159, v53, v159
    v_cvt_pk_bf16_f32 v239, v158, v159
    v_mul_f32 v160, v53, v160
    v_mul_f32 v161, v53, v161
    v_cvt_pk_bf16_f32 v240, v160, v161
    v_mfma_f32_32x32x16_bf16 v[96:111], a[228:231], v[208:211], v[96:111]
    buffer_load_dwordx4 v42, s[20:23], s42 offen offset:2080 lds
    v_mul_f32 v162, v53, v162
    v_mul_f32 v163, v53, v163
    v_cvt_pk_bf16_f32 v241, v162, v163
    v_mul_f32 v164, v53, v164
    v_mul_f32 v165, v53, v165
    v_mfma_f32_32x32x16_bf16 v[64:79], a[232:235], v[212:215], v[64:79]
    v_cvt_pk_bf16_f32 v242, v164, v165
    v_mul_f32 v166, v53, v166
    v_mul_f32 v167, v53, v167
    v_cvt_pk_bf16_f32 v243, v166, v167
    v_mul_f32 v168, v53, v168
    v_mul_f32 v169, v53, v169
    v_cvt_pk_bf16_f32 v244, v168, v169
    v_mul_f32 v170, v53, v170
    v_mfma_f32_32x32x16_bf16 v[96:111], a[236:239], v[212:215], v[96:111]
    v_mul_f32 v171, v53, v171
    v_cvt_pk_bf16_f32 v245, v170, v171
    v_mul_f32 v172, v53, v172
    v_mul_f32 v173, v53, v173
    v_cvt_pk_bf16_f32 v246, v172, v173
    v_mul_f32 v174, v53, v174
    v_mul_f32 v175, v53, v175
    v_cvt_pk_bf16_f32 v247, v174, v175
    v_mfma_f32_32x32x16_bf16 v[64:79], a[240:243], v[216:219], v[64:79]
    v_mul_f32 v176, v53, v176
    v_mul_f32 v177, v53, v177
    v_cvt_pk_bf16_f32 v248, v176, v177
    v_mul_f32 v178, v53, v178
    v_mul_f32 v179, v53, v179
    v_cvt_pk_bf16_f32 v249, v178, v179
    v_mul_f32 v180, v53, v180
    v_mul_f32 v181, v53, v181
    v_mfma_f32_32x32x16_bf16 v[96:111], a[244:247], v[216:219], v[96:111]
    v_cvt_pk_bf16_f32 v250, v180, v181
    v_mul_f32 v182, v53, v182
    v_mul_f32 v183, v53, v183
    v_cvt_pk_bf16_f32 v251, v182, v183
    v_mul_f32 v184, v53, v184
    v_mul_f32 v185, v53, v185
    v_cvt_pk_bf16_f32 v252, v184, v185
    v_mul_f32 v186, v53, v186
    s_waitcnt lgkmcnt(0)
    v_mfma_f32_32x32x16_bf16 v[64:79], a[248:251], v[220:223], v[64:79]
    v_mul_f32 v187, v53, v187
    v_cvt_pk_bf16_f32 v253, v186, v187
    v_mul_f32 v188, v53, v188
    v_mul_f32 v189, v53, v189
    v_cvt_pk_bf16_f32 v254, v188, v189
    v_mul_f32 v190, v53, v190
    v_mul_f32 v191, v53, v191
    v_cvt_pk_bf16_f32 v255, v190, v191
    v_mfma_f32_32x32x16_bf16 v[96:111], a[252:255], v[220:223], v[96:111]
    buffer_load_dwordx4 v43, s[20:23], s42 offen offset:3120 lds
    v_mfma_f32_32x32x16_bf16 v[80:95], a[192:195], v[224:227], 0
    v_mfma_f32_32x32x16_bf16 v[112:127], a[196:199], v[224:227], 0
    v_mfma_f32_32x32x16_bf16 v[80:95], a[200:203], v[228:231], v[80:95]
    v_max3_f32 v62, v64, v65, v66
    v_max3_f32 v62, v67, v68, v62
    v_max3_f32 v62, v69, v70, v62
    v_max3_f32 v62, v71, v72, v62
    v_max3_f32 v62, v73, v74, v62
    v_max3_f32 v62, v75, v76, v62
    v_max3_f32 v62, v77, v78, v62
    v_max_f32 v62, v79, v62
    v_mov_b32 v63, v62
    v_mfma_f32_32x32x16_bf16 v[112:127], a[204:207], v[228:231], v[112:127]
    v_mov_b32 v45, 0
    s_nop 0
    v_permlane32_swap_b32 v62, v63
    v_max_f32 v62, v62, v63
    v_sub_f32 v64, v64, v62
    v_sub_f32 v65, v65, v62
    v_sub_f32 v66, v66, v62
    v_sub_f32 v67, v67, v62
    v_sub_f32 v68, v68, v62
    v_mfma_f32_32x32x16_bf16 v[80:95], a[208:211], v[232:235], v[80:95]
    v_sub_f32 v69, v69, v62
    v_sub_f32 v70, v70, v62
    v_sub_f32 v71, v71, v62
    v_sub_f32 v72, v72, v62
    v_sub_f32 v73, v73, v62
    v_sub_f32 v74, v74, v62
    v_sub_f32 v75, v75, v62
    v_sub_f32 v76, v76, v62
    v_sub_f32 v77, v77, v62
    v_mfma_f32_32x32x16_bf16 v[112:127], a[212:215], v[232:235], v[112:127]
    v_sub_f32 v78, v78, v62
    v_sub_f32 v79, v79, v62
    v_exp_f32 v54, v64
    v_exp_f32 v55, v65
    v_exp_f32 v56, v66
    v_add_f32 v47, v54, v55
    v_mfma_f32_32x32x16_bf16 v[80:95], a[216:219], v[236:239], v[80:95]
    v_cvt_pk_bf16_f32 v128, v54, v55
    v_exp_f32 v57, v67
    v_add_f32 v47, v47, v56
    v_exp_f32 v58, v68
    v_add_f32 v47, v47, v57
    v_cvt_pk_bf16_f32 v129, v56, v57
    v_mfma_f32_32x32x16_bf16 v[112:127], a[220:223], v[236:239], v[112:127]
    s_waitcnt vmcnt(8)
    s_barrier
    ds_read_b128 a[192:195], v8 offset:33280
    v_exp_f32 v59, v69
    v_add_f32 v47, v47, v58
    v_exp_f32 v60, v70
    v_add_f32 v47, v47, v59
    v_cvt_pk_bf16_f32 v130, v58, v59
    v_mfma_f32_32x32x16_bf16 v[80:95], a[224:227], v[240:243], v[80:95]
    v_exp_f32 v61, v71
    v_add_f32 v47, v47, v60
    v_exp_f32 v54, v72
    v_add_f32 v47, v47, v61
    v_cvt_pk_bf16_f32 v131, v60, v61
    v_exp_f32 v55, v73
    v_mfma_f32_32x32x16_bf16 v[112:127], a[228:231], v[240:243], v[112:127]
    ds_read_b128 a[196:199], v8 offset:33312
    v_add_f32 v47, v47, v54
    v_exp_f32 v56, v74
    v_add_f32 v47, v47, v55
    v_cvt_pk_bf16_f32 v132, v54, v55
    v_exp_f32 v57, v75
    v_add_f32 v47, v47, v56
    v_mfma_f32_32x32x16_bf16 v[80:95], a[232:235], v[244:247], v[80:95]
    v_exp_f32 v58, v76
    v_add_f32 v47, v47, v57
    v_cvt_pk_bf16_f32 v133, v56, v57
    v_exp_f32 v59, v77
    v_add_f32 v47, v47, v58
    v_exp_f32 v60, v78
    v_mfma_f32_32x32x16_bf16 v[112:127], a[236:239], v[244:247], v[112:127]
    ds_read_b128 a[200:203], v9 offset:33280
    v_add_f32 v47, v47, v59
    v_cvt_pk_bf16_f32 v134, v58, v59
    v_exp_f32 v61, v79
    v_add_f32 v47, v47, v60
    v_add_f32 v47, v47, v61
    v_cvt_pk_bf16_f32 v135, v60, v61
    v_add_f32 v45, v45, v47
    v_mfma_f32_32x32x16_bf16 v[80:95], a[240:243], v[248:251], v[80:95]
    v_sub_f32 v160, 0, v62
    v_sub_f32 v161, 0, v62
    v_sub_f32 v162, 0, v62
    v_sub_f32 v163, 0, v62
    v_sub_f32 v164, 0, v62
    v_sub_f32 v165, 0, v62
    v_sub_f32 v166, 0, v62
    v_sub_f32 v167, 0, v62
    v_sub_f32 v168, 0, v62
    v_mfma_f32_32x32x16_bf16 v[112:127], a[244:247], v[248:251], v[112:127]
    ds_read_b128 a[204:207], v9 offset:33312
    v_sub_f32 v169, 0, v62
    v_sub_f32 v170, 0, v62
    v_sub_f32 v171, 0, v62
    v_sub_f32 v172, 0, v62
    v_sub_f32 v173, 0, v62
    v_sub_f32 v174, 0, v62
    v_sub_f32 v175, 0, v62
    v_sub_f32 v96, v96, v62
    v_mfma_f32_32x32x16_bf16 v[80:95], a[248:251], v[252:255], v[80:95]
    v_sub_f32 v97, v97, v62
    v_sub_f32 v98, v98, v62
    v_sub_f32 v99, v99, v62
    v_sub_f32 v100, v100, v62
    v_sub_f32 v101, v101, v62
    v_sub_f32 v102, v102, v62
    v_sub_f32 v103, v103, v62
    v_sub_f32 v104, v104, v62
    v_sub_f32 v105, v105, v62
    v_mfma_f32_32x32x16_bf16 v[112:127], a[252:255], v[252:255], v[112:127]
    ds_read_b128 a[208:211], v10 offset:33280
    v_sub_f32 v106, v106, v62
    v_sub_f32 v107, v107, v62
    v_sub_f32 v108, v108, v62
    v_sub_f32 v109, v109, v62
    v_sub_f32 v110, v110, v62
    v_sub_f32 v111, v111, v62
    v_max3_f32 v62, v80, v81, v82
    v_max3_f32 v62, v83, v84, v62
    v_max3_f32 v62, v85, v86, v62
    v_max3_f32 v62, v87, v88, v62
    v_max3_f32 v62, v89, v90, v62
    v_max3_f32 v62, v91, v92, v62
    v_max3_f32 v62, v93, v94, v62
    v_max_f32 v62, v95, v62
    v_mov_b32 v63, v62
    v_mov_b32 v46, 0
    s_nop 0
    v_permlane32_swap_b32 v62, v63
    v_max_f32 v62, v62, v63
    v_sub_f32 v80, v80, v62
    v_sub_f32 v81, v81, v62
    v_sub_f32 v82, v82, v62
    v_sub_f32 v83, v83, v62
    v_sub_f32 v84, v84, v62
    v_sub_f32 v85, v85, v62
    v_sub_f32 v86, v86, v62
    v_sub_f32 v87, v87, v62
    v_sub_f32 v88, v88, v62
    v_sub_f32 v89, v89, v62
    v_sub_f32 v90, v90, v62
    v_sub_f32 v91, v91, v62
    v_sub_f32 v92, v92, v62
    v_sub_f32 v93, v93, v62
    v_sub_f32 v94, v94, v62
    v_sub_f32 v95, v95, v62
    v_exp_f32 v54, v80
    v_exp_f32 v55, v81
    v_exp_f32 v56, v82
    v_add_f32 v48, v54, v55
    v_cvt_pk_bf16_f32 v136, v54, v55
    v_exp_f32 v57, v83
    v_add_f32 v48, v48, v56
    v_exp_f32 v58, v84
    v_add_f32 v48, v48, v57
    v_cvt_pk_bf16_f32 v137, v56, v57
    v_exp_f32 v59, v85
    v_add_f32 v48, v48, v58
    v_exp_f32 v60, v86
    v_add_f32 v48, v48, v59
    v_cvt_pk_bf16_f32 v138, v58, v59
    v_exp_f32 v61, v87
    v_add_f32 v48, v48, v60
    v_exp_f32 v54, v88
    v_add_f32 v48, v48, v61
    v_cvt_pk_bf16_f32 v139, v60, v61
    v_exp_f32 v55, v89
    v_add_f32 v48, v48, v54
    v_exp_f32 v56, v90
    v_add_f32 v48, v48, v55
    v_cvt_pk_bf16_f32 v140, v54, v55
    v_exp_f32 v57, v91
    v_add_f32 v48, v48, v56
    v_exp_f32 v58, v92
    v_add_f32 v48, v48, v57
    v_cvt_pk_bf16_f32 v141, v56, v57
    v_exp_f32 v59, v93
    v_add_f32 v48, v48, v58
    v_exp_f32 v60, v94
    v_add_f32 v48, v48, v59
    v_cvt_pk_bf16_f32 v142, v58, v59
    v_exp_f32 v61, v95
    v_add_f32 v48, v48, v60
    v_add_f32 v48, v48, v61
    v_cvt_pk_bf16_f32 v143, v60, v61
    v_add_f32 v46, v46, v48
    v_sub_f32 v176, 0, v62
    v_sub_f32 v177, 0, v62
    v_sub_f32 v178, 0, v62
    v_sub_f32 v179, 0, v62
    v_sub_f32 v180, 0, v62
    v_sub_f32 v181, 0, v62
    v_sub_f32 v182, 0, v62
    v_sub_f32 v183, 0, v62
    v_sub_f32 v184, 0, v62
    v_sub_f32 v185, 0, v62
    v_sub_f32 v186, 0, v62
    v_sub_f32 v187, 0, v62
    v_sub_f32 v188, 0, v62
    v_sub_f32 v189, 0, v62
    v_sub_f32 v190, 0, v62
    v_sub_f32 v191, 0, v62
    v_sub_f32 v112, v112, v62
    v_sub_f32 v113, v113, v62
    v_sub_f32 v114, v114, v62
    v_sub_f32 v115, v115, v62
    v_sub_f32 v116, v116, v62
    v_sub_f32 v117, v117, v62
    v_sub_f32 v118, v118, v62
    v_sub_f32 v119, v119, v62
    v_sub_f32 v120, v120, v62
    v_sub_f32 v121, v121, v62
    v_sub_f32 v122, v122, v62
    v_sub_f32 v123, v123, v62
    v_sub_f32 v124, v124, v62
    v_sub_f32 v125, v125, v62
    v_sub_f32 v126, v126, v62
    v_sub_f32 v127, v127, v62
    s_waitcnt lgkmcnt(0)
    v_mfma_f32_32x32x16_bf16 v[64:79], a[192:195], v[192:195], v[160:175]
    ds_read_b128 a[212:215], v10 offset:33312
    s_add_u32 s42, s44, 32768
    s_add_u32 m0, s33, 66560
    v_exp_f32 v54, v96
    v_mfma_f32_32x32x16_bf16 v[80:95], a[192:195], v[224:227], v[176:191]
    buffer_load_dwordx4 v40, s[16:19], s42 offen offset:0 lds
    v_exp_f32 v55, v97
    v_mfma_f32_32x32x16_bf16 v[64:79], a[196:199], v[196:199], v[64:79]
    ds_read_b128 a[216:219], v11 offset:33280
    s_mov_b32 s43, 19922944
    v_exp_f32 v56, v98
    v_add_f32 v47, v54, v55
    v_cvt_pk_bf16_f32 v144, v54, v55
    v_mfma_f32_32x32x16_bf16 v[80:95], a[196:199], v[228:231], v[80:95]
    buffer_load_dwordx4 v41, s[16:19], s42 offen offset:1040 lds
    v_exp_f32 v57, v99
    v_add_f32 v47, v47, v56
    v_mfma_f32_32x32x16_bf16 v[64:79], a[200:203], v[200:203], v[64:79]
    ds_read_b128 a[220:223], v11 offset:33312
    v_exp_f32 v58, v100
    v_add_f32 v47, v47, v57
    v_cvt_pk_bf16_f32 v145, v56, v57
    v_mfma_f32_32x32x16_bf16 v[80:95], a[200:203], v[232:235], v[80:95]
    buffer_load_dwordx4 v42, s[16:19], s42 offen offset:2080 lds
    v_exp_f32 v59, v101
    v_add_f32 v47, v47, v58
    v_mfma_f32_32x32x16_bf16 v[64:79], a[204:207], v[204:207], v[64:79]
    ds_read_b64_tr_b16 a[192:193], v16 offset:16640
    ds_read_b64_tr_b16 a[194:195], v16 offset:17680
    v_exp_f32 v60, v102
    v_add_f32 v47, v47, v59
    v_cvt_pk_bf16_f32 v146, v58, v59
    v_mfma_f32_32x32x16_bf16 v[80:95], a[204:207], v[236:239], v[80:95]
    buffer_load_dwordx4 v43, s[16:19], s42 offen offset:3120 lds
    v_exp_f32 v61, v103
    v_add_f32 v47, v47, v60
    v_mfma_f32_32x32x16_bf16 v[64:79], a[208:211], v[208:211], v[64:79]
    ds_read_b64_tr_b16 a[196:197], v17 offset:16640
    ds_read_b64_tr_b16 a[198:199], v17 offset:17680
    s_add_u32 s42, s44, 49152
    s_add_u32 m0, s33, 0
    v_exp_f32 v54, v104
    v_mfma_f32_32x32x16_bf16 v[80:95], a[208:211], v[240:243], v[80:95]
    buffer_load_dwordx4 v40, s[16:19], s42 offen offset:0 lds
    v_add_f32 v47, v47, v61
    v_cvt_pk_bf16_f32 v147, v60, v61
    s_waitcnt lgkmcnt(4)
    v_mfma_f32_32x32x16_bf16 v[64:79], a[212:215], v[212:215], v[64:79]
    ds_read_b64_tr_b16 a[200:201], v18 offset:16640
    ds_read_b64_tr_b16 a[202:203], v18 offset:17680
    v_exp_f32 v55, v105
    v_add_f32 v47, v47, v54
    v_mfma_f32_32x32x16_bf16 v[80:95], a[212:215], v[244:247], v[80:95]
    buffer_load_dwordx4 v41, s[16:19], s42 offen offset:1040 lds
    v_exp_f32 v56, v106
    v_add_f32 v47, v47, v55
    v_mfma_f32_32x32x16_bf16 v[64:79], a[216:219], v[216:219], v[64:79]
    ds_read_b64_tr_b16 a[204:205], v19 offset:16640
    ds_read_b64_tr_b16 a[206:207], v19 offset:17680
    v_cvt_pk_bf16_f32 v148, v54, v55
    v_exp_f32 v57, v107
    v_add_f32 v47, v47, v56
    v_mfma_f32_32x32x16_bf16 v[80:95], a[216:219], v[248:251], v[80:95]
    buffer_load_dwordx4 v42, s[16:19], s42 offen offset:2080 lds
    v_exp_f32 v58, v108
    v_add_f32 v47, v47, v57
    v_mfma_f32_32x32x16_bf16 v[64:79], a[220:223], v[220:223], v[64:79]
    ds_read_b64_tr_b16 a[208:209], v16 offset:20800
    ds_read_b64_tr_b16 a[210:211], v16 offset:21840
    v_cvt_pk_bf16_f32 v149, v56, v57
    v_exp_f32 v59, v109
    v_add_f32 v47, v47, v58
    v_mfma_f32_32x32x16_bf16 v[80:95], a[220:223], v[252:255], v[80:95]
    buffer_load_dwordx4 v43, s[16:19], s42 offen offset:3120 lds
    v_exp_f32 v60, v110
    v_add_f32 v47, v47, v59
    s_waitcnt lgkmcnt(4)
    v_mfma_f32_32x32x16_bf16 a[0:15], a[192:195], v[128:131], 0
    ds_read_b64_tr_b16 a[212:213], v17 offset:20800
    ds_read_b64_tr_b16 a[214:215], v17 offset:21840
    v_cvt_pk_bf16_f32 v150, v58, v59
    v_exp_f32 v61, v111
    v_add_f32 v47, v47, v60
    v_mfma_f32_32x32x16_bf16 a[64:79], a[192:195], v[136:139], 0
    buffer_load_dwordx4 v[32:35], v44, s[28:31], s43 offen offset:0 sc1
    v_exp_f32 v54, v112
    v_add_f32 v47, v47, v61
    v_mfma_f32_32x32x16_bf16 a[16:31], a[196:199], v[128:131], 0
    ds_read_b64_tr_b16 a[216:217], v18 offset:20800
    ds_read_b64_tr_b16 a[218:219], v18 offset:21840
    v_cvt_pk_bf16_f32 v151, v60, v61
    v_exp_f32 v55, v113
    v_mfma_f32_32x32x16_bf16 a[80:95], a[196:199], v[136:139], 0
    v_exp_f32 v56, v114
    v_add_f32 v48, v54, v55
    v_cvt_pk_bf16_f32 v152, v54, v55
    v_exp_f32 v57, v115
    v_mfma_f32_32x32x16_bf16 a[32:47], a[200:203], v[128:131], 0
    ds_read_b64_tr_b16 a[220:221], v19 offset:20800
    ds_read_b64_tr_b16 a[222:223], v19 offset:21840
    v_add_f32 v48, v48, v56
    v_exp_f32 v58, v116
    v_add_f32 v48, v48, v57
    v_mfma_f32_32x32x16_bf16 a[96:111], a[200:203], v[136:139], 0
    buffer_load_dwordx4 v[36:39], v44, s[28:31], s43 offen offset:1024 sc1
    v_cvt_pk_bf16_f32 v153, v56, v57
    v_exp_f32 v59, v117
    s_waitcnt lgkmcnt(4)
    v_mfma_f32_32x32x16_bf16 a[48:63], a[204:207], v[128:131], 0
    ds_read_b128 a[192:195], v8 offset:41600
    v_add_f32 v48, v48, v58
    v_exp_f32 v60, v118
    v_add_f32 v48, v48, v59
    v_cvt_pk_bf16_f32 v154, v58, v59
    v_mfma_f32_32x32x16_bf16 a[112:127], a[204:207], v[136:139], 0
    v_exp_f32 v61, v119
    v_add_f32 v48, v48, v60
    v_exp_f32 v54, v120
    v_add_f32 v48, v48, v61
    v_mfma_f32_32x32x16_bf16 a[0:15], a[208:211], v[132:135], a[0:15]
    ds_read_b128 a[196:199], v8 offset:41632
    v_cvt_pk_bf16_f32 v155, v60, v61
    v_exp_f32 v55, v121
    v_add_f32 v48, v48, v54
    v_mfma_f32_32x32x16_bf16 a[64:79], a[208:211], v[140:143], a[64:79]
    v_exp_f32 v56, v122
    v_add_f32 v48, v48, v55
    v_cvt_pk_bf16_f32 v156, v54, v55
    v_exp_f32 v57, v123
    v_mfma_f32_32x32x16_bf16 a[16:31], a[212:215], v[132:135], a[16:31]
    ds_read_b128 a[200:203], v9 offset:41600
    v_add_f32 v48, v48, v56
    v_exp_f32 v58, v124
    v_add_f32 v48, v48, v57
    v_cvt_pk_bf16_f32 v157, v56, v57
    v_mfma_f32_32x32x16_bf16 a[80:95], a[212:215], v[140:143], a[80:95]
    v_exp_f32 v59, v125
    v_add_f32 v48, v48, v58
    v_exp_f32 v60, v126
    v_add_f32 v48, v48, v59
    s_waitcnt lgkmcnt(2)
    v_mfma_f32_32x32x16_bf16 a[32:47], a[216:219], v[132:135], a[32:47]
    ds_read_b128 a[204:207], v9 offset:41632
    v_cvt_pk_bf16_f32 v158, v58, v59
    v_exp_f32 v61, v127
    v_add_f32 v48, v48, v60
    v_mfma_f32_32x32x16_bf16 a[96:111], a[216:219], v[140:143], a[96:111]
    v_mfma_f32_32x32x16_bf16 a[48:63], a[220:223], v[132:135], a[48:63]
    ds_read_b128 a[208:211], v10 offset:41600
    v_add_f32 v48, v48, v61
    v_cvt_pk_bf16_f32 v159, v60, v61
    v_max_f32 v62, v47, v48
    v_cmp_lt_f32 vcc, s36, v62
    v_mfma_f32_32x32x16_bf16 a[112:127], a[220:223], v[140:143], a[112:127]
    s_cbranch_vccnz L_stub0
L_back0:
    v_add_f32 v45, v45, v47
    v_add_f32 v46, v46, v48
    v_mfma_f32_32x32x16_bf16 v[96:111], a[192:195], v[192:195], v[160:175]
    ds_read_b128 a[212:215], v10 offset:41632
    s_add_u32 s42, s44, 32768
    s_add_u32 m0, s33, 83200
    v_exp_f32 v54, v64
    v_exp_f32 v55, v65
    v_mfma_f32_32x32x16_bf16 v[112:127], a[192:195], v[224:227], v[176:191]
    buffer_load_dwordx4 v40, s[20:23], s42 offen offset:0 lds
    v_exp_f32 v56, v66
    v_add_f32 v47, v54, v55
    s_waitcnt lgkmcnt(2)
    v_mfma_f32_32x32x16_bf16 v[96:111], a[196:199], v[196:199], v[96:111]
    ds_read_b128 a[216:219], v11 offset:41600
    s_add_u32 s76, s58, 0x1400000
    s_addc_u32 s77, s59, 0
    v_cvt_pk_bf16_f32 v128, v54, v55
    v_exp_f32 v57, v67
    v_add_f32 v47, v47, v56
    v_mfma_f32_32x32x16_bf16 v[112:127], a[196:199], v[228:231], v[112:127]
    buffer_load_dwordx4 v41, s[20:23], s42 offen offset:1040 lds
    v_exp_f32 v58, v68
    v_add_f32 v47, v47, v57
    v_mfma_f32_32x32x16_bf16 v[96:111], a[200:203], v[200:203], v[96:111]
    ds_read_b128 a[220:223], v11 offset:41632
    s_mov_b32 s78, 0x404000
    s_mov_b32 s79, 0x20000
    v_cvt_pk_bf16_f32 v129, v56, v57
    v_exp_f32 v59, v69
    v_add_f32 v47, v47, v58
    v_mfma_f32_32x32x16_bf16 v[112:127], a[200:203], v[232:235], v[112:127]
    buffer_load_dwordx4 v42, s[20:23], s42 offen offset:2080 lds
    v_exp_f32 v60, v70
    v_add_f32 v47, v47, v59
    v_mfma_f32_32x32x16_bf16 v[96:111], a[204:207], v[204:207], v[96:111]
    ds_read_b64_tr_b16 a[192:193], v16 offset:24960
    ds_read_b64_tr_b16 a[194:195], v16 offset:26000
    s_add_u32 s38, s41, 36864
    v_add_u32 v28, s38, v16
    v_cvt_pk_bf16_f32 v130, v58, v59
    v_exp_f32 v61, v71
    v_mfma_f32_32x32x16_bf16 v[112:127], a[204:207], v[236:239], v[112:127]
    buffer_load_dwordx4 v43, s[20:23], s42 offen offset:3120 lds
    v_add_f32 v47, v47, v60
    v_exp_f32 v54, v72
    s_waitcnt lgkmcnt(3)
    v_mfma_f32_32x32x16_bf16 v[96:111], a[208:211], v[208:211], v[96:111]
    ds_read_b64_tr_b16 a[196:197], v17 offset:24960
    ds_read_b64_tr_b16 a[198:199], v17 offset:26000
    v_add_u32 v29, s38, v17
    v_add_f32 v47, v47, v61
    v_cvt_pk_bf16_f32 v131, v60, v61
    v_exp_f32 v55, v73
    v_mfma_f32_32x32x16_bf16 v[112:127], a[208:211], v[240:243], v[112:127]
    v_add_u32 v30, s38, v18
    v_add_u32 v31, s38, v19
    v_add_f32 v47, v47, v54
    v_exp_f32 v56, v74
    v_add_f32 v47, v47, v55
    v_mfma_f32_32x32x16_bf16 v[96:111], a[212:215], v[212:215], v[96:111]
    ds_read_b64_tr_b16 a[200:201], v18 offset:24960
    ds_read_b64_tr_b16 a[202:203], v18 offset:26000
    v_cvt_pk_bf16_f32 v132, v54, v55
    v_exp_f32 v57, v75
    v_add_f32 v47, v47, v56
    v_mfma_f32_32x32x16_bf16 v[112:127], a[212:215], v[244:247], v[112:127]
    s_lshl_b32 s38, s2, 11
    s_mul_i32 s39, s32, 1052672
    v_exp_f32 v58, v76
    v_add_f32 v47, v47, v57
    v_cvt_pk_bf16_f32 v133, v56, v57
    v_mfma_f32_32x32x16_bf16 v[96:111], a[216:219], v[216:219], v[96:111]
    ds_read_b64_tr_b16 a[204:205], v19 offset:24960
    ds_read_b64_tr_b16 a[206:207], v19 offset:26000
    v_exp_f32 v59, v77
    v_add_f32 v47, v47, v58
    v_exp_f32 v60, v78
    v_mfma_f32_32x32x16_bf16 v[112:127], a[216:219], v[248:251], v[112:127]
    s_add_u32 s38, s38, s39
    s_add_u32 s39, s38, 526336
    v_add_f32 v47, v47, v59
    v_cvt_pk_bf16_f32 v134, v58, v59
    v_exp_f32 v61, v79
    s_waitcnt lgkmcnt(4)
    v_mfma_f32_32x32x16_bf16 v[96:111], a[220:223], v[220:223], v[96:111]
    ds_read_b64_tr_b16 a[208:209], v16 offset:29120
    ds_read_b64_tr_b16 a[210:211], v16 offset:30160
    v_add_f32 v47, v47, v60
    v_exp_f32 v54, v80
    v_add_f32 v47, v47, v61
    v_cvt_pk_bf16_f32 v135, v60, v61
    v_mfma_f32_32x32x16_bf16 v[112:127], a[220:223], v[252:255], v[112:127]
    s_waitcnt vmcnt(18)
    v_exp_f32 v55, v81
    v_exp_f32 v56, v82
    v_add_f32 v48, v54, v55
    v_mfma_f32_32x32x16_bf16 a[0:15], a[192:195], v[144:147], a[0:15]
    ds_read_b64_tr_b16 a[212:213], v17 offset:29120
    ds_read_b64_tr_b16 a[214:215], v17 offset:30160
    v_cvt_pk_bf16_f32 v136, v54, v55
    v_exp_f32 v57, v83
    v_add_f32 v48, v48, v56
    v_mfma_f32_32x32x16_bf16 a[64:79], a[192:195], v[152:155], a[64:79]
    ds_read_b64_tr_b16 a[152:153], v28
    ds_read_b64_tr_b16 a[154:155], v28 offset:1040
    v_exp_f32 v58, v84
    v_add_f32 v48, v48, v57
    v_cvt_pk_bf16_f32 v137, v56, v57
    v_mfma_f32_32x32x16_bf16 a[16:31], a[196:199], v[144:147], a[16:31]
    ds_read_b64_tr_b16 a[216:217], v18 offset:29120
    ds_read_b64_tr_b16 a[218:219], v18 offset:30160
    v_exp_f32 v59, v85
    v_add_f32 v48, v48, v58
    v_exp_f32 v60, v86
    v_mfma_f32_32x32x16_bf16 a[80:95], a[196:199], v[152:155], a[80:95]
    ds_read_b64_tr_b16 a[156:157], v29
    ds_read_b64_tr_b16 a[158:159], v29 offset:1040
    v_add_f32 v48, v48, v59
    v_cvt_pk_bf16_f32 v138, v58, v59
    v_exp_f32 v61, v87
    s_waitcnt lgkmcnt(8)
    v_mfma_f32_32x32x16_bf16 a[32:47], a[200:203], v[144:147], a[32:47]
    ds_read_b64_tr_b16 a[220:221], v19 offset:29120
    ds_read_b64_tr_b16 a[222:223], v19 offset:30160
    v_add_f32 v48, v48, v60
    v_exp_f32 v54, v88
    v_add_f32 v48, v48, v61
    v_cvt_pk_bf16_f32 v139, v60, v61
    v_mfma_f32_32x32x16_bf16 a[96:111], a[200:203], v[152:155], a[96:111]
    ds_read_b64_tr_b16 a[160:161], v30
    ds_read_b64_tr_b16 a[162:163], v30 offset:1040
    v_exp_f32 v55, v89
    v_add_f32 v48, v48, v54
    v_mfma_f32_32x32x16_bf16 a[48:63], a[204:207], v[144:147], a[48:63]
    s_waitcnt vmcnt(10)
    s_barrier
    ds_read_b128 a[192:195], v12 offset:0
    v_exp_f32 v56, v90
    v_add_f32 v48, v48, v55
    v_cvt_pk_bf16_f32 v140, v54, v55
    v_mfma_f32_32x32x16_bf16 a[112:127], a[204:207], v[152:155], a[112:127]
    ds_read_b64_tr_b16 a[164:165], v31
    v_exp_f32 v57, v91
    v_add_f32 v48, v48, v56
    v_exp_f32 v58, v92
    v_mfma_f32_32x32x16_bf16 a[0:15], a[208:211], v[148:151], a[0:15]
    ds_read_b128 a[196:199], v12 offset:32
    s_waitcnt lgkmcnt(14)
    ds_read_b64_tr_b16 a[166:167], v31 offset:1040
    v_add_f32 v48, v48, v57
    v_cvt_pk_bf16_f32 v141, v56, v57
    v_exp_f32 v59, v93
    v_add_f32 v48, v48, v58
    v_mfma_f32_32x32x16_bf16 a[64:79], a[208:211], v[156:159], a[64:79]
    s_waitcnt lgkmcnt(6)
    buffer_store_dwordx4 a[152:155], v44, s[76:79], s38 offen offset:0 sc1
    v_exp_f32 v60, v94
    v_add_f32 v48, v48, v59
    v_mfma_f32_32x32x16_bf16 a[16:31], a[212:215], v[148:151], a[16:31]
    ds_read_b128 a[200:203], v13 offset:0
    buffer_store_dwordx4 a[156:159], v44, s[76:79], s38 offen offset:1024 sc1
    v_cvt_pk_bf16_f32 v142, v58, v59
    v_exp_f32 v61, v95
    v_mfma_f32_32x32x16_bf16 a[80:95], a[212:215], v[156:159], a[80:95]
    s_waitcnt lgkmcnt(4)
    buffer_store_dwordx4 a[160:163], v44, s[76:79], s39 offen offset:0 sc1
    v_add_f32 v48, v48, v60
    v_mfma_f32_32x32x16_bf16 a[32:47], a[216:219], v[148:151], a[32:47]
    ds_read_b128 a[204:207], v13 offset:32
    s_waitcnt lgkmcnt(2)
    buffer_store_dwordx4 a[164:167], v44, s[76:79], s39 offen offset:1024 sc1
    v_mfma_f32_32x32x16_bf16 a[96:111], a[216:219], v[156:159], a[96:111]
    v_mfma_f32_32x32x16_bf16 a[48:63], a[220:223], v[148:151], a[48:63]
    ds_read_b128 a[208:211], v14 offset:0
    v_add_f32 v48, v48, v61
    v_cvt_pk_bf16_f32 v143, v60, v61
    v_max_f32 v62, v47, v48
    v_cmp_lt_f32 vcc, s36, v62
    v_mfma_f32_32x32x16_bf16 a[112:127], a[220:223], v[156:159], a[112:127]
    s_cbranch_vccnz L_stub1
L_back1:
    v_add_f32 v45, v45, v47
    v_add_f32 v46, v46, v48
    v_mfma_f32_32x32x16_bf16 v[64:79], a[192:195], v[192:195], v[160:175]
    ds_read_b128 a[212:215], v14 offset:32
    s_add_u32 s42, s44, 65536
    s_add_u32 m0, s33, 33280
    v_exp_f32 v54, v96
    v_exp_f32 v55, v97
    v_mfma_f32_32x32x16_bf16 v[80:95], a[192:195], v[224:227], v[176:191]
    buffer_load_dwordx4 v40, s[16:19], s42 offen offset:0 lds
    v_exp_f32 v56, v98
    v_add_f32 v47, v54, v55
    v_mfma_f32_32x32x16_bf16 v[64:79], a[196:199], v[196:199], v[64:79]
    ds_read_b128 a[216:219], v15 offset:0
    s_lshr_b32 s34, s2, 3
    v_cvt_pk_bf16_f32 v144, v54, v55
    v_exp_f32 v57, v99
    v_add_f32 v47, v47, v56
    v_mfma_f32_32x32x16_bf16 v[80:95], a[196:199], v[228:231], v[80:95]
    buffer_load_dwordx4 v41, s[16:19], s42 offen offset:1040 lds
    v_exp_f32 v58, v100
    v_add_f32 v47, v47, v57
    s_waitcnt lgkmcnt(2)
    v_mfma_f32_32x32x16_bf16 v[64:79], a[200:203], v[200:203], v[64:79]
    ds_read_b128 a[220:223], v15 offset:32
    s_and_b32 s35, s34, 3
    s_lshr_b32 s7, s34, 2
    v_cvt_pk_bf16_f32 v145, v56, v57
    v_exp_f32 v59, v101
    v_add_f32 v47, v47, v58
    v_mfma_f32_32x32x16_bf16 v[80:95], a[200:203], v[232:235], v[80:95]
    buffer_load_dwordx4 v42, s[16:19], s42 offen offset:2080 lds
    v_exp_f32 v60, v102
    v_add_f32 v47, v47, v59
    v_mfma_f32_32x32x16_bf16 v[64:79], a[204:207], v[204:207], v[64:79]
    ds_read_b64_tr_b16 a[192:193], v16 offset:49920
    ds_read_b64_tr_b16 a[194:195], v16 offset:50960
    s_lshl_b32 s6, s46, 2
    s_add_u32 s6, s6, s35
    v_cvt_pk_bf16_f32 v146, v58, v59
    v_exp_f32 v61, v103
    v_mfma_f32_32x32x16_bf16 v[80:95], a[204:207], v[236:239], v[80:95]
    buffer_load_dwordx4 v43, s[16:19], s42 offen offset:3120 lds
    v_add_f32 v47, v47, v60
    v_exp_f32 v54, v104
    v_mfma_f32_32x32x16_bf16 v[64:79], a[208:211], v[208:211], v[64:79]
    ds_read_b64_tr_b16 a[196:197], v17 offset:49920
    ds_read_b64_tr_b16 a[198:199], v17 offset:50960
    s_mul_i32 s34, s6, 526336
    v_add_f32 v47, v47, v61
    v_cvt_pk_bf16_f32 v147, v60, v61
    v_exp_f32 v55, v105
    v_mfma_f32_32x32x16_bf16 v[80:95], a[208:211], v[240:243], v[80:95]
    s_lshl_b32 s35, s32, 16
    s_add_u32 s34, s34, s35
    v_add_f32 v47, v47, v54
    v_exp_f32 v56, v106
    v_add_f32 v47, v47, v55
    s_waitcnt lgkmcnt(4)
    v_mfma_f32_32x32x16_bf16 v[64:79], a[212:215], v[212:215], v[64:79]
    ds_read_b64_tr_b16 a[200:201], v18 offset:49920
    ds_read_b64_tr_b16 a[202:203], v18 offset:50960
    v_cvt_pk_bf16_f32 v148, v54, v55
    v_exp_f32 v57, v107
    v_add_f32 v47, v47, v56
    v_mfma_f32_32x32x16_bf16 v[80:95], a[212:215], v[244:247], v[80:95]
    s_add_u32 s8, s58, 0x200000
    s_addc_u32 s9, s59, 0
    v_exp_f32 v58, v108
    v_add_f32 v47, v47, v57
    v_cvt_pk_bf16_f32 v149, v56, v57
    v_mfma_f32_32x32x16_bf16 v[64:79], a[216:219], v[216:219], v[64:79]
    ds_read_b64_tr_b16 a[204:205], v19 offset:49920
    ds_read_b64_tr_b16 a[206:207], v19 offset:50960
    s_add_u32 s8, s8, s34
    s_addc_u32 s9, s9, 0
    v_exp_f32 v59, v109
    v_add_f32 v47, v47, v58
    v_mfma_f32_32x32x16_bf16 v[80:95], a[216:219], v[248:251], v[80:95]
    s_mov_b32 s10, 0x10000
    s_mov_b32 s11, 0x20000
    v_exp_f32 v60, v110
    v_add_f32 v47, v47, v59
    v_cvt_pk_bf16_f32 v150, v58, v59
    v_mfma_f32_32x32x16_bf16 v[64:79], a[220:223], v[220:223], v[64:79]
    ds_read_b64_tr_b16 a[208:209], v16 offset:54080
    ds_read_b64_tr_b16 a[210:211], v16 offset:55120
    v_exp_f32 v61, v111
    v_add_f32 v47, v47, v60
    v_exp_f32 v54, v112
    v_mfma_f32_32x32x16_bf16 v[80:95], a[220:223], v[252:255], v[80:95]
    s_lshl_b32 s6, s6, 6
    v_add_f32 v47, v47, v61
    v_cvt_pk_bf16_f32 v151, v60, v61
    v_exp_f32 v55, v113
    s_waitcnt lgkmcnt(4)
    v_mfma_f32_32x32x16_bf16 a[0:15], a[192:195], v[128:131], a[0:15]
    ds_read_b64_tr_b16 a[212:213], v17 offset:54080
    ds_read_b64_tr_b16 a[214:215], v17 offset:55120
    v_exp_f32 v56, v114
    v_add_f32 v48, v54, v55
    v_cvt_pk_bf16_f32 v152, v54, v55
    v_mfma_f32_32x32x16_bf16 a[64:79], a[192:195], v[136:139], a[64:79]
    s_lshl_b32 s50, s32, 11
    s_and_b32 s53, s7, 0
    v_exp_f32 v57, v115
    v_add_f32 v48, v48, v56
    v_mfma_f32_32x32x16_bf16 a[16:31], a[196:199], v[128:131], a[16:31]
    ds_read_b64_tr_b16 a[216:217], v18 offset:54080
    ds_read_b64_tr_b16 a[218:219], v18 offset:55120
    v_exp_f32 v58, v116
    v_add_f32 v48, v48, v57
    v_cvt_pk_bf16_f32 v153, v56, v57
    v_mfma_f32_32x32x16_bf16 a[80:95], a[196:199], v[136:139], a[80:95]
    s_mul_i32 s53, s53, 8
    s_add_u32 s53, s53, s46
    v_exp_f32 v59, v117
    v_add_f32 v48, v48, v58
    v_mfma_f32_32x32x16_bf16 a[32:47], a[200:203], v[128:131], a[32:47]
    ds_read_b64_tr_b16 a[220:221], v19 offset:54080
    ds_read_b64_tr_b16 a[222:223], v19 offset:55120
    v_exp_f32 v60, v118
    v_add_f32 v48, v48, v59
    v_cvt_pk_bf16_f32 v154, v58, v59
    v_mfma_f32_32x32x16_bf16 a[96:111], a[200:203], v[136:139], a[96:111]
    s_and_b32 s53, s53, 7
    v_exp_f32 v61, v119
    v_add_f32 v48, v48, v60
    v_exp_f32 v54, v120
    s_waitcnt lgkmcnt(4)
    v_mfma_f32_32x32x16_bf16 a[48:63], a[204:207], v[128:131], a[48:63]
    ds_read_b128 a[192:195], v12 offset:8320
    s_mul_i32 s35, s7, 526336
    v_add_f32 v48, v48, v61
    v_cvt_pk_bf16_f32 v155, v60, v61
    v_exp_f32 v55, v121
    v_add_f32 v48, v48, v54
    v_mfma_f32_32x32x16_bf16 a[112:127], a[204:207], v[136:139], a[112:127]
    s_add_u32 s34, s45, s35
    v_exp_f32 v56, v122
    v_add_f32 v48, v48, v55
    v_cvt_pk_bf16_f32 v156, v54, v55
    v_mfma_f32_32x32x16_bf16 a[0:15], a[208:211], v[132:135], a[0:15]
    ds_read_b128 a[196:199], v12 offset:8352
    s_add_u32 s76, s76, s34
    s_addc_u32 s77, s77, 0
    v_exp_f32 v57, v123
    v_add_f32 v48, v48, v56
    v_mfma_f32_32x32x16_bf16 a[64:79], a[208:211], v[140:143], a[64:79]
    s_mov_b32 s78, 131072
    v_exp_f32 v58, v124
    v_add_f32 v48, v48, v57
    v_cvt_pk_bf16_f32 v157, v56, v57
    v_mfma_f32_32x32x16_bf16 a[16:31], a[212:215], v[132:135], a[16:31]
    ds_read_b128 a[200:203], v13 offset:8320
    s_lshl_b32 s51, s53, 14
    v_exp_f32 v59, v125
    v_add_f32 v48, v48, v58
    v_exp_f32 v60, v126
    v_mfma_f32_32x32x16_bf16 a[80:95], a[212:215], v[140:143], a[80:95]
    s_lshl_b32 s52, s53, 13
    v_add_f32 v48, v48, v59
    v_cvt_pk_bf16_f32 v158, v58, v59
    v_exp_f32 v61, v127
    v_add_f32 v48, v48, v60
    s_waitcnt lgkmcnt(2)
    v_mfma_f32_32x32x16_bf16 a[32:47], a[216:219], v[132:135], a[32:47]
    ds_read_b128 a[204:207], v13 offset:8352
    s_and_b32 s34, s32, 1
    v_mfma_f32_32x32x16_bf16 a[96:111], a[216:219], v[140:143], a[96:111]
    v_mfma_f32_32x32x16_bf16 a[48:63], a[220:223], v[132:135], a[48:63]
    ds_read_b128 a[208:211], v14 offset:8320
    v_add_f32 v48, v48, v61
    v_cvt_pk_bf16_f32 v159, v60, v61
    v_max_f32 v62, v47, v48
    v_cmp_lt_f32 vcc, s36, v62
    v_mfma_f32_32x32x16_bf16 a[112:127], a[220:223], v[140:143], a[112:127]
    s_cbranch_vccnz L_stub2
L_back2:
    v_add_f32 v45, v45, v47
    v_add_f32 v46, v46, v48
    v_mfma_f32_32x32x16_bf16 v[96:111], a[192:195], v[192:195], v[160:175]
    ds_read_b128 a[212:215], v14 offset:8352
    s_add_u32 s42, s44, 49152
    s_add_u32 m0, s33, 99840
    v_exp_f32 v54, v64
    v_exp_f32 v55, v65
    v_mfma_f32_32x32x16_bf16 v[112:127], a[192:195], v[224:227], v[176:191]
    buffer_load_dwordx4 v40, s[20:23], s42 offen offset:0 lds
    v_exp_f32 v56, v66
    v_add_f32 v47, v54, v55
    v_cvt_pk_bf16_f32 v128, v54, v55
    s_waitcnt lgkmcnt(3)
    v_mfma_f32_32x32x16_bf16 v[96:111], a[196:199], v[196:199], v[96:111]
    ds_read_b128 a[216:219], v15 offset:8320
    s_lshl_b32 s34, s34, 10
    v_exp_f32 v57, v67
    v_add_f32 v47, v47, v56
    v_exp_f32 v58, v68
    v_mfma_f32_32x32x16_bf16 v[112:127], a[196:199], v[228:231], v[112:127]
    buffer_load_dwordx4 v41, s[20:23], s42 offen offset:1040 lds
    v_add_f32 v47, v47, v57
    v_cvt_pk_bf16_f32 v129, v56, v57
    v_exp_f32 v59, v69
    v_mfma_f32_32x32x16_bf16 v[96:111], a[200:203], v[200:203], v[96:111]
    ds_read_b128 a[220:223], v15 offset:8352
    v_add_u32 v24, s34, v44
    v_xor_b32 v25, 1024, v24
    v_add_f32 v47, v47, v58
    v_exp_f32 v60, v70
    v_add_f32 v47, v47, v59
    v_mfma_f32_32x32x16_bf16 v[112:127], a[200:203], v[232:235], v[112:127]
    buffer_load_dwordx4 v42, s[20:23], s42 offen offset:2080 lds
    v_cvt_pk_bf16_f32 v130, v58, v59
    v_exp_f32 v61, v71
    v_add_f32 v47, v47, v60
    s_waitcnt lgkmcnt(2)
    v_mfma_f32_32x32x16_bf16 v[96:111], a[204:207], v[204:207], v[96:111]
    ds_read_b64_tr_b16 a[192:193], v16 offset:58240
    ds_read_b64_tr_b16 a[194:195], v16 offset:59280
    s_lshr_b32 s34, s2, 3
    s_mul_i32 s5, s46, 22
    v_exp_f32 v54, v72
    v_add_f32 v47, v47, v61
    v_mfma_f32_32x32x16_bf16 v[112:127], a[204:207], v[236:239], v[112:127]
    buffer_load_dwordx4 v43, s[20:23], s42 offen offset:3120 lds
    s_add_u32 s5, s5, s34
    v_cvt_pk_bf16_f32 v131, v60, v61
    v_exp_f32 v55, v73
    v_mfma_f32_32x32x16_bf16 v[96:111], a[208:211], v[208:211], v[96:111]
    ds_read_b64_tr_b16 a[196:197], v17 offset:58240
    ds_read_b64_tr_b16 a[198:199], v17 offset:59280
    s_add_u32 s42, s44, 65536
    s_add_u32 m0, s33, 16640
    v_add_f32 v47, v47, v54
    v_exp_f32 v56, v74
    v_mfma_f32_32x32x16_bf16 v[112:127], a[208:211], v[240:243], v[112:127]
    buffer_load_dwordx4 v40, s[20:23], s42 offen offset:0 lds
    s_cmp_lt_u32 s34, 22
    s_cselect_b32 s5, s5, 0x1000
    v_add_f32 v47, v47, v55
    v_cvt_pk_bf16_f32 v132, v54, v55
    v_mfma_f32_32x32x16_bf16 v[96:111], a[212:215], v[212:215], v[96:111]
    ds_read_b64_tr_b16 a[200:201], v18 offset:58240
    ds_read_b64_tr_b16 a[202:203], v18 offset:59280
    s_cmp_lt_u32 s5, 172
    s_cselect_b32 s5, s5, 0x1000
    v_exp_f32 v57, v75
    v_add_f32 v47, v47, v56
    v_mfma_f32_32x32x16_bf16 v[112:127], a[212:215], v[244:247], v[112:127]
    buffer_load_dwordx4 v41, s[20:23], s42 offen offset:1040 lds
    s_lshl_b32 s54, s5, 4
    v_exp_f32 v58, v76
    v_add_f32 v47, v47, v57
    s_waitcnt lgkmcnt(4)
    v_mfma_f32_32x32x16_bf16 v[96:111], a[216:219], v[216:219], v[96:111]
    ds_read_b64_tr_b16 a[204:205], v19 offset:58240
    ds_read_b64_tr_b16 a[206:207], v19 offset:59280
    s_cmp_lt_u32 s5, 172
    s_cselect_b32 s54, s54, 1073741824
    v_cvt_pk_bf16_f32 v133, v56, v57
    v_exp_f32 v59, v77
    v_mfma_f32_32x32x16_bf16 v[112:127], a[216:219], v[248:251], v[112:127]
    buffer_load_dwordx4 v42, s[20:23], s42 offen offset:2080 lds
    s_movk_i32 s35, 5504
    v_add_f32 v47, v47, v58
    v_exp_f32 v60, v78
    v_mfma_f32_32x32x16_bf16 v[96:111], a[220:223], v[220:223], v[96:111]
    ds_read_b64_tr_b16 a[208:209], v16 offset:62400
    ds_read_b64_tr_b16 a[210:211], v16 offset:63440
    v_mul_lo_u32 v52, v0, s35
    v_lshlrev_b32 v53, 2, v0
    v_add_f32 v47, v47, v59
    v_cvt_pk_bf16_f32 v134, v58, v59
    v_mfma_f32_32x32x16_bf16 v[112:127], a[220:223], v[252:255], v[112:127]
    buffer_load_dwordx4 v43, s[20:23], s42 offen offset:3120 lds
    v_exp_f32 v61, v79
    v_add_f32 v47, v47, v60
    v_mfma_f32_32x32x16_bf16 a[0:15], a[192:195], v[144:147], a[0:15]
    ds_read_b64_tr_b16 a[212:213], v17 offset:62400
    ds_read_b64_tr_b16 a[214:215], v17 offset:63440
    s_lshl_b32 s55, s5, 13
    v_exp_f32 v54, v80
    v_add_f32 v47, v47, v61
    v_cvt_pk_bf16_f32 v135, v60, v61
    v_mfma_f32_32x32x16_bf16 a[64:79], a[192:195], v[152:155], a[64:79]
    s_lshr_b32 s34, s2, 3
    s_mul_i32 s34, s34, 44032
    v_exp_f32 v55, v81
    v_exp_f32 v56, v82
    v_add_f32 v48, v54, v55
    s_waitcnt lgkmcnt(4)
    v_mfma_f32_32x32x16_bf16 a[16:31], a[196:199], v[144:147], a[16:31]
    ds_read_b64_tr_b16 a[216:217], v18 offset:62400
    ds_read_b64_tr_b16 a[218:219], v18 offset:63440
    v_cvt_pk_bf16_f32 v136, v54, v55
    v_exp_f32 v57, v83
    v_add_f32 v48, v48, v56
    v_mfma_f32_32x32x16_bf16 a[80:95], a[196:199], v[152:155], a[80:95]
    s_mul_i32 s35, s46, 352
    s_add_u32 s34, s34, s35
    v_exp_f32 v58, v84
    v_add_f32 v48, v48, v57
    v_cvt_pk_bf16_f32 v137, v56, v57
    v_mfma_f32_32x32x16_bf16 a[32:47], a[200:203], v[144:147], a[32:47]
    ds_read_b64_tr_b16 a[220:221], v19 offset:62400
    ds_read_b64_tr_b16 a[222:223], v19 offset:63440
    v_exp_f32 v59, v85
    v_add_f32 v48, v48, v58
    v_exp_f32 v60, v86
    v_mfma_f32_32x32x16_bf16 a[96:111], a[200:203], v[152:155], a[96:111]
    v_lshrrev_b32 v4, 2, v2
    v_mul_u32_u24 v4, 2752, v4
    v_add_f32 v48, v48, v59
    v_cvt_pk_bf16_f32 v138, v58, v59
    v_exp_f32 v61, v87
    v_add_f32 v48, v48, v60
    v_mfma_f32_32x32x16_bf16 a[48:63], a[204:207], v[144:147], a[48:63]
    s_waitcnt vmcnt(22)
    s_waitcnt vmcnt(16)
    s_waitcnt vmcnt(12)
    s_barrier
    ds_read_b128 a[192:195], v8 offset:0
    v_exp_f32 v54, v88
    v_add_f32 v48, v48, v61
    v_cvt_pk_bf16_f32 v139, v60, v61
    v_mfma_f32_32x32x16_bf16 a[112:127], a[204:207], v[152:155], a[112:127]
    v_and_b32 v5, 3, v2
    v_exp_f32 v55, v89
    v_add_f32 v48, v48, v54
    v_exp_f32 v56, v90
    v_add_f32 v48, v48, v55
    s_waitcnt lgkmcnt(3)
    v_mfma_f32_32x32x16_bf16 a[0:15], a[208:211], v[148:151], a[0:15]
    ds_read_b128 a[196:199], v8 offset:32
    v_lshl_add_u32 v4, v5, 7, v4
    v_cvt_pk_bf16_f32 v140, v54, v55
    v_exp_f32 v57, v91
    v_add_f32 v48, v48, v56
    v_mfma_f32_32x32x16_bf16 a[64:79], a[208:211], v[156:159], a[64:79]
    s_cmp_eq_u32 s32, 0
    s_cselect_b32 s35, s34, 1073741824
    v_exp_f32 v58, v92
    v_add_f32 v48, v48, v57
    v_cvt_pk_bf16_f32 v141, v56, v57
    v_mfma_f32_32x32x16_bf16 a[16:31], a[212:215], v[148:151], a[16:31]
    ds_read_b128 a[200:203], v9 offset:0
    buffer_load_dword a170, v4, s[80:83], s35 offen
    v_exp_f32 v59, v93
    v_add_f32 v48, v48, v58
    v_mfma_f32_32x32x16_bf16 a[80:95], a[212:215], v[156:159], a[80:95]
    s_cmp_eq_u32 s32, 1
    s_cselect_b32 s35, s34, 1073741824
    v_exp_f32 v60, v94
    v_add_f32 v48, v48, v59
    v_cvt_pk_bf16_f32 v142, v58, v59
    v_mfma_f32_32x32x16_bf16 a[32:47], a[216:219], v[148:151], a[32:47]
    ds_read_b128 a[204:207], v9 offset:32
    buffer_load_dword a171, v4, s[84:87], s35 offen
    s_and_b32 s62, s2, 3
    s_lshl_b32 s62, s62, 3
    s_lshl_b32 s62, 2, s62
    v_mov_b32 v5, s62
    s_and_b32 s62, s2, 0xfc
    buffer_atomic_or v5, v49, s[72:75], s62 offen
    v_mfma_f32_32x32x16_bf16 a[96:111], a[216:219], v[156:159], a[96:111]
    v_exp_f32 v61, v95
    v_add_f32 v48, v48, v60
    s_waitcnt lgkmcnt(2)
    v_mfma_f32_32x32x16_bf16 a[48:63], a[220:223], v[148:151], a[48:63]
    ds_read_b128 a[208:211], v10 offset:0
    v_add_f32 v48, v48, v61
    v_cvt_pk_bf16_f32 v143, v60, v61
    v_max_f32 v62, v47, v48
    v_cmp_lt_f32 vcc, s36, v62
    v_mfma_f32_32x32x16_bf16 a[112:127], a[220:223], v[156:159], a[112:127]
    s_cbranch_vccnz L_stub3
L_back3:
    v_add_f32 v45, v45, v47
    v_add_f32 v46, v46, v48
    v_mfma_f32_32x32x16_bf16 v[64:79], a[192:195], v[192:195], v[160:175]
    ds_read_b128 a[212:215], v10 offset:32
    s_add_u32 s42, s44, 81920
    s_add_u32 m0, s33, 66560
    v_exp_f32 v54, v96
    v_exp_f32 v55, v97
    v_mfma_f32_32x32x16_bf16 v[80:95], a[192:195], v[224:227], v[176:191]
    buffer_load_dwordx4 v40, s[16:19], s42 offen offset:0 lds
    v_exp_f32 v56, v98
    v_add_f32 v47, v54, v55
    v_mfma_f32_32x32x16_bf16 v[64:79], a[196:199], v[196:199], v[64:79]
    ds_read_b128 a[216:219], v11 offset:0
    v_mov_b32 v28, 1073741824
    v_cvt_pk_bf16_f32 v144, v54, v55
    v_exp_f32 v57, v99
    v_add_f32 v47, v47, v56
    v_mfma_f32_32x32x16_bf16 v[80:95], a[196:199], v[228:231], v[80:95]
    buffer_load_dwordx4 v41, s[16:19], s42 offen offset:1040 lds
    v_exp_f32 v58, v100
    v_add_f32 v47, v47, v57
    s_waitcnt lgkmcnt(2)
    v_mfma_f32_32x32x16_bf16 v[64:79], a[200:203], v[200:203], v[64:79]
    ds_read_b128 a[220:223], v11 offset:32
    v_lshlrev_b32 v27, 2, v0
    v_cvt_pk_bf16_f32 v145, v56, v57
    v_exp_f32 v59, v101
    v_add_f32 v47, v47, v58
    v_mfma_f32_32x32x16_bf16 v[80:95], a[200:203], v[232:235], v[80:95]
    buffer_load_dwordx4 v42, s[16:19], s42 offen offset:2080 lds
    v_exp_f32 v60, v102
    v_add_f32 v47, v47, v59
    v_mfma_f32_32x32x16_bf16 v[64:79], a[204:207], v[204:207], v[64:79]
    ds_read_b64_tr_b16 a[192:193], v20 offset:16640
    ds_read_b64_tr_b16 a[194:195], v20 offset:17680
    v_cmp_gt_u32 vcc, 64, v0
    s_nop 1
    v_cndmask_b32 v27, v28, v27, vcc
    v_cvt_pk_bf16_f32 v146, v58, v59
    v_mfma_f32_32x32x16_bf16 v[80:95], a[204:207], v[236:239], v[80:95]
    buffer_load_dwordx4 v43, s[16:19], s42 offen offset:3120 lds
    v_exp_f32 v61, v103
    v_add_f32 v47, v47, v60
    v_mfma_f32_32x32x16_bf16 v[64:79], a[208:211], v[208:211], v[64:79]
    ds_read_b64_tr_b16 a[196:197], v21 offset:16640
    ds_read_b64_tr_b16 a[198:199], v21 offset:17680
    v_exp_f32 v54, v104
    v_add_f32 v47, v47, v61
    v_cvt_pk_bf16_f32 v147, v60, v61
    v_mfma_f32_32x32x16_bf16 v[80:95], a[208:211], v[240:243], v[80:95]
    s_mul_i32 s49, s49, 3
    v_exp_f32 v55, v105
    v_add_f32 v47, v47, v54
    v_exp_f32 v56, v106
    s_waitcnt lgkmcnt(4)
    v_mfma_f32_32x32x16_bf16 v[64:79], a[212:215], v[212:215], v[64:79]
    ds_read_b64_tr_b16 a[200:201], v22 offset:16640
    ds_read_b64_tr_b16 a[202:203], v22 offset:17680
    v_add_f32 v47, v47, v55
    v_cvt_pk_bf16_f32 v148, v54, v55
    v_exp_f32 v57, v107
    v_add_f32 v47, v47, v56
    v_mfma_f32_32x32x16_bf16 v[80:95], a[212:215], v[244:247], v[80:95]
    buffer_load_dword a144, v53, s[88:91], s55 offen offset:0
    v_exp_f32 v58, v108
    v_add_f32 v47, v47, v57
    v_mfma_f32_32x32x16_bf16 v[64:79], a[216:219], v[216:219], v[64:79]
    ds_read_b64_tr_b16 a[204:205], v23 offset:16640
    ds_read_b64_tr_b16 a[206:207], v23 offset:17680
    buffer_load_dword a145, v53, s[88:91], s55 offen offset:1024
    v_cvt_pk_bf16_f32 v149, v56, v57
    v_mfma_f32_32x32x16_bf16 v[80:95], a[216:219], v[248:251], v[80:95]
    v_max3_u32 v50, v32, v33, v34
    v_exp_f32 v59, v109
    v_add_f32 v47, v47, v58
    v_exp_f32 v60, v110
    v_mfma_f32_32x32x16_bf16 v[64:79], a[220:223], v[220:223], v[64:79]
    ds_read_b64_tr_b16 a[208:209], v20 offset:20800
    ds_read_b64_tr_b16 a[210:211], v20 offset:21840
    v_add_f32 v47, v47, v59
    v_cvt_pk_bf16_f32 v150, v58, v59
    v_exp_f32 v61, v111
    v_add_f32 v47, v47, v60
    v_mfma_f32_32x32x16_bf16 v[80:95], a[220:223], v[252:255], v[80:95]
    v_max3_u32 v50, v50, v35, v36
    v_exp_f32 v54, v112
    v_add_f32 v47, v47, v61
    v_cvt_pk_bf16_f32 v151, v60, v61
    s_waitcnt lgkmcnt(4)
    v_mfma_f32_32x32x16_bf16 a[0:15], a[192:195], v[128:131], a[0:15]
    ds_read_b64_tr_b16 a[212:213], v21 offset:20800
    ds_read_b64_tr_b16 a[214:215], v21 offset:21840
    v_exp_f32 v55, v113
    v_exp_f32 v56, v114
    v_add_f32 v48, v54, v55
    v_mfma_f32_32x32x16_bf16 a[64:79], a[192:195], v[136:139], a[64:79]
    v_max3_u32 v50, v50, v37, v38
    v_cvt_pk_bf16_f32 v152, v54, v55
    v_exp_f32 v57, v115
    v_add_f32 v48, v48, v56
    v_mfma_f32_32x32x16_bf16 a[16:31], a[196:199], v[128:131], a[16:31]
    ds_read_b64_tr_b16 a[216:217], v22 offset:20800
    ds_read_b64_tr_b16 a[218:219], v22 offset:21840
    v_exp_f32 v58, v116
    v_add_f32 v48, v48, v57
    v_cvt_pk_bf16_f32 v153, v56, v57
    v_mfma_f32_32x32x16_bf16 a[80:95], a[196:199], v[136:139], a[80:95]
    v_max_u32 v50, v50, v39
    v_exp_f32 v59, v117
    v_add_f32 v48, v48, v58
    v_exp_f32 v60, v118
    v_mfma_f32_32x32x16_bf16 a[32:47], a[200:203], v[128:131], a[32:47]
    ds_read_b64_tr_b16 a[220:221], v23 offset:20800
    ds_read_b64_tr_b16 a[222:223], v23 offset:21840
    v_add_f32 v48, v48, v59
    v_cvt_pk_bf16_f32 v154, v58, v59
    v_exp_f32 v61, v119
    v_add_f32 v48, v48, v60
    v_mfma_f32_32x32x16_bf16 a[96:111], a[200:203], v[136:139], a[96:111]
    buffer_load_dwordx4 v[32:35], v44, s[28:31], s43 offen offset:2048 sc1
    v_exp_f32 v54, v120
    v_add_f32 v48, v48, v61
    s_waitcnt lgkmcnt(4)
    v_mfma_f32_32x32x16_bf16 a[48:63], a[204:207], v[128:131], a[48:63]
    ds_read_b128 a[192:195], v8 offset:8320
    v_cvt_pk_bf16_f32 v155, v60, v61
    v_exp_f32 v55, v121
    v_add_f32 v48, v48, v54
    v_exp_f32 v56, v122
    v_mfma_f32_32x32x16_bf16 a[112:127], a[204:207], v[136:139], a[112:127]
    buffer_load_dwordx4 v[36:39], v44, s[28:31], s43 offen offset:3072 sc1
    v_add_f32 v48, v48, v55
    v_cvt_pk_bf16_f32 v156, v54, v55
    v_mfma_f32_32x32x16_bf16 a[0:15], a[208:211], v[132:135], a[0:15]
    ds_read_b128 a[196:199], v8 offset:8352
    v_exp_f32 v57, v123
    v_add_f32 v48, v48, v56
    v_exp_f32 v58, v124
    v_add_f32 v48, v48, v57
    v_mfma_f32_32x32x16_bf16 a[64:79], a[208:211], v[140:143], a[64:79]
    s_mov_b32 s39, 4096
    v_cvt_pk_bf16_f32 v157, v56, v57
    v_exp_f32 v59, v125
    v_add_f32 v48, v48, v58
    v_mfma_f32_32x32x16_bf16 a[16:31], a[212:215], v[132:135], a[16:31]
    ds_read_b128 a[200:203], v9 offset:8320
    v_exp_f32 v60, v126
    v_add_f32 v48, v48, v59
    v_cvt_pk_bf16_f32 v158, v58, v59
    v_exp_f32 v61, v127
    v_mfma_f32_32x32x16_bf16 a[80:95], a[212:215], v[140:143], a[80:95]
    s_mov_b32 s40, 263168
    v_add_f32 v48, v48, v60
    s_waitcnt lgkmcnt(2)
    v_mfma_f32_32x32x16_bf16 a[32:47], a[216:219], v[132:135], a[32:47]
    ds_read_b128 a[204:207], v9 offset:8352
    s_mov_b32 s45, 267264
    v_mfma_f32_32x32x16_bf16 a[96:111], a[216:219], v[140:143], a[96:111]
    v_mfma_f32_32x32x16_bf16 a[48:63], a[220:223], v[132:135], a[48:63]
    ds_read_b128 a[208:211], v10 offset:8320
    v_add_f32 v48, v48, v61
    v_cvt_pk_bf16_f32 v159, v60, v61
    v_max_f32 v62, v47, v48
    v_cmp_lt_f32 vcc, s36, v62
    v_mfma_f32_32x32x16_bf16 a[112:127], a[220:223], v[140:143], a[112:127]
    s_cbranch_vccnz L_stub4
L_back4:
    v_add_f32 v45, v45, v47
    v_add_f32 v46, v46, v48
    v_mfma_f32_32x32x16_bf16 v[96:111], a[192:195], v[192:195], v[160:175]
    ds_read_b128 a[212:215], v10 offset:8352
    s_add_u32 s42, s44, 81920
    s_add_u32 m0, s33, 49920
    v_exp_f32 v54, v64
    v_mfma_f32_32x32x16_bf16 v[112:127], a[192:195], v[224:227], v[176:191]
    buffer_load_dwordx4 v40, s[20:23], s42 offen offset:0 lds
    v_exp_f32 v55, v65
    s_waitcnt lgkmcnt(3)
    v_mfma_f32_32x32x16_bf16 v[96:111], a[196:199], v[196:199], v[96:111]
    ds_read_b128 a[216:219], v11 offset:8320
    v_exp_f32 v56, v66
    v_add_f32 v47, v54, v55
    v_cvt_pk_bf16_f32 v128, v54, v55
    v_mfma_f32_32x32x16_bf16 v[112:127], a[196:199], v[228:231], v[112:127]
    buffer_load_dwordx4 v41, s[20:23], s42 offen offset:1040 lds
    v_exp_f32 v57, v67
    v_mfma_f32_32x32x16_bf16 v[96:111], a[200:203], v[200:203], v[96:111]
    ds_read_b128 a[220:223], v11 offset:8352
    v_add_f32 v47, v47, v56
    v_exp_f32 v58, v68
    v_add_f32 v47, v47, v57
    v_cvt_pk_bf16_f32 v129, v56, v57
    v_mfma_f32_32x32x16_bf16 v[112:127], a[200:203], v[232:235], v[112:127]
    buffer_load_dwordx4 v42, s[20:23], s42 offen offset:2080 lds
    v_exp_f32 v59, v69
    s_waitcnt lgkmcnt(3)
    v_mfma_f32_32x32x16_bf16 v[96:111], a[204:207], v[204:207], v[96:111]
    ds_read_b64_tr_b16 a[192:193], v20 offset:24960
    ds_read_b64_tr_b16 a[194:195], v20 offset:26000
    v_add_f32 v47, v47, v58
    v_exp_f32 v60, v70
    v_add_f32 v47, v47, v59
    v_mfma_f32_32x32x16_bf16 v[112:127], a[204:207], v[236:239], v[112:127]
    buffer_load_dwordx4 v43, s[20:23], s42 offen offset:3120 lds
    v_cvt_pk_bf16_f32 v130, v58, v59
    v_mfma_f32_32x32x16_bf16 v[96:111], a[208:211], v[208:211], v[96:111]
    ds_read_b64_tr_b16 a[196:197], v21 offset:24960
    ds_read_b64_tr_b16 a[198:199], v21 offset:26000
    v_exp_f32 v61, v71
    v_add_f32 v47, v47, v60
    v_mfma_f32_32x32x16_bf16 v[112:127], a[208:211], v[240:243], v[112:127]
    buffer_load_dword a146, v53, s[88:91], s55 offen offset:2048
    v_exp_f32 v54, v72
    s_waitcnt lgkmcnt(4)
    v_mfma_f32_32x32x16_bf16 v[96:111], a[212:215], v[212:215], v[96:111]
    ds_read_b64_tr_b16 a[200:201], v22 offset:24960
    ds_read_b64_tr_b16 a[202:203], v22 offset:26000
    v_add_f32 v47, v47, v61
    v_cvt_pk_bf16_f32 v131, v60, v61
    v_exp_f32 v55, v73
    v_mfma_f32_32x32x16_bf16 v[112:127], a[212:215], v[244:247], v[112:127]
    v_add_f32 v47, v47, v54
    v_exp_f32 v56, v74
    v_add_f32 v47, v47, v55
    v_cvt_pk_bf16_f32 v132, v54, v55
    v_mfma_f32_32x32x16_bf16 v[96:111], a[216:219], v[216:219], v[96:111]
    ds_read_b64_tr_b16 a[204:205], v23 offset:24960
    ds_read_b64_tr_b16 a[206:207], v23 offset:26000
    v_exp_f32 v57, v75
    v_add_f32 v47, v47, v56
    v_mfma_f32_32x32x16_bf16 v[112:127], a[216:219], v[248:251], v[112:127]
    v_exp_f32 v58, v76
    v_add_f32 v47, v47, v57
    v_cvt_pk_bf16_f32 v133, v56, v57
    v_mfma_f32_32x32x16_bf16 v[96:111], a[220:223], v[220:223], v[96:111]
    ds_read_b64_tr_b16 a[208:209], v20 offset:29120
    ds_read_b64_tr_b16 a[210:211], v20 offset:30160
    v_exp_f32 v59, v77
    v_add_f32 v47, v47, v58
    v_mfma_f32_32x32x16_bf16 v[112:127], a[220:223], v[252:255], v[112:127]
    buffer_load_dword a147, v53, s[88:91], s55 offen offset:3072
    v_exp_f32 v60, v78
    s_waitcnt lgkmcnt(4)
    v_mfma_f32_32x32x16_bf16 a[0:15], a[192:195], v[144:147], a[0:15]
    ds_read_b64_tr_b16 a[212:213], v21 offset:29120
    ds_read_b64_tr_b16 a[214:215], v21 offset:30160
    v_add_f32 v47, v47, v59
    v_cvt_pk_bf16_f32 v134, v58, v59
    v_exp_f32 v61, v79
    v_mfma_f32_32x32x16_bf16 a[64:79], a[192:195], v[152:155], a[64:79]
    v_add_f32 v47, v47, v60
    v_exp_f32 v54, v80
    v_add_f32 v47, v47, v61
    v_cvt_pk_bf16_f32 v135, v60, v61
    v_mfma_f32_32x32x16_bf16 a[16:31], a[196:199], v[144:147], a[16:31]
    ds_read_b64_tr_b16 a[216:217], v22 offset:29120
    ds_read_b64_tr_b16 a[218:219], v22 offset:30160
    v_exp_f32 v55, v81
    v_exp_f32 v56, v82
    v_mfma_f32_32x32x16_bf16 a[80:95], a[196:199], v[152:155], a[80:95]
    v_add_f32 v48, v54, v55
    v_cvt_pk_bf16_f32 v136, v54, v55
    v_exp_f32 v57, v83
    v_add_f32 v48, v48, v56
    v_mfma_f32_32x32x16_bf16 a[32:47], a[200:203], v[144:147], a[32:47]
    ds_read_b64_tr_b16 a[220:221], v23 offset:29120
    ds_read_b64_tr_b16 a[222:223], v23 offset:30160
    v_exp_f32 v58, v84
    v_add_f32 v48, v48, v57
    v_cvt_pk_bf16_f32 v137, v56, v57
    v_mfma_f32_32x32x16_bf16 a[96:111], a[200:203], v[152:155], a[96:111]
    v_exp_f32 v59, v85
    v_add_f32 v48, v48, v58
    v_exp_f32 v60, v86
    s_waitcnt lgkmcnt(4)
    v_mfma_f32_32x32x16_bf16 a[48:63], a[204:207], v[144:147], a[48:63]
    s_waitcnt vmcnt(25)
    s_waitcnt vmcnt(21)
    s_barrier
    ds_read_b128 a[192:195], v8 offset:33280
    v_add_f32 v48, v48, v59
    v_cvt_pk_bf16_f32 v138, v58, v59
    v_exp_f32 v61, v87
    v_mfma_f32_32x32x16_bf16 a[112:127], a[204:207], v[152:155], a[112:127]
    v_add_f32 v48, v48, v60
    v_exp_f32 v54, v88
    v_add_f32 v48, v48, v61
    v_cvt_pk_bf16_f32 v139, v60, v61
    v_mfma_f32_32x32x16_bf16 a[0:15], a[208:211], v[148:151], a[0:15]
    ds_read_b128 a[196:199], v8 offset:33312
    v_exp_f32 v55, v89
    v_add_f32 v48, v48, v54
    v_exp_f32 v56, v90
    v_mfma_f32_32x32x16_bf16 a[64:79], a[208:211], v[156:159], a[64:79]
    v_add_f32 v48, v48, v55
    v_cvt_pk_bf16_f32 v140, v54, v55
    v_exp_f32 v57, v91
    v_add_f32 v48, v48, v56
    v_mfma_f32_32x32x16_bf16 a[16:31], a[212:215], v[148:151], a[16:31]
    ds_read_b128 a[200:203], v9 offset:33280
    v_exp_f32 v58, v92
    v_add_f32 v48, v48, v57
    v_cvt_pk_bf16_f32 v141, v56, v57
    v_mfma_f32_32x32x16_bf16 a[80:95], a[212:215], v[156:159], a[80:95]
    v_exp_f32 v59, v93
    v_add_f32 v48, v48, v58
    v_exp_f32 v60, v94
    s_waitcnt lgkmcnt(2)
    v_mfma_f32_32x32x16_bf16 a[32:47], a[216:219], v[148:151], a[32:47]
    ds_read_b128 a[204:207], v9 offset:33312
    v_add_f32 v48, v48, v59
    v_cvt_pk_bf16_f32 v142, v58, v59
    v_exp_f32 v61, v95
    v_add_f32 v48, v48, v60
    v_mfma_f32_32x32x16_bf16 a[96:111], a[216:219], v[156:159], a[96:111]
    buffer_load_dwordx4 a[128:131], v52, s[80:83], s54 offen
    v_mfma_f32_32x32x16_bf16 a[48:63], a[220:223], v[148:151], a[48:63]
    ds_read_b128 a[208:211], v10 offset:33280
    v_add_f32 v48, v48, v61
    v_cvt_pk_bf16_f32 v143, v60, v61
    v_max_f32 v62, v47, v48
    v_cmp_lt_f32 vcc, s36, v62
    v_mfma_f32_32x32x16_bf16 a[112:127], a[220:223], v[156:159], a[112:127]
    s_cbranch_vccnz L_stub5
L_back5:
    v_add_f32 v45, v45, v47
    v_add_f32 v46, v46, v48
    v_mfma_f32_32x32x16_bf16 v[64:79], a[192:195], v[192:195], v[160:175]
    ds_read_b128 a[212:215], v10 offset:33312
    s_add_u32 s42, s44, 98304
    s_add_u32 m0, s33, 0
    v_exp_f32 v54, v96
    v_mfma_f32_32x32x16_bf16 v[80:95], a[192:195], v[224:227], v[176:191]
    buffer_load_dwordx4 v40, s[16:19], s42 offen offset:0 lds
    v_exp_f32 v55, v97
    s_waitcnt lgkmcnt(2)
    v_mfma_f32_32x32x16_bf16 v[64:79], a[196:199], v[196:199], v[64:79]
    ds_read_b128 a[216:219], v11 offset:33280
    v_exp_f32 v56, v98
    v_add_f32 v47, v54, v55
    v_cvt_pk_bf16_f32 v144, v54, v55
    v_mfma_f32_32x32x16_bf16 v[80:95], a[196:199], v[228:231], v[80:95]
    buffer_load_dwordx4 v41, s[16:19], s42 offen offset:1040 lds
    v_exp_f32 v57, v99
    v_add_f32 v47, v47, v56
    v_mfma_f32_32x32x16_bf16 v[64:79], a[200:203], v[200:203], v[64:79]
    ds_read_b128 a[220:223], v11 offset:33312
    v_exp_f32 v58, v100
    v_add_f32 v47, v47, v57
    v_cvt_pk_bf16_f32 v145, v56, v57
    v_mfma_f32_32x32x16_bf16 v[80:95], a[200:203], v[232:235], v[80:95]
    buffer_load_dwordx4 v42, s[16:19], s42 offen offset:2080 lds
    v_exp_f32 v59, v101
    v_add_f32 v47, v47, v58
    v_mfma_f32_32x32x16_bf16 v[64:79], a[204:207], v[204:207], v[64:79]
    ds_read_b64_tr_b16 a[192:193], v20 offset:33280
    ds_read_b64_tr_b16 a[194:195], v20 offset:34320
    v_exp_f32 v60, v102
    v_add_f32 v47, v47, v59
    v_cvt_pk_bf16_f32 v146, v58, v59
    v_mfma_f32_32x32x16_bf16 v[80:95], a[204:207], v[236:239], v[80:95]
    buffer_load_dwordx4 v43, s[16:19], s42 offen offset:3120 lds
    v_exp_f32 v61, v103
    v_add_f32 v47, v47, v60
    s_waitcnt lgkmcnt(3)
    v_mfma_f32_32x32x16_bf16 v[64:79], a[208:211], v[208:211], v[64:79]
    ds_read_b64_tr_b16 a[196:197], v21 offset:33280
    ds_read_b64_tr_b16 a[198:199], v21 offset:34320
    v_exp_f32 v54, v104
    v_add_f32 v47, v47, v61
    v_cvt_pk_bf16_f32 v147, v60, v61
    v_mfma_f32_32x32x16_bf16 v[80:95], a[208:211], v[240:243], v[80:95]
    s_add_u32 s55, s55, 4096
    buffer_load_dword a148, v53, s[88:91], s55 offen offset:0
    v_exp_f32 v55, v105
    v_mfma_f32_32x32x16_bf16 v[64:79], a[212:215], v[212:215], v[64:79]
    ds_read_b64_tr_b16 a[200:201], v22 offset:33280
    ds_read_b64_tr_b16 a[202:203], v22 offset:34320
    v_add_f32 v47, v47, v54
    v_exp_f32 v56, v106
    v_add_f32 v47, v47, v55
    v_mfma_f32_32x32x16_bf16 v[80:95], a[212:215], v[244:247], v[80:95]
    v_cvt_pk_bf16_f32 v148, v54, v55
    v_exp_f32 v57, v107
    v_add_f32 v47, v47, v56
    v_exp_f32 v58, v108
    v_mfma_f32_32x32x16_bf16 v[64:79], a[216:219], v[216:219], v[64:79]
    ds_read_b64_tr_b16 a[204:205], v23 offset:33280
    ds_read_b64_tr_b16 a[206:207], v23 offset:34320
    v_add_f32 v47, v47, v57
    v_cvt_pk_bf16_f32 v149, v56, v57
    v_exp_f32 v59, v109
    v_mfma_f32_32x32x16_bf16 v[80:95], a[216:219], v[248:251], v[80:95]
    v_add_f32 v47, v47, v58
    v_exp_f32 v60, v110
    v_add_f32 v47, v47, v59
    v_cvt_pk_bf16_f32 v150, v58, v59
    s_waitcnt lgkmcnt(4)
    v_mfma_f32_32x32x16_bf16 v[64:79], a[220:223], v[220:223], v[64:79]
    ds_read_b64_tr_b16 a[208:209], v20 offset:37440
    ds_read_b64_tr_b16 a[210:211], v20 offset:38480
    v_exp_f32 v61, v111
    v_add_f32 v47, v47, v60
    v_mfma_f32_32x32x16_bf16 v[80:95], a[220:223], v[252:255], v[80:95]
    buffer_load_dword a149, v53, s[88:91], s55 offen offset:1024
    v_exp_f32 v54, v112
    v_add_f32 v47, v47, v61
    v_mfma_f32_32x32x16_bf16 a[0:15], a[192:195], v[128:131], a[0:15]
    ds_read_b64_tr_b16 a[212:213], v21 offset:37440
    ds_read_b64_tr_b16 a[214:215], v21 offset:38480
    v_cvt_pk_bf16_f32 v151, v60, v61
    v_exp_f32 v55, v113
    v_mfma_f32_32x32x16_bf16 a[64:79], a[192:195], v[136:139], a[64:79]
    v_exp_f32 v56, v114
    v_add_f32 v48, v54, v55
    v_cvt_pk_bf16_f32 v152, v54, v55
    v_exp_f32 v57, v115
    v_mfma_f32_32x32x16_bf16 a[16:31], a[196:199], v[128:131], a[16:31]
    ds_read_b64_tr_b16 a[216:217], v22 offset:37440
    ds_read_b64_tr_b16 a[218:219], v22 offset:38480
    v_add_f32 v48, v48, v56
    v_exp_f32 v58, v116
    v_add_f32 v48, v48, v57
    v_mfma_f32_32x32x16_bf16 a[80:95], a[196:199], v[136:139], a[80:95]
    v_cvt_pk_bf16_f32 v153, v56, v57
    v_exp_f32 v59, v117
    v_add_f32 v48, v48, v58
    v_exp_f32 v60, v118
    s_waitcnt lgkmcnt(4)
    v_mfma_f32_32x32x16_bf16 a[32:47], a[200:203], v[128:131], a[32:47]
    ds_read_b64_tr_b16 a[220:221], v23 offset:37440
    ds_read_b64_tr_b16 a[222:223], v23 offset:38480
    v_add_f32 v48, v48, v59
    v_cvt_pk_bf16_f32 v154, v58, v59
    v_exp_f32 v61, v119
    v_mfma_f32_32x32x16_bf16 a[96:111], a[200:203], v[136:139], a[96:111]
    v_add_f32 v48, v48, v60
    v_exp_f32 v54, v120
    v_add_f32 v48, v48, v61
    v_cvt_pk_bf16_f32 v155, v60, v61
    v_mfma_f32_32x32x16_bf16 a[48:63], a[204:207], v[128:131], a[48:63]
    ds_read_b128 a[192:195], v8 offset:41600
    v_exp_f32 v55, v121
    v_add_f32 v48, v48, v54
    v_exp_f32 v56, v122
    v_mfma_f32_32x32x16_bf16 a[112:127], a[204:207], v[136:139], a[112:127]
    v_add_f32 v48, v48, v55
    v_cvt_pk_bf16_f32 v156, v54, v55
    v_exp_f32 v57, v123
    v_add_f32 v48, v48, v56
    v_mfma_f32_32x32x16_bf16 a[0:15], a[208:211], v[132:135], a[0:15]
    ds_read_b128 a[196:199], v8 offset:41632
    v_exp_f32 v58, v124
    v_add_f32 v48, v48, v57
    v_cvt_pk_bf16_f32 v157, v56, v57
    v_mfma_f32_32x32x16_bf16 a[64:79], a[208:211], v[140:143], a[64:79]
    v_exp_f32 v59, v125
    v_add_f32 v48, v48, v58
    v_exp_f32 v60, v126
    v_add_f32 v48, v48, v59
    s_waitcnt lgkmcnt(2)
    v_mfma_f32_32x32x16_bf16 a[16:31], a[212:215], v[132:135], a[16:31]
    ds_read_b128 a[200:203], v9 offset:41600
    v_cvt_pk_bf16_f32 v158, v58, v59
    v_exp_f32 v61, v127
    v_add_f32 v48, v48, v60
    v_mfma_f32_32x32x16_bf16 a[80:95], a[212:215], v[140:143], a[80:95]
    v_mfma_f32_32x32x16_bf16 a[32:47], a[216:219], v[132:135], a[32:47]
    ds_read_b128 a[204:207], v9 offset:41632
    buffer_load_dword v5, v27, s[72:75], 0 offen sc1
    v_mfma_f32_32x32x16_bf16 a[96:111], a[216:219], v[140:143], a[96:111]
    buffer_load_dwordx4 a[132:135], v52, s[80:83], s54 offen offset:2752
    v_mfma_f32_32x32x16_bf16 a[48:63], a[220:223], v[132:135], a[48:63]
    ds_read_b128 a[208:211], v10 offset:41600
    v_add_f32 v48, v48, v61
    v_cvt_pk_bf16_f32 v159, v60, v61
    v_max_f32 v62, v47, v48
    v_cmp_lt_f32 vcc, s36, v62
    v_mfma_f32_32x32x16_bf16 a[112:127], a[220:223], v[140:143], a[112:127]
    s_cbranch_vccnz L_stub6
L_back6:
    v_add_f32 v45, v45, v47
    v_add_f32 v46, v46, v48
    s_waitcnt lgkmcnt(3)
    v_mfma_f32_32x32x16_bf16 v[96:111], a[192:195], v[192:195], v[160:175]
    ds_read_b128 a[212:215], v10 offset:41632
    s_add_u32 s42, s44, 98304
    s_add_u32 m0, s33, 83200
    v_exp_f32 v54, v64
    v_exp_f32 v55, v65
    v_mfma_f32_32x32x16_bf16 v[112:127], a[192:195], v[224:227], v[176:191]
    buffer_load_dwordx4 v40, s[20:23], s42 offen offset:0 lds
    v_exp_f32 v56, v66
    v_add_f32 v47, v54, v55
    v_mfma_f32_32x32x16_bf16 v[96:111], a[196:199], v[196:199], v[96:111]
    ds_read_b128 a[216:219], v11 offset:41600
    buffer_load_dword a150, v53, s[88:91], s55 offen offset:2048
    v_cvt_pk_bf16_f32 v128, v54, v55
    v_exp_f32 v57, v67
    v_mfma_f32_32x32x16_bf16 v[112:127], a[196:199], v[228:231], v[112:127]
    buffer_load_dwordx4 v41, s[20:23], s42 offen offset:1040 lds
    v_add_f32 v47, v47, v56
    v_exp_f32 v58, v68
    s_waitcnt lgkmcnt(2)
    v_mfma_f32_32x32x16_bf16 v[96:111], a[200:203], v[200:203], v[96:111]
    ds_read_b128 a[220:223], v11 offset:41632
    buffer_load_dword a151, v53, s[88:91], s55 offen offset:3072
    v_add_f32 v47, v47, v57
    v_cvt_pk_bf16_f32 v129, v56, v57
    v_mfma_f32_32x32x16_bf16 v[112:127], a[200:203], v[232:235], v[112:127]
    buffer_load_dwordx4 v42, s[20:23], s42 offen offset:2080 lds
    s_waitcnt vmcnt(21)
    v_max3_u32 v50, v50, v32, v33
    v_exp_f32 v59, v69
    v_mfma_f32_32x32x16_bf16 v[96:111], a[204:207], v[204:207], v[96:111]
    ds_read_b64_tr_b16 a[192:193], v20 offset:41600
    ds_read_b64_tr_b16 a[194:195], v20 offset:42640
    v_max3_u32 v50, v50, v34, v35
    v_add_f32 v47, v47, v58
    v_exp_f32 v60, v70
    v_add_f32 v47, v47, v59
    v_mfma_f32_32x32x16_bf16 v[112:127], a[204:207], v[236:239], v[112:127]
    buffer_load_dwordx4 v43, s[20:23], s42 offen offset:3120 lds
    v_cvt_pk_bf16_f32 v130, v58, v59
    v_exp_f32 v61, v71
    v_mfma_f32_32x32x16_bf16 v[96:111], a[208:211], v[208:211], v[96:111]
    ds_read_b64_tr_b16 a[196:197], v21 offset:41600
    ds_read_b64_tr_b16 a[198:199], v21 offset:42640
    s_waitcnt vmcnt(21)
    v_max3_u32 v50, v50, v36, v37
    v_add_f32 v47, v47, v60
    v_exp_f32 v54, v72
    v_add_f32 v47, v47, v61
    v_mfma_f32_32x32x16_bf16 v[112:127], a[208:211], v[240:243], v[112:127]
    v_max3_u32 v50, v50, v38, v39
    v_cvt_pk_bf16_f32 v131, v60, v61
    v_exp_f32 v55, v73
    v_add_f32 v47, v47, v54
    s_waitcnt lgkmcnt(4)
    v_mfma_f32_32x32x16_bf16 v[96:111], a[212:215], v[212:215], v[96:111]
    ds_read_b64_tr_b16 a[200:201], v22 offset:41600
    ds_read_b64_tr_b16 a[202:203], v22 offset:42640
    v_exp_f32 v56, v74
    v_add_f32 v47, v47, v55
    v_cvt_pk_bf16_f32 v132, v54, v55
    v_mfma_f32_32x32x16_bf16 v[112:127], a[212:215], v[244:247], v[112:127]
    v_max_u32_dpp v50, v50, v50 quad_perm:[1,0,3,2] row_mask:0xf bank_mask:0xf
    s_nop 1
    v_max_u32_dpp v50, v50, v50 quad_perm:[2,3,0,1] row_mask:0xf bank_mask:0xf
    v_exp_f32 v57, v75
    v_add_f32 v47, v47, v56
    v_mfma_f32_32x32x16_bf16 v[96:111], a[216:219], v[216:219], v[96:111]
    ds_read_b64_tr_b16 a[204:205], v23 offset:41600
    ds_read_b64_tr_b16 a[206:207], v23 offset:42640
    v_exp_f32 v58, v76
    v_add_f32 v47, v47, v57
    v_cvt_pk_bf16_f32 v133, v56, v57
    v_mfma_f32_32x32x16_bf16 v[112:127], a[216:219], v[248:251], v[112:127]
    v_max_u32_dpp v50, v50, v50 row_half_mirror row_mask:0xf bank_mask:0xf
    s_nop 1
    v_max_u32_dpp v50, v50, v50 row_mirror row_mask:0xf bank_mask:0xf
    v_exp_f32 v59, v77
    v_add_f32 v47, v47, v58
    v_mfma_f32_32x32x16_bf16 v[96:111], a[220:223], v[220:223], v[96:111]
    ds_read_b64_tr_b16 a[208:209], v20 offset:45760
    ds_read_b64_tr_b16 a[210:211], v20 offset:46800
    v_exp_f32 v60, v78
    v_add_f32 v47, v47, v59
    v_cvt_pk_bf16_f32 v134, v58, v59
    v_mfma_f32_32x32x16_bf16 v[112:127], a[220:223], v[252:255], v[112:127]
    v_mov_b32 v32, v50
    v_exp_f32 v61, v79
    v_add_f32 v47, v47, v60
    v_exp_f32 v54, v80
    s_waitcnt lgkmcnt(4)
    v_mfma_f32_32x32x16_bf16 a[0:15], a[192:195], v[144:147], a[0:15]
    ds_read_b64_tr_b16 a[212:213], v21 offset:45760
    ds_read_b64_tr_b16 a[214:215], v21 offset:46800
    v_add_f32 v47, v47, v61
    v_cvt_pk_bf16_f32 v135, v60, v61
    v_exp_f32 v55, v81
    v_mfma_f32_32x32x16_bf16 a[64:79], a[192:195], v[152:155], a[64:79]
    v_permlane16_swap_b32 v50, v32
    v_max_u32 v50, v50, v32
    v_exp_f32 v56, v82
    v_add_f32 v48, v54, v55
    v_cvt_pk_bf16_f32 v136, v54, v55
    v_mfma_f32_32x32x16_bf16 a[16:31], a[196:199], v[144:147], a[16:31]
    ds_read_b64_tr_b16 a[216:217], v22 offset:45760
    ds_read_b64_tr_b16 a[218:219], v22 offset:46800
    v_exp_f32 v57, v83
    v_add_f32 v48, v48, v56
    v_exp_f32 v58, v84
    v_mfma_f32_32x32x16_bf16 a[80:95], a[196:199], v[152:155], a[80:95]
    v_mov_b32 v32, v50
    v_add_f32 v48, v48, v57
    v_cvt_pk_bf16_f32 v137, v56, v57
    v_exp_f32 v59, v85
    v_add_f32 v48, v48, v58
    v_mfma_f32_32x32x16_bf16 a[32:47], a[200:203], v[144:147], a[32:47]
    ds_read_b64_tr_b16 a[220:221], v23 offset:45760
    ds_read_b64_tr_b16 a[222:223], v23 offset:46800
    v_exp_f32 v60, v86
    v_add_f32 v48, v48, v59
    v_cvt_pk_bf16_f32 v138, v58, v59
    v_mfma_f32_32x32x16_bf16 a[96:111], a[200:203], v[152:155], a[96:111]
    v_permlane32_swap_b32 v50, v32
    v_exp_f32 v61, v87
    v_add_f32 v48, v48, v60
    v_exp_f32 v54, v88
    s_waitcnt lgkmcnt(4)
    v_mfma_f32_32x32x16_bf16 a[48:63], a[204:207], v[144:147], a[48:63]
    v_max_u32 v50, v50, v32
    v_add_f32 v48, v48, v61
    v_cvt_pk_bf16_f32 v139, v60, v61
    v_exp_f32 v55, v89
    v_add_f32 v48, v48, v54
    v_mfma_f32_32x32x16_bf16 a[112:127], a[204:207], v[152:155], a[112:127]
    v_readfirstlane_b32 s3, v50
    v_exp_f32 v56, v90
    v_add_f32 v48, v48, v55
    v_cvt_pk_bf16_f32 v140, v54, v55
    v_mfma_f32_32x32x16_bf16 a[0:15], a[208:211], v[148:151], a[0:15]
    s_and_b32 s4, s3, 0xffff
    v_exp_f32 v57, v91
    v_add_f32 v48, v48, v56
    v_exp_f32 v58, v92
    v_add_f32 v48, v48, v57
    v_mfma_f32_32x32x16_bf16 a[64:79], a[208:211], v[156:159], a[64:79]
    s_waitcnt vmcnt(7)
    v_and_b32 v5, s49, v5
    v_cmp_ne_u32 vcc, s49, v5
    s_cbranch_vccnz L_spin1
L_ok1:
    s_barrier
    ds_read_b128 a[192:195], v12 offset:0
    v_mfma_f32_32x32x16_bf16 a[16:31], a[212:215], v[148:151], a[16:31]
    ds_read_b64_tr_b16 a[196:197], v16 offset:16640
    ds_read_b64_tr_b16 a[198:199], v16 offset:17680
    s_sub_u32 s4, 0xffff, s4
    v_cvt_pk_bf16_f32 v141, v56, v57
    v_exp_f32 v59, v93
    v_add_f32 v48, v48, v58
    v_mfma_f32_32x32x16_bf16 a[80:95], a[212:215], v[156:159], a[80:95]
    ds_read_b128 a[200:203], v12 offset:32
    s_lshl_b32 s34, s4, 10
    v_exp_f32 v60, v94
    v_add_f32 v48, v48, v59
    v_cvt_pk_bf16_f32 v142, v58, v59
    s_waitcnt lgkmcnt(4)
    v_mfma_f32_32x32x16_bf16 a[32:47], a[216:219], v[148:151], a[32:47]
    ds_read_b64_tr_b16 a[204:205], v17 offset:16640
    ds_read_b64_tr_b16 a[206:207], v17 offset:17680
    buffer_load_dword v51, v53, s[28:31], s34 offen sc1
    v_exp_f32 v61, v95
    v_mfma_f32_32x32x16_bf16 a[96:111], a[216:219], v[156:159], a[96:111]
    ds_read_b128 a[208:211], v13 offset:0
    buffer_load_dwordx4 a[136:139], v52, s[84:87], s54 offen
    v_add_f32 v48, v48, v60
    v_mfma_f32_32x32x16_bf16 a[48:63], a[220:223], v[148:151], a[48:63]
    ds_read_b64_tr_b16 a[212:213], v18 offset:16640
    ds_read_b64_tr_b16 a[214:215], v18 offset:17680
    v_add_f32 v48, v48, v61
    v_cvt_pk_bf16_f32 v143, v60, v61
    v_max_f32 v62, v47, v48
    v_cmp_lt_f32 vcc, s36, v62
    v_mfma_f32_32x32x16_bf16 a[112:127], a[220:223], v[156:159], a[112:127]
    ds_read_b128 a[216:219], v13 offset:32
    s_cbranch_vccnz L_stub7
L_back7:
    v_add_f32 v45, v45, v47
    v_add_f32 v46, v46, v48
    s_waitcnt lgkmcnt(6)
    v_mfma_f32_32x32x16_bf16 v[64:79], a[192:195], v[192:195], v[160:175]
    ds_read_b64_tr_b16 a[220:221], v19 offset:16640
    ds_read_b64_tr_b16 a[222:223], v19 offset:17680
    v_mfma_f32_32x32x16_bf16 a[0:15], a[196:199], v[128:131], a[0:15]
    ds_read_b128 a[192:195], v14 offset:0
    v_exp_f32 v54, v96
    v_exp_f32 v55, v97
    v_exp_f32 v56, v98
    v_add_f32 v47, v54, v55
    v_cvt_pk_bf16_f32 v144, v54, v55
    v_mfma_f32_32x32x16_bf16 v[64:79], a[200:203], v[196:199], v[64:79]
    ds_read_b64_tr_b16 a[196:197], v16 offset:20800
    ds_read_b64_tr_b16 a[198:199], v16 offset:21840
    s_lshr_b32 s34, s32, 1
    s_lshl_b32 s34, s34, 5
    v_exp_f32 v57, v99
    v_add_f32 v47, v47, v56
    v_exp_f32 v58, v100
    s_waitcnt lgkmcnt(6)
    v_mfma_f32_32x32x16_bf16 a[16:31], a[204:207], v[128:131], a[16:31]
    ds_read_b128 a[200:203], v14 offset:32
    s_add_u32 s42, s44, 114688
    s_add_u32 m0, s33, 33280
    s_nop 0
    buffer_load_dwordx4 v40, s[16:19], s42 offen offset:0 lds
    v_add_f32 v47, v47, v57
    v_cvt_pk_bf16_f32 v145, v56, v57
    v_mfma_f32_32x32x16_bf16 v[64:79], a[208:211], v[200:203], v[64:79]
    ds_read_b64_tr_b16 a[204:205], v17 offset:20800
    ds_read_b64_tr_b16 a[206:207], v17 offset:21840
    buffer_load_dwordx4 v41, s[16:19], s42 offen offset:1040 lds
    s_add_u32 s34, s34, s6
    v_exp_f32 v59, v101
    v_add_f32 v47, v47, v58
    v_mfma_f32_32x32x16_bf16 a[32:47], a[212:215], v[128:131], a[32:47]
    ds_read_b128 a[208:211], v15 offset:0
    buffer_load_dwordx4 v42, s[16:19], s42 offen offset:2080 lds
    v_and_b32 v5, 31, v2
    v_lshrrev_b32 v4, 5, v2
    v_exp_f32 v60, v102
    v_add_f32 v47, v47, v59
    s_waitcnt lgkmcnt(4)
    v_mfma_f32_32x32x16_bf16 v[64:79], a[216:219], v[204:207], v[64:79]
    ds_read_b64_tr_b16 a[212:213], v18 offset:20800
    ds_read_b64_tr_b16 a[214:215], v18 offset:21840
    buffer_load_dwordx4 v43, s[16:19], s42 offen offset:3120 lds
    v_add_u32 v33, s34, v5
    v_cvt_pk_bf16_f32 v146, v58, v59
    v_exp_f32 v61, v103
    v_mfma_f32_32x32x16_bf16 a[48:63], a[220:223], v[128:131], a[48:63]
    ds_read_b128 a[216:219], v15 offset:32
    s_add_u32 s42, s44, 114688
    s_add_u32 m0, s33, 99840
    s_nop 0
    buffer_load_dwordx4 v40, s[20:23], s42 offen offset:0 lds
    v_add_f32 v47, v47, v60
    v_exp_f32 v54, v104
    v_mfma_f32_32x32x16_bf16 v[64:79], a[192:195], v[208:211], v[64:79]
    ds_read_b64_tr_b16 a[220:221], v19 offset:20800
    ds_read_b64_tr_b16 a[222:223], v19 offset:21840
    buffer_load_dwordx4 v41, s[20:23], s42 offen offset:1040 lds
    v_lshlrev_b32 v32, 10, v33
    v_add_f32 v47, v47, v61
    v_cvt_pk_bf16_f32 v147, v60, v61
    v_mfma_f32_32x32x16_bf16 a[0:15], a[196:199], v[132:135], a[0:15]
    ds_read_b128 a[192:195], v12 offset:8320
    buffer_load_dwordx4 v42, s[20:23], s42 offen offset:2080 lds
    v_lshl_add_u32 v32, v4, 4, v32
    s_and_b32 s35, s32, 1
    v_exp_f32 v55, v105
    v_add_f32 v47, v47, v54
    s_waitcnt lgkmcnt(4)
    v_mfma_f32_32x32x16_bf16 v[64:79], a[200:203], v[212:215], v[64:79]
    ds_read_b64_tr_b16 a[196:197], v16 offset:24960
    ds_read_b64_tr_b16 a[198:199], v16 offset:26000
    buffer_load_dwordx4 v43, s[20:23], s42 offen offset:3120 lds
    v_exp_f32 v56, v106
    v_add_f32 v47, v47, v55
    v_cvt_pk_bf16_f32 v148, v54, v55
    v_mfma_f32_32x32x16_bf16 a[16:31], a[204:207], v[132:135], a[16:31]
    ds_read_b128 a[200:203], v12 offset:8352
    s_lshl_b32 s35, s35, 6
    s_lshl_b32 s49, s7, 7
    v_exp_f32 v57, v107
    v_add_f32 v47, v47, v56
    v_exp_f32 v58, v108
    v_add_f32 v47, v47, v57
    v_mfma_f32_32x32x16_bf16 v[64:79], a[208:211], v[216:219], v[64:79]
    ds_read_b64_tr_b16 a[204:205], v17 offset:24960
    ds_read_b64_tr_b16 a[206:207], v17 offset:26000
    s_add_u32 s49, s49, s35
    v_cvt_pk_bf16_f32 v149, v56, v57
    v_exp_f32 v59, v109
    v_add_f32 v47, v47, v58
    v_exp_f32 v60, v110
    v_mfma_f32_32x32x16_bf16 a[32:47], a[212:215], v[132:135], a[32:47]
    ds_read_b128 a[208:211], v13 offset:8320
    v_add_f32 v47, v47, v59
    v_cvt_pk_bf16_f32 v150, v58, v59
    v_exp_f32 v61, v111
    v_add_f32 v47, v47, v60
    s_waitcnt lgkmcnt(4)
    v_mfma_f32_32x32x16_bf16 v[64:79], a[216:219], v[220:223], v[64:79]
    ds_read_b64_tr_b16 a[212:213], v18 offset:24960
    ds_read_b64_tr_b16 a[214:215], v18 offset:26000
    v_add_f32 v47, v47, v61
    v_cvt_pk_bf16_f32 v151, v60, v61
    v_cmp_lt_f32 vcc, s36, v47
    buffer_load_dwordx4 a[152:155], v24, s[76:79], s51 offen offset:0 sc1
    v_mfma_f32_32x32x16_bf16 a[48:63], a[220:223], v[132:135], a[48:63]
    ds_read_b128 a[216:219], v13 offset:8352
    s_cbranch_vccnz L_stub8
L_back8:
    v_add_f32 v45, v45, v47
    buffer_load_dwordx4 a[156:159], v25, s[76:79], s51 offen offset:0 sc1
    v_mfma_f32_32x32x16_bf16 v[96:111], a[192:195], v[192:195], v[160:175]
    ds_read_b64_tr_b16 a[220:221], v19 offset:24960
    ds_read_b64_tr_b16 a[222:223], v19 offset:26000
    buffer_load_dwordx4 a[160:163], v24, s[76:79], s51 offen offset:2048 sc1
    buffer_load_dwordx4 a[164:167], v25, s[76:79], s51 offen offset:2048 sc1
    s_add_u32 s51, s51, 4096
    v_mfma_f32_32x32x16_bf16 a[0:15], a[196:199], v[144:147], a[0:15]
    ds_read_b128 a[192:195], v14 offset:8320
    v_exp_f32 v54, v64
    v_exp_f32 v55, v65
    v_exp_f32 v56, v66
    s_waitcnt lgkmcnt(6)
    v_mfma_f32_32x32x16_bf16 v[96:111], a[200:203], v[196:199], v[96:111]
    ds_read_b64_tr_b16 a[196:197], v16 offset:29120
    ds_read_b64_tr_b16 a[198:199], v16 offset:30160
    v_add_f32 v47, v54, v55
    v_cvt_pk_bf16_f32 v128, v54, v55
    v_exp_f32 v57, v67
    v_add_f32 v47, v47, v56
    v_mfma_f32_32x32x16_bf16 a[16:31], a[204:207], v[144:147], a[16:31]
    ds_read_b128 a[200:203], v14 offset:8352
    v_mov_b32 v27, 1073741824
    v_exp_f32 v58, v68
    v_add_f32 v47, v47, v57
    v_cvt_pk_bf16_f32 v129, v56, v57
    buffer_load_dwordx4 a[168:171], v24, s[76:79], s51 offen offset:0 sc1
    v_mfma_f32_32x32x16_bf16 v[96:111], a[208:211], v[200:203], v[96:111]
    ds_read_b64_tr_b16 a[204:205], v17 offset:29120
    ds_read_b64_tr_b16 a[206:207], v17 offset:30160
    v_exp_f32 v59, v69
    v_add_f32 v47, v47, v58
    v_exp_f32 v60, v70
    s_waitcnt lgkmcnt(6)
    v_mfma_f32_32x32x16_bf16 a[32:47], a[212:215], v[144:147], a[32:47]
    ds_read_b128 a[208:211], v15 offset:8320
    v_lshlrev_b32 v26, 13, v0
    v_add_f32 v47, v47, v59
    v_cvt_pk_bf16_f32 v130, v58, v59
    v_exp_f32 v61, v71
    v_add_f32 v47, v47, v60
    v_mfma_f32_32x32x16_bf16 v[96:111], a[216:219], v[204:207], v[96:111]
    ds_read_b64_tr_b16 a[212:213], v18 offset:29120
    ds_read_b64_tr_b16 a[214:215], v18 offset:30160
    v_exp_f32 v54, v72
    v_add_f32 v47, v47, v61
    v_cvt_pk_bf16_f32 v131, v60, v61
    buffer_load_dwordx4 a[172:175], v25, s[76:79], s51 offen offset:0 sc1
    v_mfma_f32_32x32x16_bf16 a[48:63], a[220:223], v[144:147], a[48:63]
    ds_read_b128 a[216:219], v15 offset:8352
    v_mov_b32 v35, 1
    v_exp_f32 v55, v73
    v_add_f32 v47, v47, v54
    v_exp_f32 v56, v74
    s_waitcnt lgkmcnt(5)
    v_mfma_f32_32x32x16_bf16 v[96:111], a[192:195], v[208:211], v[96:111]
    ds_read_b64_tr_b16 a[220:221], v19 offset:29120
    ds_read_b64_tr_b16 a[222:223], v19 offset:30160
    v_add_f32 v47, v47, v55
    v_cvt_pk_bf16_f32 v132, v54, v55
    v_exp_f32 v57, v75
    v_add_f32 v47, v47, v56
    v_mfma_f32_32x32x16_bf16 a[0:15], a[196:199], v[148:151], a[0:15]
    s_barrier
    ds_read_b128 a[192:195], v8 offset:0
    v_exp_f32 v58, v76
    v_add_f32 v47, v47, v57
    v_cvt_pk_bf16_f32 v133, v56, v57
    buffer_load_dwordx4 a[176:179], v24, s[76:79], s51 offen offset:2048 sc1
    v_mfma_f32_32x32x16_bf16 v[96:111], a[200:203], v[212:215], v[96:111]
    ds_read_b64_tr_b16 a[196:197], v16 offset:49920
    ds_read_b64_tr_b16 a[198:199], v16 offset:50960
    v_exp_f32 v59, v77
    v_add_f32 v47, v47, v58
    v_exp_f32 v60, v78
    s_waitcnt lgkmcnt(5)
    v_mfma_f32_32x32x16_bf16 a[16:31], a[204:207], v[148:151], a[16:31]
    ds_read_b128 a[200:203], v8 offset:32
    v_cmp_gt_u32 vcc, 32, v0
    s_nop 1
    v_cndmask_b32 v26, v27, v26, vcc
    v_add_f32 v47, v47, v59
    v_cvt_pk_bf16_f32 v134, v58, v59
    v_mfma_f32_32x32x16_bf16 v[96:111], a[208:211], v[216:219], v[96:111]
    ds_read_b64_tr_b16 a[204:205], v17 offset:49920
    ds_read_b64_tr_b16 a[206:207], v17 offset:50960
    v_exp_f32 v61, v79
    v_add_f32 v47, v47, v60
    buffer_load_dwordx4 a[180:183], v25, s[76:79], s51 offen offset:2048 sc1
    s_add_u32 s51, s51, 4096
    v_mfma_f32_32x32x16_bf16 a[32:47], a[212:215], v[148:151], a[32:47]
    ds_read_b128 a[208:211], v9 offset:0
    buffer_load_dwordx4 a[140:143], v52, s[84:87], s54 offen offset:2752
    v_mfma_f32_32x32x16_bf16 v[96:111], a[216:219], v[220:223], v[96:111]
    ds_read_b64_tr_b16 a[212:213], v18 offset:49920
    ds_read_b64_tr_b16 a[214:215], v18 offset:50960
    v_add_f32 v47, v47, v61
    v_cvt_pk_bf16_f32 v135, v60, v61
    v_cmp_lt_f32 vcc, s36, v47
    s_waitcnt lgkmcnt(6)
    v_mfma_f32_32x32x16_bf16 a[48:63], a[220:223], v[148:151], a[48:63]
    ds_read_b128 a[216:219], v9 offset:32
    s_cbranch_vccnz L_stub9
L_back9:
    v_add_f32 v45, v45, v47
    v_mfma_f32_32x32x16_bf16 v[64:79], a[192:195], v[192:195], v[160:175]
    ds_read_b64_tr_b16 a[220:221], v19 offset:49920
    ds_read_b64_tr_b16 a[222:223], v19 offset:50960
    buffer_load_dwordx4 a[184:187], v24, s[76:79], s51 offen offset:0 sc1
    buffer_load_dwordx4 a[188:191], v25, s[76:79], s51 offen offset:0 sc1
    v_mfma_f32_32x32x16_bf16 a[0:15], a[196:199], v[128:131], a[0:15]
    ds_read_b128 a[192:195], v10 offset:0
    v_exp_f32 v54, v96
    v_exp_f32 v55, v97
    v_exp_f32 v56, v98
    s_waitcnt lgkmcnt(7)
    v_mfma_f32_32x32x16_bf16 v[64:79], a[200:203], v[196:199], v[64:79]
    ds_read_b64_tr_b16 a[196:197], v16 offset:54080
    ds_read_b64_tr_b16 a[198:199], v16 offset:55120
    v_lshrrev_b32 v4, 4, v2
    v_add_f32 v47, v54, v55
    v_cvt_pk_bf16_f32 v144, v54, v55
    v_exp_f32 v57, v99
    v_mfma_f32_32x32x16_bf16 a[16:31], a[204:207], v[128:131], a[16:31]
    ds_read_b128 a[200:203], v10 offset:32
    v_and_b32 v5, 7, v2
    v_xor_b32 v5, v5, v4
    v_add_f32 v47, v47, v56
    v_exp_f32 v58, v100
    v_add_f32 v47, v47, v57
    s_waitcnt lgkmcnt(6)
    v_mfma_f32_32x32x16_bf16 v[64:79], a[208:211], v[200:203], v[64:79]
    ds_read_b64_tr_b16 a[204:205], v17 offset:54080
    ds_read_b64_tr_b16 a[206:207], v17 offset:55120
    v_cvt_pk_bf16_f32 v145, v56, v57
    v_exp_f32 v59, v101
    v_add_f32 v47, v47, v58
    buffer_load_dwordx4 a[224:227], v24, s[76:79], s51 offen offset:2048 sc1
    v_mfma_f32_32x32x16_bf16 a[32:47], a[212:215], v[128:131], a[32:47]
    ds_read_b128 a[208:211], v11 offset:0
    v_lshlrev_b32 v5, 4, v5
    v_lshrrev_b32 v4, 3, v2
    v_exp_f32 v60, v102
    v_add_f32 v47, v47, v59
    v_cvt_pk_bf16_f32 v146, v58, v59
    v_mfma_f32_32x32x16_bf16 v[64:79], a[216:219], v[204:207], v[64:79]
    ds_read_b64_tr_b16 a[212:213], v18 offset:54080
    ds_read_b64_tr_b16 a[214:215], v18 offset:55120
    v_exp_f32 v61, v103
    v_add_f32 v47, v47, v60
    v_exp_f32 v54, v104
    s_waitcnt lgkmcnt(5)
    v_mfma_f32_32x32x16_bf16 a[48:63], a[220:223], v[128:131], a[48:63]
    ds_read_b128 a[216:219], v11 offset:32
    v_lshl_add_u32 v28, v4, 10, v5
    v_xor_b32 v29, 64, v28
    v_add_f32 v47, v47, v61
    v_cvt_pk_bf16_f32 v147, v60, v61
    v_exp_f32 v55, v105
    v_mfma_f32_32x32x16_bf16 v[64:79], a[192:195], v[208:211], v[64:79]
    ds_read_b64_tr_b16 a[220:221], v19 offset:54080
    ds_read_b64_tr_b16 a[222:223], v19 offset:55120
    v_add_u32 v29, 7168, v29
    v_add_f32 v47, v47, v54
    v_exp_f32 v56, v106
    v_add_f32 v47, v47, v55
    v_mfma_f32_32x32x16_bf16 a[0:15], a[196:199], v[132:135], a[0:15]
    ds_read_b128 a[192:195], v8 offset:8320
    s_lshl_b32 s34, s32, 4
    s_add_u32 s34, s34, s6
    v_cvt_pk_bf16_f32 v148, v54, v55
    v_exp_f32 v57, v107
    v_add_f32 v47, v47, v56
    v_mfma_f32_32x32x16_bf16 v[64:79], a[200:203], v[212:215], v[64:79]
    ds_read_b64_tr_b16 a[196:197], v16 offset:58240
    ds_read_b64_tr_b16 a[198:199], v16 offset:59280
    v_exp_f32 v58, v108
    v_add_f32 v47, v47, v57
    v_cvt_pk_bf16_f32 v149, v56, v57
    s_waitcnt lgkmcnt(5)
    v_mfma_f32_32x32x16_bf16 a[16:31], a[204:207], v[132:135], a[16:31]
    ds_read_b128 a[200:203], v8 offset:8352
    s_lshl_b32 s34, s34, 10
    s_lshl_b32 s55, s7, 7
    v_exp_f32 v59, v109
    v_add_f32 v47, v47, v58
    v_mfma_f32_32x32x16_bf16 v[64:79], a[208:211], v[216:219], v[64:79]
    ds_read_b64_tr_b16 a[204:205], v17 offset:58240
    ds_read_b64_tr_b16 a[206:207], v17 offset:59280
    s_add_u32 s55, s55, s34
    v_exp_f32 v60, v110
    v_add_f32 v47, v47, v59
    v_cvt_pk_bf16_f32 v150, v58, v59
    v_mfma_f32_32x32x16_bf16 a[32:47], a[212:215], v[132:135], a[32:47]
    ds_read_b128 a[208:211], v9 offset:8320
    v_exp_f32 v61, v111
    v_add_f32 v47, v47, v60
    buffer_load_dwordx4 a[228:231], v25, s[76:79], s51 offen offset:2048 sc1
    s_add_u32 s51, s51, 4096
    v_mfma_f32_32x32x16_bf16 v[64:79], a[216:219], v[220:223], v[64:79]
    ds_read_b64_tr_b16 a[212:213], v18 offset:58240
    ds_read_b64_tr_b16 a[214:215], v18 offset:59280
    v_add_f32 v47, v47, v61
    v_cvt_pk_bf16_f32 v151, v60, v61
    v_cmp_lt_f32 vcc, s36, v47
    buffer_load_dwordx4 a[232:235], v24, s[76:79], s51 offen offset:0 sc1
    s_waitcnt lgkmcnt(5)
    v_mfma_f32_32x32x16_bf16 a[48:63], a[220:223], v[132:135], a[48:63]
    ds_read_b128 a[216:219], v9 offset:8352
    s_cbranch_vccnz L_stub10
L_back10:
    v_add_f32 v45, v45, v47
    buffer_load_dwordx4 a[236:239], v25, s[76:79], s51 offen offset:0 sc1
    v_mfma_f32_32x32x16_bf16 v[96:111], a[192:195], v[192:195], v[160:175]
    ds_read_b64_tr_b16 a[220:221], v19 offset:58240
    ds_read_b64_tr_b16 a[222:223], v19 offset:59280
    s_add_u32 m0, s50, 141056
    s_nop 0
    buffer_load_dwordx4 v28, s[28:31], s55 offen sc1 lds
    v_mfma_f32_32x32x16_bf16 a[0:15], a[196:199], v[144:147], a[0:15]
    ds_read_b128 a[192:195], v10 offset:8320
    v_exp_f32 v54, v64
    v_exp_f32 v55, v65
    v_exp_f32 v56, v66
    v_mfma_f32_32x32x16_bf16 v[96:111], a[200:203], v[196:199], v[96:111]
    ds_read_b64_tr_b16 a[196:197], v16 offset:62400
    ds_read_b64_tr_b16 a[198:199], v16 offset:63440
    v_add_f32 v47, v54, v55
    v_cvt_pk_bf16_f32 v128, v54, v55
    v_exp_f32 v57, v67
    v_add_f32 v47, v47, v56
    s_waitcnt lgkmcnt(6)
    v_mfma_f32_32x32x16_bf16 a[16:31], a[204:207], v[144:147], a[16:31]
    ds_read_b128 a[200:203], v10 offset:8352
    v_exp_f32 v58, v68
    v_add_f32 v47, v47, v57
    v_cvt_pk_bf16_f32 v129, v56, v57
    v_exp_f32 v59, v69
    v_mfma_f32_32x32x16_bf16 v[96:111], a[208:211], v[200:203], v[96:111]
    ds_read_b64_tr_b16 a[204:205], v17 offset:62400
    ds_read_b64_tr_b16 a[206:207], v17 offset:63440
    v_add_f32 v47, v47, v58
    v_exp_f32 v60, v70
    v_add_f32 v47, v47, v59
    v_cvt_pk_bf16_f32 v130, v58, v59
    v_mfma_f32_32x32x16_bf16 a[32:47], a[212:215], v[144:147], a[32:47]
    ds_read_b128 a[208:211], v11 offset:8320
    v_exp_f32 v61, v71
    v_add_f32 v47, v47, v60
    v_exp_f32 v54, v72
    v_add_f32 v47, v47, v61
    s_waitcnt lgkmcnt(5)
    v_mfma_f32_32x32x16_bf16 v[96:111], a[216:219], v[204:207], v[96:111]
    ds_read_b64_tr_b16 a[212:213], v18 offset:62400
    ds_read_b64_tr_b16 a[214:215], v18 offset:63440
    v_cvt_pk_bf16_f32 v131, v60, v61
    v_exp_f32 v55, v73
    v_add_f32 v47, v47, v54
    v_mfma_f32_32x32x16_bf16 a[48:63], a[220:223], v[144:147], a[48:63]
    ds_read_b128 a[216:219], v11 offset:8352
    v_exp_f32 v56, v74
    v_add_f32 v47, v47, v55
    v_cvt_pk_bf16_f32 v132, v54, v55
    v_exp_f32 v57, v75
    v_mfma_f32_32x32x16_bf16 v[96:111], a[192:195], v[208:211], v[96:111]
    ds_read_b64_tr_b16 a[220:221], v19 offset:62400
    ds_read_b64_tr_b16 a[222:223], v19 offset:63440
    v_add_f32 v47, v47, v56
    v_exp_f32 v58, v76
    v_add_f32 v47, v47, v57
    v_cvt_pk_bf16_f32 v133, v56, v57
    s_waitcnt lgkmcnt(6)
    v_mfma_f32_32x32x16_bf16 a[0:15], a[196:199], v[148:151], a[0:15]
    s_waitcnt vmcnt(20)
    s_barrier
    ds_read_b128 a[192:195], v8 offset:33280
    v_exp_f32 v59, v77
    v_add_f32 v47, v47, v58
    v_exp_f32 v60, v78
    v_mfma_f32_32x32x16_bf16 v[96:111], a[200:203], v[212:215], v[96:111]
    ds_read_b64_tr_b16 a[196:197], v20 offset:16640
    ds_read_b64_tr_b16 a[198:199], v20 offset:17680
    v_add_f32 v47, v47, v59
    v_cvt_pk_bf16_f32 v134, v58, v59
    v_exp_f32 v61, v79
    v_add_f32 v47, v47, v60
    v_mfma_f32_32x32x16_bf16 a[16:31], a[204:207], v[148:151], a[16:31]
    ds_read_b128 a[200:203], v8 offset:33312
    buffer_load_dwordx4 v29, s[28:31], s55 offen offset:1024 sc1 lds
    s_add_u32 m0, s50, 149248
    s_nop 0
    buffer_load_dwordx4 v28, s[64:67], s55 offen lds
    s_waitcnt lgkmcnt(6)
    v_mfma_f32_32x32x16_bf16 v[96:111], a[208:211], v[216:219], v[96:111]
    ds_read_b64_tr_b16 a[204:205], v21 offset:16640
    ds_read_b64_tr_b16 a[206:207], v21 offset:17680
    buffer_load_dwordx4 v29, s[64:67], s55 offen offset:1024 lds
    buffer_load_dwordx4 a[240:243], v24, s[76:79], s51 offen offset:2048 sc1
    v_mfma_f32_32x32x16_bf16 a[32:47], a[212:215], v[148:151], a[32:47]
    ds_read_b128 a[208:211], v9 offset:33280
    buffer_load_dwordx4 a[244:247], v25, s[76:79], s51 offen offset:2048 sc1
    s_add_u32 s51, s51, 4096
    s_and_b32 s51, s51, 0x1ffff
    v_mfma_f32_32x32x16_bf16 v[96:111], a[216:219], v[220:223], v[96:111]
    ds_read_b64_tr_b16 a[212:213], v22 offset:16640
    ds_read_b64_tr_b16 a[214:215], v22 offset:17680
    v_add_f32 v47, v47, v61
    v_cvt_pk_bf16_f32 v135, v60, v61
    v_cmp_lt_f32 vcc, s36, v47
    s_waitcnt lgkmcnt(6)
    v_mfma_f32_32x32x16_bf16 a[48:63], a[220:223], v[148:151], a[48:63]
    ds_read_b128 a[216:219], v9 offset:33312
    s_cbranch_vccnz L_stub11
L_back11:
    v_add_f32 v45, v45, v47
    v_mfma_f32_32x32x16_bf16 v[64:79], a[192:195], v[192:195], v[160:175]
    ds_read_b64_tr_b16 a[220:221], v23 offset:16640
    ds_read_b64_tr_b16 a[222:223], v23 offset:17680
    buffer_load_dwordx4 a[248:251], v24, s[76:79], s51 offen offset:0 sc1
    buffer_load_dwordx4 a[252:255], v25, s[76:79], s51 offen offset:0 sc1
    v_mfma_f32_32x32x16_bf16 a[0:15], a[196:199], v[128:131], a[0:15]
    ds_read_b128 a[192:195], v10 offset:33280
    v_exp_f32 v54, v96
    v_exp_f32 v55, v97
    v_exp_f32 v56, v98
    s_waitcnt lgkmcnt(7)
    v_mfma_f32_32x32x16_bf16 v[64:79], a[200:203], v[196:199], v[64:79]
    ds_read_b64_tr_b16 a[196:197], v20 offset:20800
    ds_read_b64_tr_b16 a[198:199], v20 offset:21840
    v_add_f32 v47, v54, v55
    v_cvt_pk_bf16_f32 v144, v54, v55
    v_exp_f32 v57, v99
    v_add_f32 v47, v47, v56
    v_mfma_f32_32x32x16_bf16 a[16:31], a[204:207], v[128:131], a[16:31]
    ds_read_b128 a[200:203], v10 offset:33312
    v_exp_f32 v58, v100
    v_add_f32 v47, v47, v57
    v_cvt_pk_bf16_f32 v145, v56, v57
    v_exp_f32 v59, v101
    s_waitcnt lgkmcnt(6)
    v_mfma_f32_32x32x16_bf16 v[64:79], a[208:211], v[200:203], v[64:79]
    ds_read_b64_tr_b16 a[204:205], v21 offset:20800
    ds_read_b64_tr_b16 a[206:207], v21 offset:21840
    v_add_f32 v47, v47, v58
    v_exp_f32 v60, v102
    v_add_f32 v47, v47, v59
    v_cvt_pk_bf16_f32 v146, v58, v59
    v_mfma_f32_32x32x16_bf16 a[32:47], a[212:215], v[128:131], a[32:47]
    ds_read_b128 a[208:211], v11 offset:33280
    v_exp_f32 v61, v103
    v_add_f32 v47, v47, v60
    v_exp_f32 v54, v104
    v_add_f32 v47, v47, v61
    v_mfma_f32_32x32x16_bf16 v[64:79], a[216:219], v[204:207], v[64:79]
    ds_read_b64_tr_b16 a[212:213], v22 offset:20800
    ds_read_b64_tr_b16 a[214:215], v22 offset:21840
    v_cvt_pk_bf16_f32 v147, v60, v61
    v_exp_f32 v55, v105
    v_add_f32 v47, v47, v54
    s_waitcnt lgkmcnt(6)
    v_mfma_f32_32x32x16_bf16 a[48:63], a[220:223], v[128:131], a[48:63]
    ds_read_b128 a[216:219], v11 offset:33312
    v_exp_f32 v56, v106
    v_add_f32 v47, v47, v55
    v_cvt_pk_bf16_f32 v148, v54, v55
    v_exp_f32 v57, v107
    v_mfma_f32_32x32x16_bf16 v[64:79], a[192:195], v[208:211], v[64:79]
    ds_read_b64_tr_b16 a[220:221], v23 offset:20800
    ds_read_b64_tr_b16 a[222:223], v23 offset:21840
    v_add_f32 v47, v47, v56
    v_exp_f32 v58, v108
    v_add_f32 v47, v47, v57
    v_cvt_pk_bf16_f32 v149, v56, v57
    v_mfma_f32_32x32x16_bf16 a[0:15], a[196:199], v[132:135], a[0:15]
    ds_read_b128 a[192:195], v8 offset:41600
    v_exp_f32 v59, v109
    v_add_f32 v47, v47, v58
    v_exp_f32 v60, v110
    v_add_f32 v47, v47, v59
    s_waitcnt lgkmcnt(6)
    v_mfma_f32_32x32x16_bf16 v[64:79], a[200:203], v[212:215], v[64:79]
    ds_read_b64_tr_b16 a[196:197], v20 offset:24960
    ds_read_b64_tr_b16 a[198:199], v20 offset:26000
    v_cvt_pk_bf16_f32 v150, v58, v59
    v_exp_f32 v61, v111
    v_add_f32 v47, v47, v60
    v_mfma_f32_32x32x16_bf16 a[16:31], a[204:207], v[132:135], a[16:31]
    ds_read_b128 a[200:203], v8 offset:41632
    s_add_u32 m0, s50, 114432
    s_nop 0
    buffer_load_dwordx4 v44, s[76:79], s51 offen offset:2048 sc1 lds
    v_mfma_f32_32x32x16_bf16 v[64:79], a[208:211], v[216:219], v[64:79]
    ds_read_b64_tr_b16 a[204:205], v21 offset:24960
    ds_read_b64_tr_b16 a[206:207], v21 offset:26000
    buffer_load_dwordx4 v44, s[76:79], s51 offen offset:3072 sc1 lds
    s_add_u32 s51, s51, 4096
    s_waitcnt lgkmcnt(6)
    v_mfma_f32_32x32x16_bf16 a[32:47], a[212:215], v[132:135], a[32:47]
    ds_read_b128 a[208:211], v9 offset:41600
    s_add_u32 m0, s50, 124672
    s_nop 0
    buffer_load_dwordx4 v44, s[76:79], s51 offen offset:0 sc1 lds
    buffer_load_dwordx4 v44, s[76:79], s51 offen offset:1024 sc1 lds
    v_mfma_f32_32x32x16_bf16 v[64:79], a[216:219], v[220:223], v[64:79]
    ds_read_b64_tr_b16 a[212:213], v22 offset:24960
    ds_read_b64_tr_b16 a[214:215], v22 offset:26000
    v_add_f32 v47, v47, v61
    v_cvt_pk_bf16_f32 v151, v60, v61
    v_cmp_lt_f32 vcc, s36, v47
    v_mfma_f32_32x32x16_bf16 a[48:63], a[220:223], v[132:135], a[48:63]
    ds_read_b128 a[216:219], v9 offset:41632
    s_cbranch_vccnz L_stub12
L_back12:
    v_add_f32 v45, v45, v47
    s_waitcnt lgkmcnt(7)
    v_mfma_f32_32x32x16_bf16 v[96:111], a[192:195], v[192:195], v[160:175]
    ds_read_b64_tr_b16 a[220:221], v23 offset:24960
    ds_read_b64_tr_b16 a[222:223], v23 offset:26000
    s_add_u32 m0, s50, 130816
    s_nop 0
    buffer_load_dwordx4 v44, s[76:79], s51 offen offset:2048 sc1 lds
    v_mfma_f32_32x32x16_bf16 a[0:15], a[196:199], v[144:147], a[0:15]
    ds_read_b128 a[192:195], v10 offset:41600
    v_exp_f32 v54, v64
    v_exp_f32 v55, v65
    v_exp_f32 v56, v66
    s_waitcnt lgkmcnt(7)
    v_mfma_f32_32x32x16_bf16 v[96:111], a[200:203], v[196:199], v[96:111]
    ds_read_b64_tr_b16 a[196:197], v20 offset:29120
    ds_read_b64_tr_b16 a[198:199], v20 offset:30160
    v_add_f32 v47, v54, v55
    v_cvt_pk_bf16_f32 v128, v54, v55
    v_exp_f32 v57, v67
    v_add_f32 v47, v47, v56
    v_mfma_f32_32x32x16_bf16 a[16:31], a[204:207], v[144:147], a[16:31]
    ds_read_b128 a[200:203], v10 offset:41632
    s_lshl_b32 s41, s2, 10
    s_add_u32 s41, s41, 20340736
    v_exp_f32 v58, v68
    v_add_f32 v47, v47, v57
    v_cvt_pk_bf16_f32 v129, v56, v57
    s_waitcnt lgkmcnt(6)
    v_mfma_f32_32x32x16_bf16 v[96:111], a[208:211], v[200:203], v[96:111]
    ds_read_b64_tr_b16 a[204:205], v21 offset:29120
    ds_read_b64_tr_b16 a[206:207], v21 offset:30160
    v_exp_f32 v59, v69
    v_add_f32 v47, v47, v58
    v_exp_f32 v60, v70
    v_mfma_f32_32x32x16_bf16 a[32:47], a[212:215], v[144:147], a[32:47]
    ds_read_b128 a[208:211], v11 offset:41600
    v_add_u32 v31, s53, v2
    v_and_b32 v31, 7, v31
    v_add_f32 v47, v47, v59
    v_cvt_pk_bf16_f32 v130, v58, v59
    v_exp_f32 v61, v71
    v_mfma_f32_32x32x16_bf16 v[96:111], a[216:219], v[204:207], v[96:111]
    ds_read_b64_tr_b16 a[212:213], v22 offset:29120
    ds_read_b64_tr_b16 a[214:215], v22 offset:30160
    v_add_f32 v47, v47, v60
    v_exp_f32 v54, v72
    v_add_f32 v47, v47, v61
    v_cvt_pk_bf16_f32 v131, v60, v61
    s_waitcnt lgkmcnt(5)
    v_mfma_f32_32x32x16_bf16 a[48:63], a[220:223], v[144:147], a[48:63]
    ds_read_b128 a[216:219], v11 offset:41632
    s_lshl_b32 s34, s32, 5
    v_lshlrev_b32 v31, 2, v31
    v_exp_f32 v55, v73
    v_add_f32 v47, v47, v54
    v_mfma_f32_32x32x16_bf16 v[96:111], a[192:195], v[208:211], v[96:111]
    ds_read_b64_tr_b16 a[220:221], v23 offset:29120
    ds_read_b64_tr_b16 a[222:223], v23 offset:30160
    v_add_u32 v31, s34, v31
    v_exp_f32 v56, v74
    v_add_f32 v47, v47, v55
    v_cvt_pk_bf16_f32 v132, v54, v55
    v_mfma_f32_32x32x16_bf16 a[0:15], a[196:199], v[148:151], a[0:15]
    s_waitcnt vmcnt(28)
    s_barrier
    ds_read_b64_tr_b16 a[192:193], v20 offset:33280
    ds_read_b64_tr_b16 a[194:195], v20 offset:34320
    v_exp_f32 v57, v75
    v_add_f32 v47, v47, v56
    v_mfma_f32_32x32x16_bf16 v[96:111], a[200:203], v[212:215], v[96:111]
    ds_read_b64_tr_b16 a[196:197], v21 offset:33280
    ds_read_b64_tr_b16 a[198:199], v21 offset:34320
    s_add_u32 s20, s8, 263168
    s_addc_u32 s21, s9, 0
    v_exp_f32 v58, v76
    v_add_f32 v47, v47, v57
    s_waitcnt lgkmcnt(6)
    v_mfma_f32_32x32x16_bf16 a[16:31], a[204:207], v[148:151], a[16:31]
    ds_read_b64_tr_b16 a[200:201], v22 offset:33280
    ds_read_b64_tr_b16 a[202:203], v22 offset:34320
    s_mov_b32 s22, 65536
    v_cvt_pk_bf16_f32 v133, v56, v57
    v_exp_f32 v59, v77
    v_add_f32 v47, v47, v58
    v_mfma_f32_32x32x16_bf16 v[96:111], a[208:211], v[216:219], v[96:111]
    ds_read_b64_tr_b16 a[204:205], v23 offset:33280
    ds_read_b64_tr_b16 a[206:207], v23 offset:34320
    s_mov_b32 s23, 0x20000
    v_exp_f32 v60, v78
    v_add_f32 v47, v47, v59
    v_cvt_pk_bf16_f32 v134, v58, v59
    v_mfma_f32_32x32x16_bf16 a[32:47], a[212:215], v[148:151], a[32:47]
    ds_read_b64_tr_b16 a[208:209], v20 offset:37440
    ds_read_b64_tr_b16 a[210:211], v20 offset:38480
    v_exp_f32 v61, v79
    v_add_f32 v47, v47, v60
    buffer_load_dwordx4 v44, s[76:79], s51 offen offset:3072 sc1 lds
    s_add_u32 s51, s51, 4096
    v_mfma_f32_32x32x16_bf16 v[96:111], a[216:219], v[220:223], v[96:111]
    ds_read_b64_tr_b16 a[212:213], v21 offset:37440
    ds_read_b64_tr_b16 a[214:215], v21 offset:38480
    v_add_f32 v47, v47, v61
    v_cvt_pk_bf16_f32 v135, v60, v61
    v_cmp_lt_f32 vcc, s36, v47
    buffer_load_dwordx4 v[36:39], v24, s[76:79], s51 offen offset:0 sc1
    s_waitcnt lgkmcnt(6)
    v_mfma_f32_32x32x16_bf16 a[48:63], a[220:223], v[148:151], a[48:63]
    ds_read_b64_tr_b16 a[216:217], v22 offset:37440
    ds_read_b64_tr_b16 a[218:219], v22 offset:38480
    s_cbranch_vccnz L_stub13
L_back13:
    v_add_f32 v45, v45, v47
    buffer_load_dwordx4 v[40:43], v25, s[76:79], s51 offen offset:0 sc1
    v_mfma_f32_32x32x16_bf16 a[0:15], a[192:195], v[128:131], a[0:15]
    ds_read_b64_tr_b16 a[220:221], v23 offset:37440
    ds_read_b64_tr_b16 a[222:223], v23 offset:38480
    buffer_load_dwordx4 v[192:195], v24, s[76:79], s51 offen offset:2048 sc1
    buffer_load_dwordx4 v[196:199], v25, s[76:79], s51 offen offset:2048 sc1
    s_add_u32 s51, s51, 4096
    v_mfma_f32_32x32x16_bf16 a[16:31], a[196:199], v[128:131], a[16:31]
    ds_read_b64_tr_b16 a[192:193], v20 offset:41600
    ds_read_b64_tr_b16 a[194:195], v20 offset:42640
    v_exp_f32 v54, v96
    v_exp_f32 v55, v97
    v_exp_f32 v56, v98
    v_add_f32 v47, v54, v55
    v_cvt_pk_bf16_f32 v144, v54, v55
    v_exp_f32 v57, v99
    v_add_f32 v47, v47, v56
    v_mfma_f32_32x32x16_bf16 a[32:47], a[200:203], v[128:131], a[32:47]
    ds_read_b64_tr_b16 a[196:197], v21 offset:41600
    ds_read_b64_tr_b16 a[198:199], v21 offset:42640
    v_exp_f32 v58, v100
    v_add_f32 v47, v47, v57
    v_cvt_pk_bf16_f32 v145, v56, v57
    v_exp_f32 v59, v101
    v_add_f32 v47, v47, v58
    v_exp_f32 v60, v102
    v_add_f32 v47, v47, v59
    v_cvt_pk_bf16_f32 v146, v58, v59
    s_waitcnt lgkmcnt(4)
    v_mfma_f32_32x32x16_bf16 a[48:63], a[204:207], v[128:131], a[48:63]
    ds_read_b64_tr_b16 a[200:201], v22 offset:41600
    ds_read_b64_tr_b16 a[202:203], v22 offset:42640
    v_exp_f32 v61, v103
    v_add_f32 v47, v47, v60
    v_exp_f32 v54, v104
    v_add_f32 v47, v47, v61
    v_cvt_pk_bf16_f32 v147, v60, v61
    v_exp_f32 v55, v105
    v_add_f32 v47, v47, v54
    v_mfma_f32_32x32x16_bf16 a[0:15], a[208:211], v[132:135], a[0:15]
    ds_read_b64_tr_b16 a[204:205], v23 offset:41600
    ds_read_b64_tr_b16 a[206:207], v23 offset:42640
    v_exp_f32 v56, v106
    v_add_f32 v47, v47, v55
    v_cvt_pk_bf16_f32 v148, v54, v55
    v_exp_f32 v57, v107
    v_add_f32 v47, v47, v56
    v_exp_f32 v58, v108
    v_add_f32 v47, v47, v57
    v_cvt_pk_bf16_f32 v149, v56, v57
    v_mfma_f32_32x32x16_bf16 a[16:31], a[212:215], v[132:135], a[16:31]
    ds_read_b64_tr_b16 a[208:209], v20 offset:45760
    ds_read_b64_tr_b16 a[210:211], v20 offset:46800
    v_exp_f32 v59, v109
    v_add_f32 v47, v47, v58
    v_exp_f32 v60, v110
    v_add_f32 v47, v47, v59
    v_cvt_pk_bf16_f32 v150, v58, v59
    v_exp_f32 v61, v111
    v_add_f32 v47, v47, v60
    v_mfma_f32_32x32x16_bf16 a[32:47], a[216:219], v[132:135], a[32:47]
    ds_read_b64_tr_b16 a[212:213], v21 offset:45760
    ds_read_b64_tr_b16 a[214:215], v21 offset:46800
    v_add_f32 v47, v47, v61
    v_cvt_pk_bf16_f32 v151, v60, v61
    v_cmp_lt_f32 vcc, s36, v47
    buffer_load_dwordx4 v[200:203], v24, s[76:79], s51 offen offset:0 sc1
    v_mfma_f32_32x32x16_bf16 a[48:63], a[220:223], v[132:135], a[48:63]
    ds_read_b64_tr_b16 a[216:217], v22 offset:45760
    ds_read_b64_tr_b16 a[218:219], v22 offset:46800
    s_cbranch_vccnz L_stub14
L_back14:
    v_add_f32 v45, v45, v47
    buffer_load_dwordx4 v[204:207], v25, s[76:79], s51 offen offset:0 sc1
    s_waitcnt lgkmcnt(6)
    v_mfma_f32_32x32x16_bf16 a[0:15], a[192:195], v[144:147], a[0:15]
    ds_read_b64_tr_b16 a[220:221], v23 offset:45760
    ds_read_b64_tr_b16 a[222:223], v23 offset:46800
    buffer_load_dwordx4 v[208:211], v24, s[76:79], s51 offen offset:2048 sc1
    v_mov_b32 v63, v45
    v_mfma_f32_32x32x16_bf16 a[16:31], a[196:199], v[144:147], a[16:31]
    ds_read_b128 a[192:195], v12 offset:0
    buffer_load_dwordx4 v[212:215], v25, s[76:79], s51 offen offset:2048 sc1
    s_add_u32 s51, s51, 4096
    s_and_b32 s51, s51, 0x1ffff
    v_mfma_f32_32x32x16_bf16 a[32:47], a[200:203], v[144:147], a[32:47]
    ds_read_b64_tr_b16 a[196:197], v16 offset:16640
    ds_read_b64_tr_b16 a[198:199], v16 offset:17680
    buffer_load_dwordx4 v[216:219], v24, s[76:79], s51 offen offset:0 sc1
    s_nop 0
    v_mfma_f32_32x32x16_bf16 a[48:63], a[204:207], v[144:147], a[48:63]
    ds_read_b128 a[200:203], v12 offset:32
    buffer_load_dwordx4 v[220:223], v25, s[76:79], s51 offen offset:0 sc1
    v_permlane32_swap_b32 v45, v63
    v_add_f32 v45, v45, v63
    s_waitcnt lgkmcnt(7)
    v_mfma_f32_32x32x16_bf16 a[0:15], a[208:211], v[148:151], a[0:15]
    ds_read_b64_tr_b16 a[204:205], v17 offset:16640
    ds_read_b64_tr_b16 a[206:207], v17 offset:17680
    v_rcp_f32 v45, v45
    v_mfma_f32_32x32x16_bf16 a[16:31], a[212:215], v[148:151], a[16:31]
    ds_read_b128 a[208:211], v13 offset:0
    s_waitcnt lgkmcnt(8)
    v_mfma_f32_32x32x16_bf16 a[32:47], a[216:219], v[148:151], a[32:47]
    ds_read_b64_tr_b16 a[212:213], v18 offset:16640
    ds_read_b64_tr_b16 a[214:215], v18 offset:17680
    s_waitcnt lgkmcnt(9)
    v_mfma_f32_32x32x16_bf16 a[48:63], a[220:223], v[148:151], a[48:63]
    ds_read_b128 a[216:219], v13 offset:32
    s_waitcnt lgkmcnt(9)
    v_mfma_f32_32x32x16_bf16 v[80:95], a[192:195], v[224:227], v[176:191]
    ds_read_b64_tr_b16 a[220:221], v19 offset:16640
    ds_read_b64_tr_b16 a[222:223], v19 offset:17680
    buffer_load_dwordx4 v[160:163], v24, s[76:79], s51 offen offset:2048 sc1
    s_waitcnt lgkmcnt(9)
    v_mfma_f32_32x32x16_bf16 a[64:79], a[196:199], v[136:139], a[64:79]
    ds_read_b128 a[192:195], v14 offset:0
    v_exp_f32 v54, v112
    v_exp_f32 v55, v113
    v_exp_f32 v56, v114
    s_waitcnt lgkmcnt(9)
    v_mfma_f32_32x32x16_bf16 v[80:95], a[200:203], v[228:231], v[80:95]
    ds_read_b64_tr_b16 a[196:197], v16 offset:20800
    ds_read_b64_tr_b16 a[198:199], v16 offset:21840
    v_add_f32 v48, v54, v55
    v_cvt_pk_bf16_f32 v152, v54, v55
    v_exp_f32 v57, v115
    v_add_f32 v48, v48, v56
    v_accvgpr_read_b32 v64, a0
    v_accvgpr_read_b32 v65, a1
    v_accvgpr_read_b32 v66, a2
    v_accvgpr_read_b32 v67, a3
    v_accvgpr_read_b32 v68, a4
    v_accvgpr_read_b32 v69, a5
    v_accvgpr_read_b32 v70, a6
    v_accvgpr_read_b32 v71, a7
    v_mul_f32 v64, v64, v45
    v_mul_f32 v65, v65, v45
    v_mul_f32 v66, v66, v45
    v_mul_f32 v67, v67, v45
    v_mul_f32 v68, v68, v45
    v_mul_f32 v69, v69, v45
    v_mul_f32 v70, v70, v45
    s_waitcnt lgkmcnt(2)
    v_mfma_f32_32x32x16_bf16 a[80:95], a[204:207], v[136:139], a[80:95]
    ds_read_b128 a[200:203], v14 offset:32
    v_exp_f32 v58, v116
    v_add_f32 v48, v48, v57
    v_cvt_pk_bf16_f32 v153, v56, v57
    v_exp_f32 v59, v117
    v_mul_f32 v71, v71, v45
    v_cvt_pk_bf16_f32 v72, v64, v65
    v_cvt_pk_bf16_f32 v73, v66, v67
    v_cvt_pk_bf16_f32 v74, v68, v69
    v_cvt_pk_bf16_f32 v75, v70, v71
    buffer_store_dwordx4 v[72:75], v44, s[24:27], 0 offen offset:0 sc1
    v_accvgpr_read_b32 v96, a8
    v_accvgpr_read_b32 v97, a9
    v_accvgpr_read_b32 v98, a10
    v_accvgpr_read_b32 v99, a11
    v_accvgpr_read_b32 v100, a12
    v_accvgpr_read_b32 v101, a13
    v_accvgpr_read_b32 v102, a14
    v_mfma_f32_32x32x16_bf16 v[80:95], a[208:211], v[232:235], v[80:95]
    ds_read_b64_tr_b16 a[204:205], v17 offset:20800
    ds_read_b64_tr_b16 a[206:207], v17 offset:21840
    v_add_f32 v48, v48, v58
    v_exp_f32 v60, v118
    v_add_f32 v48, v48, v59
    v_cvt_pk_bf16_f32 v154, v58, v59
    v_accvgpr_read_b32 v103, a15
    v_mul_f32 v96, v96, v45
    v_mul_f32 v97, v97, v45
    v_mul_f32 v98, v98, v45
    v_mul_f32 v99, v99, v45
    v_mul_f32 v100, v100, v45
    v_mul_f32 v101, v101, v45
    v_mul_f32 v102, v102, v45
    v_mul_f32 v103, v103, v45
    v_cvt_pk_bf16_f32 v104, v96, v97
    v_cvt_pk_bf16_f32 v105, v98, v99
    v_cvt_pk_bf16_f32 v106, v100, v101
    v_cvt_pk_bf16_f32 v107, v102, v103
    v_mfma_f32_32x32x16_bf16 a[96:111], a[212:215], v[136:139], a[96:111]
    ds_read_b128 a[208:211], v15 offset:0
    v_exp_f32 v61, v119
    v_add_f32 v48, v48, v60
    v_exp_f32 v54, v120
    v_add_f32 v48, v48, v61
    buffer_store_dwordx4 v[104:107], v44, s[24:27], 0 offen offset:1024 sc1
    v_accvgpr_read_b32 v64, a16
    v_accvgpr_read_b32 v65, a17
    v_accvgpr_read_b32 v66, a18
    v_accvgpr_read_b32 v67, a19
    v_accvgpr_read_b32 v68, a20
    v_accvgpr_read_b32 v69, a21
    v_accvgpr_read_b32 v70, a22
    v_accvgpr_read_b32 v71, a23
    v_mul_f32 v64, v64, v45
    v_mul_f32 v65, v65, v45
    v_mul_f32 v66, v66, v45
    v_mul_f32 v67, v67, v45
    v_mfma_f32_32x32x16_bf16 v[80:95], a[216:219], v[236:239], v[80:95]
    ds_read_b64_tr_b16 a[212:213], v18 offset:20800
    ds_read_b64_tr_b16 a[214:215], v18 offset:21840
    v_cvt_pk_bf16_f32 v155, v60, v61
    v_exp_f32 v55, v121
    v_add_f32 v48, v48, v54
    v_mul_f32 v68, v68, v45
    v_mul_f32 v69, v69, v45
    v_mul_f32 v70, v70, v45
    v_mul_f32 v71, v71, v45
    v_cvt_pk_bf16_f32 v72, v64, v65
    v_cvt_pk_bf16_f32 v73, v66, v67
    v_cvt_pk_bf16_f32 v74, v68, v69
    v_cvt_pk_bf16_f32 v75, v70, v71
    buffer_store_dwordx4 v[72:75], v44, s[24:27], 0 offen offset:2048 sc1
    v_accvgpr_read_b32 v96, a24
    v_accvgpr_read_b32 v97, a25
    v_accvgpr_read_b32 v98, a26
    v_accvgpr_read_b32 v99, a27
    v_accvgpr_read_b32 v100, a28
    v_mfma_f32_32x32x16_bf16 a[112:127], a[220:223], v[136:139], a[112:127]
    ds_read_b128 a[216:219], v15 offset:32
    v_exp_f32 v56, v122
    v_add_f32 v48, v48, v55
    v_cvt_pk_bf16_f32 v156, v54, v55
    v_exp_f32 v57, v123
    v_accvgpr_read_b32 v101, a29
    v_accvgpr_read_b32 v102, a30
    v_accvgpr_read_b32 v103, a31
    v_mul_f32 v96, v96, v45
    v_mul_f32 v97, v97, v45
    v_mul_f32 v98, v98, v45
    v_mul_f32 v99, v99, v45
    v_mul_f32 v100, v100, v45
    v_mul_f32 v101, v101, v45
    v_mul_f32 v102, v102, v45
    v_mul_f32 v103, v103, v45
    v_cvt_pk_bf16_f32 v104, v96, v97
    v_cvt_pk_bf16_f32 v105, v98, v99
    v_cvt_pk_bf16_f32 v106, v100, v101
    v_cvt_pk_bf16_f32 v107, v102, v103
    v_mfma_f32_32x32x16_bf16 v[80:95], a[192:195], v[240:243], v[80:95]
    ds_read_b64_tr_b16 a[220:221], v19 offset:20800
    ds_read_b64_tr_b16 a[222:223], v19 offset:21840
    v_add_f32 v48, v48, v56
    v_exp_f32 v58, v124
    v_add_f32 v48, v48, v57
    v_cvt_pk_bf16_f32 v157, v56, v57
    buffer_store_dwordx4 v[104:107], v44, s[24:27], 0 offen offset:3072 sc1
    v_accvgpr_read_b32 v64, a32
    v_accvgpr_read_b32 v65, a33
    v_accvgpr_read_b32 v66, a34
    v_accvgpr_read_b32 v67, a35
    v_accvgpr_read_b32 v68, a36
    v_accvgpr_read_b32 v69, a37
    v_accvgpr_read_b32 v70, a38
    v_accvgpr_read_b32 v71, a39
    v_mul_f32 v64, v64, v45
    v_mul_f32 v65, v65, v45
    v_mul_f32 v66, v66, v45
    v_mul_f32 v67, v67, v45
    s_waitcnt lgkmcnt(2)
    v_mfma_f32_32x32x16_bf16 a[64:79], a[196:199], v[140:143], a[64:79]
    ds_read_b128 a[192:195], v12 offset:8320
    v_exp_f32 v59, v125
    v_add_f32 v48, v48, v58
    v_exp_f32 v60, v126
    v_add_f32 v48, v48, v59
    v_mul_f32 v68, v68, v45
    v_mul_f32 v69, v69, v45
    v_mul_f32 v70, v70, v45
    v_mul_f32 v71, v71, v45
    v_cvt_pk_bf16_f32 v72, v64, v65
    v_cvt_pk_bf16_f32 v73, v66, v67
    v_cvt_pk_bf16_f32 v74, v68, v69
    v_cvt_pk_bf16_f32 v75, v70, v71
    buffer_store_dwordx4 v[72:75], v44, s[24:27], s39 offen offset:0 sc1
    v_accvgpr_read_b32 v96, a40
    v_accvgpr_read_b32 v97, a41
    v_accvgpr_read_b32 v98, a42
    v_accvgpr_read_b32 v99, a43
    v_mfma_f32_32x32x16_bf16 v[80:95], a[200:203], v[244:247], v[80:95]
    ds_read_b64_tr_b16 a[196:197], v16 offset:24960
    ds_read_b64_tr_b16 a[198:199], v16 offset:26000
    v_cvt_pk_bf16_f32 v158, v58, v59
    v_exp_f32 v61, v127
    v_add_f32 v48, v48, v60
    v_accvgpr_read_b32 v100, a44
    v_accvgpr_read_b32 v101, a45
    v_accvgpr_read_b32 v102, a46
    v_accvgpr_read_b32 v103, a47
    v_mul_f32 v96, v96, v45
    v_mul_f32 v97, v97, v45
    v_mul_f32 v98, v98, v45
    v_mul_f32 v99, v99, v45
    v_mul_f32 v100, v100, v45
    v_mul_f32 v101, v101, v45
    v_mul_f32 v102, v102, v45
    v_mul_f32 v103, v103, v45
    v_cvt_pk_bf16_f32 v104, v96, v97
    v_cvt_pk_bf16_f32 v105, v98, v99
    v_cvt_pk_bf16_f32 v106, v100, v101
    v_cvt_pk_bf16_f32 v107, v102, v103
    v_mfma_f32_32x32x16_bf16 a[80:95], a[204:207], v[140:143], a[80:95]
    ds_read_b128 a[200:203], v12 offset:8352
    buffer_load_dwordx4 v[164:167], v25, s[76:79], s51 offen offset:2048 sc1
    s_add_u32 s51, s51, 4096
    buffer_store_dwordx4 v[104:107], v44, s[24:27], s39 offen offset:1024 sc1
    v_accvgpr_read_b32 v64, a48
    v_accvgpr_read_b32 v65, a49
    v_accvgpr_read_b32 v66, a50
    v_accvgpr_read_b32 v67, a51
    v_accvgpr_read_b32 v68, a52
    v_accvgpr_read_b32 v69, a53
    v_accvgpr_read_b32 v70, a54
    v_accvgpr_read_b32 v71, a55
    v_mul_f32 v64, v64, v45
    v_mul_f32 v65, v65, v45
    v_mul_f32 v66, v66, v45
    v_mul_f32 v67, v67, v45
    v_mul_f32 v68, v68, v45
    v_mul_f32 v69, v69, v45
    v_mfma_f32_32x32x16_bf16 v[80:95], a[208:211], v[248:251], v[80:95]
    ds_read_b64_tr_b16 a[204:205], v17 offset:24960
    ds_read_b64_tr_b16 a[206:207], v17 offset:26000
    v_mul_f32 v70, v70, v45
    v_mul_f32 v71, v71, v45
    v_cvt_pk_bf16_f32 v72, v64, v65
    v_cvt_pk_bf16_f32 v73, v66, v67
    v_cvt_pk_bf16_f32 v74, v68, v69
    v_cvt_pk_bf16_f32 v75, v70, v71
    buffer_store_dwordx4 v[72:75], v44, s[24:27], s39 offen offset:2048 sc1
    v_accvgpr_read_b32 v96, a56
    v_accvgpr_read_b32 v97, a57
    v_accvgpr_read_b32 v98, a58
    v_accvgpr_read_b32 v99, a59
    v_accvgpr_read_b32 v100, a60
    v_accvgpr_read_b32 v101, a61
    v_accvgpr_read_b32 v102, a62
    v_accvgpr_read_b32 v103, a63
    v_mul_f32 v96, v96, v45
    v_mul_f32 v97, v97, v45
    v_mul_f32 v98, v98, v45
    v_mfma_f32_32x32x16_bf16 a[96:111], a[212:215], v[140:143], a[96:111]
    ds_read_b128 a[208:211], v13 offset:8320
    v_mul_f32 v99, v99, v45
    v_mul_f32 v100, v100, v45
    v_mul_f32 v101, v101, v45
    v_mul_f32 v102, v102, v45
    v_mul_f32 v103, v103, v45
    v_cvt_pk_bf16_f32 v104, v96, v97
    v_cvt_pk_bf16_f32 v105, v98, v99
    v_cvt_pk_bf16_f32 v106, v100, v101
    v_cvt_pk_bf16_f32 v107, v102, v103
    buffer_store_dwordx4 v[104:107], v44, s[24:27], s39 offen offset:3072 sc1
    v_mfma_f32_32x32x16_bf16 v[80:95], a[216:219], v[252:255], v[80:95]
    ds_read_b64_tr_b16 a[212:213], v18 offset:24960
    ds_read_b64_tr_b16 a[214:215], v18 offset:26000
    v_add_f32 v48, v48, v61
    v_cvt_pk_bf16_f32 v159, v60, v61
    v_cmp_lt_f32 vcc, s36, v48
    s_waitcnt lgkmcnt(3)
    v_mfma_f32_32x32x16_bf16 a[112:127], a[220:223], v[140:143], a[112:127]
    ds_read_b128 a[216:219], v13 offset:8352
    s_cbranch_vccnz L_stub15
L_back15:
    v_add_f32 v46, v46, v48
    v_mfma_f32_32x32x16_bf16 v[112:127], a[192:195], v[224:227], v[176:191]
    ds_read_b64_tr_b16 a[220:221], v19 offset:24960
    ds_read_b64_tr_b16 a[222:223], v19 offset:26000
    buffer_load_dwordx4 v[168:171], v24, s[76:79], s51 offen offset:0 sc1
    v_mfma_f32_32x32x16_bf16 a[64:79], a[196:199], v[152:155], a[64:79]
    ds_read_b128 a[192:195], v14 offset:8320
    v_exp_f32 v54, v80
    v_exp_f32 v55, v81
    v_exp_f32 v56, v82
    v_mfma_f32_32x32x16_bf16 v[112:127], a[200:203], v[228:231], v[112:127]
    ds_read_b64_tr_b16 a[196:197], v16 offset:29120
    ds_read_b64_tr_b16 a[198:199], v16 offset:30160
    v_add_f32 v48, v54, v55
    v_cvt_pk_bf16_f32 v136, v54, v55
    v_exp_f32 v57, v83
    v_add_f32 v48, v48, v56
    v_mfma_f32_32x32x16_bf16 a[80:95], a[204:207], v[152:155], a[80:95]
    ds_read_b128 a[200:203], v14 offset:8352
    v_exp_f32 v58, v84
    v_add_f32 v48, v48, v57
    v_cvt_pk_bf16_f32 v137, v56, v57
    v_exp_f32 v59, v85
    s_waitcnt lgkmcnt(6)
    v_mfma_f32_32x32x16_bf16 v[112:127], a[208:211], v[232:235], v[112:127]
    ds_read_b64_tr_b16 a[204:205], v17 offset:29120
    ds_read_b64_tr_b16 a[206:207], v17 offset:30160
    v_add_f32 v48, v48, v58
    v_exp_f32 v60, v86
    v_add_f32 v48, v48, v59
    v_cvt_pk_bf16_f32 v138, v58, v59
    v_mfma_f32_32x32x16_bf16 a[96:111], a[212:215], v[152:155], a[96:111]
    ds_read_b128 a[208:211], v15 offset:8320
    v_exp_f32 v61, v87
    v_add_f32 v48, v48, v60
    v_exp_f32 v54, v88
    v_add_f32 v48, v48, v61
    v_mfma_f32_32x32x16_bf16 v[112:127], a[216:219], v[236:239], v[112:127]
    ds_read_b64_tr_b16 a[212:213], v18 offset:29120
    ds_read_b64_tr_b16 a[214:215], v18 offset:30160
    v_cvt_pk_bf16_f32 v139, v60, v61
    v_exp_f32 v55, v89
    v_add_f32 v48, v48, v54
    s_waitcnt lgkmcnt(6)
    v_mfma_f32_32x32x16_bf16 a[112:127], a[220:223], v[152:155], a[112:127]
    ds_read_b128 a[216:219], v15 offset:8352
    v_exp_f32 v56, v90
    v_add_f32 v48, v48, v55
    v_cvt_pk_bf16_f32 v140, v54, v55
    v_exp_f32 v57, v91
    v_mfma_f32_32x32x16_bf16 v[112:127], a[192:195], v[240:243], v[112:127]
    ds_read_b64_tr_b16 a[220:221], v19 offset:29120
    ds_read_b64_tr_b16 a[222:223], v19 offset:30160
    v_add_f32 v48, v48, v56
    v_exp_f32 v58, v92
    v_add_f32 v48, v48, v57
    v_cvt_pk_bf16_f32 v141, v56, v57
    v_mfma_f32_32x32x16_bf16 a[64:79], a[196:199], v[156:159], a[64:79]
    ds_read_b128 a[192:195], v8 offset:0
    v_exp_f32 v59, v93
    v_add_f32 v48, v48, v58
    v_exp_f32 v60, v94
    v_add_f32 v48, v48, v59
    s_waitcnt lgkmcnt(6)
    v_mfma_f32_32x32x16_bf16 v[112:127], a[200:203], v[244:247], v[112:127]
    ds_read_b64_tr_b16 a[196:197], v16 offset:49920
    ds_read_b64_tr_b16 a[198:199], v16 offset:50960
    v_cvt_pk_bf16_f32 v142, v58, v59
    v_exp_f32 v61, v95
    v_add_f32 v48, v48, v60
    v_mfma_f32_32x32x16_bf16 a[80:95], a[204:207], v[156:159], a[80:95]
    ds_read_b128 a[200:203], v8 offset:32
    buffer_load_dwordx4 v[172:175], v25, s[76:79], s51 offen offset:0 sc1
    v_mfma_f32_32x32x16_bf16 v[112:127], a[208:211], v[248:251], v[112:127]
    ds_read_b64_tr_b16 a[204:205], v17 offset:49920
    ds_read_b64_tr_b16 a[206:207], v17 offset:50960
    buffer_load_dwordx4 v[128:131], v24, s[76:79], s51 offen offset:2048 sc1
    s_waitcnt lgkmcnt(7)
    v_mfma_f32_32x32x16_bf16 a[96:111], a[212:215], v[156:159], a[96:111]
    ds_read_b128 a[208:211], v9 offset:0
    buffer_load_dwordx4 v[132:135], v25, s[76:79], s51 offen offset:2048 sc1
    s_add_u32 s51, s51, 4096
    v_mfma_f32_32x32x16_bf16 v[112:127], a[216:219], v[252:255], v[112:127]
    ds_read_b64_tr_b16 a[212:213], v18 offset:49920
    ds_read_b64_tr_b16 a[214:215], v18 offset:50960
    v_add_f32 v48, v48, v61
    v_cvt_pk_bf16_f32 v143, v60, v61
    v_cmp_lt_f32 vcc, s36, v48
    s_waitcnt lgkmcnt(8)
    v_mfma_f32_32x32x16_bf16 a[112:127], a[220:223], v[156:159], a[112:127]
    ds_read_b128 a[216:219], v9 offset:32
    s_cbranch_vccnz L_stub16
L_back16:
    v_add_f32 v46, v46, v48
    v_mfma_f32_32x32x16_bf16 v[80:95], a[192:195], v[224:227], v[176:191]
    ds_read_b64_tr_b16 a[220:221], v19 offset:49920
    ds_read_b64_tr_b16 a[222:223], v19 offset:50960
    buffer_load_dwordx4 v[144:147], v24, s[76:79], s51 offen offset:0 sc1
    buffer_load_dwordx4 v[148:151], v25, s[76:79], s51 offen offset:0 sc1
    s_waitcnt lgkmcnt(8)
    v_mfma_f32_32x32x16_bf16 a[64:79], a[196:199], v[136:139], a[64:79]
    ds_read_b128 a[192:195], v10 offset:0
    v_exp_f32 v54, v112
    v_exp_f32 v55, v113
    v_exp_f32 v56, v114
    v_mfma_f32_32x32x16_bf16 v[80:95], a[200:203], v[228:231], v[80:95]
    ds_read_b64_tr_b16 a[196:197], v16 offset:54080
    ds_read_b64_tr_b16 a[198:199], v16 offset:55120
    v_add_f32 v48, v54, v55
    v_cvt_pk_bf16_f32 v152, v54, v55
    v_exp_f32 v57, v115
    v_add_f32 v48, v48, v56
    s_waitcnt lgkmcnt(6)
    v_mfma_f32_32x32x16_bf16 a[80:95], a[204:207], v[136:139], a[80:95]
    ds_read_b128 a[200:203], v10 offset:32
    v_exp_f32 v58, v116
    v_add_f32 v48, v48, v57
    v_cvt_pk_bf16_f32 v153, v56, v57
    v_exp_f32 v59, v117
    v_mfma_f32_32x32x16_bf16 v[80:95], a[208:211], v[232:235], v[80:95]
    ds_read_b64_tr_b16 a[204:205], v17 offset:54080
    ds_read_b64_tr_b16 a[206:207], v17 offset:55120
    v_add_f32 v48, v48, v58
    v_exp_f32 v60, v118
    v_add_f32 v48, v48, v59
    v_cvt_pk_bf16_f32 v154, v58, v59
    v_mfma_f32_32x32x16_bf16 a[96:111], a[212:215], v[136:139], a[96:111]
    ds_read_b128 a[208:211], v11 offset:0
    v_exp_f32 v61, v119
    v_add_f32 v48, v48, v60
    v_exp_f32 v54, v120
    v_add_f32 v48, v48, v61
    s_waitcnt lgkmcnt(5)
    v_mfma_f32_32x32x16_bf16 v[80:95], a[216:219], v[236:239], v[80:95]
    ds_read_b64_tr_b16 a[212:213], v18 offset:54080
    ds_read_b64_tr_b16 a[214:215], v18 offset:55120
    v_cvt_pk_bf16_f32 v155, v60, v61
    v_exp_f32 v55, v121
    v_add_f32 v48, v48, v54
    buffer_load_dwordx4 a[0:3], v24, s[76:79], s51 offen offset:2048 sc1
    v_mfma_f32_32x32x16_bf16 a[112:127], a[220:223], v[136:139], a[112:127]
    ds_read_b128 a[216:219], v11 offset:32
    v_exp_f32 v56, v122
    v_add_f32 v48, v48, v55
    v_cvt_pk_bf16_f32 v156, v54, v55
    v_exp_f32 v57, v123
    v_mfma_f32_32x32x16_bf16 v[80:95], a[192:195], v[240:243], v[80:95]
    ds_read_b64_tr_b16 a[220:221], v19 offset:54080
    ds_read_b64_tr_b16 a[222:223], v19 offset:55120
    v_add_f32 v48, v48, v56
    v_exp_f32 v58, v124
    v_add_f32 v48, v48, v57
    v_cvt_pk_bf16_f32 v157, v56, v57
    s_waitcnt lgkmcnt(5)
    v_mfma_f32_32x32x16_bf16 a[64:79], a[196:199], v[140:143], a[64:79]
    ds_read_b128 a[192:195], v8 offset:8320
    v_exp_f32 v59, v125
    v_add_f32 v48, v48, v58
    v_exp_f32 v60, v126
    v_add_f32 v48, v48, v59
    v_mfma_f32_32x32x16_bf16 v[80:95], a[200:203], v[244:247], v[80:95]
    ds_read_b64_tr_b16 a[196:197], v16 offset:58240
    ds_read_b64_tr_b16 a[198:199], v16 offset:59280
    v_cvt_pk_bf16_f32 v158, v58, v59
    v_exp_f32 v61, v127
    v_add_f32 v48, v48, v60
    v_mfma_f32_32x32x16_bf16 a[80:95], a[204:207], v[140:143], a[80:95]
    ds_read_b128 a[200:203], v8 offset:8352
    buffer_load_dwordx4 a[4:7], v25, s[76:79], s51 offen offset:2048 sc1
    s_add_u32 s51, s51, 4096
    buffer_load_dwordx4 a[8:11], v24, s[76:79], s51 offen offset:0 sc1
    v_mfma_f32_32x32x16_bf16 v[80:95], a[208:211], v[248:251], v[80:95]
    ds_read_b64_tr_b16 a[204:205], v17 offset:58240
    ds_read_b64_tr_b16 a[206:207], v17 offset:59280
    buffer_load_dwordx4 a[12:15], v25, s[76:79], s51 offen offset:0 sc1
    buffer_load_dwordx4 a[16:19], v24, s[76:79], s51 offen offset:2048 sc1
    s_waitcnt lgkmcnt(6)
    v_mfma_f32_32x32x16_bf16 a[96:111], a[212:215], v[140:143], a[96:111]
    ds_read_b128 a[208:211], v9 offset:8320
    buffer_load_dwordx4 a[20:23], v25, s[76:79], s51 offen offset:2048 sc1
    s_add_u32 s51, s51, 4096
    s_and_b32 s51, s51, 0x1ffff
    v_mfma_f32_32x32x16_bf16 v[80:95], a[216:219], v[252:255], v[80:95]
    ds_read_b64_tr_b16 a[212:213], v18 offset:58240
    ds_read_b64_tr_b16 a[214:215], v18 offset:59280
    v_add_f32 v48, v48, v61
    v_cvt_pk_bf16_f32 v159, v60, v61
    v_cmp_lt_f32 vcc, s36, v48
    v_mfma_f32_32x32x16_bf16 a[112:127], a[220:223], v[140:143], a[112:127]
    ds_read_b128 a[216:219], v9 offset:8352
    s_cbranch_vccnz L_stub17
L_back17:
    v_add_f32 v46, v46, v48
    s_waitcnt lgkmcnt(7)
    v_mfma_f32_32x32x16_bf16 v[112:127], a[192:195], v[224:227], v[176:191]
    ds_read_b64_tr_b16 a[220:221], v19 offset:58240
    ds_read_b64_tr_b16 a[222:223], v19 offset:59280
    buffer_load_dwordx4 a[24:27], v24, s[76:79], s51 offen offset:0 sc1
    buffer_load_dwordx4 a[28:31], v25, s[76:79], s51 offen offset:0 sc1
    v_mfma_f32_32x32x16_bf16 a[64:79], a[196:199], v[152:155], a[64:79]
    ds_read_b128 a[192:195], v10 offset:8320
    v_exp_f32 v54, v80
    v_exp_f32 v55, v81
    v_exp_f32 v56, v82
    s_waitcnt lgkmcnt(7)
    v_mfma_f32_32x32x16_bf16 v[112:127], a[200:203], v[228:231], v[112:127]
    ds_read_b64_tr_b16 a[196:197], v16 offset:62400
    ds_read_b64_tr_b16 a[198:199], v16 offset:63440
    v_add_f32 v48, v54, v55
    v_cvt_pk_bf16_f32 v136, v54, v55
    v_exp_f32 v57, v83
    v_add_f32 v48, v48, v56
    v_mfma_f32_32x32x16_bf16 a[80:95], a[204:207], v[152:155], a[80:95]
    ds_read_b128 a[200:203], v10 offset:8352
    v_exp_f32 v58, v84
    v_add_f32 v48, v48, v57
    v_cvt_pk_bf16_f32 v137, v56, v57
    v_exp_f32 v59, v85
    s_waitcnt lgkmcnt(6)
    v_mfma_f32_32x32x16_bf16 v[112:127], a[208:211], v[232:235], v[112:127]
    ds_read_b64_tr_b16 a[204:205], v17 offset:62400
    ds_read_b64_tr_b16 a[206:207], v17 offset:63440
    v_add_f32 v48, v48, v58
    v_exp_f32 v60, v86
    v_add_f32 v48, v48, v59
    v_cvt_pk_bf16_f32 v138, v58, v59
    v_mfma_f32_32x32x16_bf16 a[96:111], a[212:215], v[152:155], a[96:111]
    ds_read_b128 a[208:211], v11 offset:8320
    v_exp_f32 v61, v87
    v_add_f32 v48, v48, v60
    v_exp_f32 v54, v88
    v_add_f32 v48, v48, v61
    v_mfma_f32_32x32x16_bf16 v[112:127], a[216:219], v[236:239], v[112:127]
    ds_read_b64_tr_b16 a[212:213], v18 offset:62400
    ds_read_b64_tr_b16 a[214:215], v18 offset:63440
    v_cvt_pk_bf16_f32 v139, v60, v61
    v_exp_f32 v55, v89
    v_add_f32 v48, v48, v54
    s_waitcnt lgkmcnt(6)
    v_mfma_f32_32x32x16_bf16 a[112:127], a[220:223], v[152:155], a[112:127]
    ds_read_b128 a[216:219], v11 offset:8352
    v_exp_f32 v56, v90
    v_add_f32 v48, v48, v55
    v_cvt_pk_bf16_f32 v140, v54, v55
    v_exp_f32 v57, v91
    v_mfma_f32_32x32x16_bf16 v[112:127], a[192:195], v[240:243], v[112:127]
    ds_read_b64_tr_b16 a[220:221], v19 offset:62400
    ds_read_b64_tr_b16 a[222:223], v19 offset:63440
    v_add_f32 v48, v48, v56
    v_exp_f32 v58, v92
    v_add_f32 v48, v48, v57
    v_cvt_pk_bf16_f32 v141, v56, v57
    v_mfma_f32_32x32x16_bf16 a[64:79], a[196:199], v[156:159], a[64:79]
    s_waitcnt vmcnt(14)
    s_barrier
    buffer_store_dword v35, v26, s[28:31], s48 offen sc1
    ds_read_b128 a[192:195], v8 offset:33280
    v_exp_f32 v59, v93
    s_waitcnt lgkmcnt(6)
    v_mfma_f32_32x32x16_bf16 v[112:127], a[200:203], v[244:247], v[112:127]
    ds_read_b64_tr_b16 a[196:197], v20 offset:16640
    ds_read_b64_tr_b16 a[198:199], v20 offset:17680
    v_add_f32 v48, v48, v58
    v_exp_f32 v60, v94
    v_add_f32 v48, v48, v59
    v_cvt_pk_bf16_f32 v142, v58, v59
    v_mfma_f32_32x32x16_bf16 a[80:95], a[204:207], v[156:159], a[80:95]
    ds_read_b128 a[200:203], v8 offset:33312
    v_exp_f32 v61, v95
    v_add_f32 v48, v48, v60
    buffer_load_dwordx4 a[32:35], v24, s[76:79], s51 offen offset:2048 sc1
    v_mfma_f32_32x32x16_bf16 v[112:127], a[208:211], v[248:251], v[112:127]
    ds_read_b64_tr_b16 a[204:205], v21 offset:16640
    ds_read_b64_tr_b16 a[206:207], v21 offset:17680
    buffer_load_dwordx4 a[36:39], v25, s[76:79], s51 offen offset:2048 sc1
    s_add_u32 s51, s51, 4096
    s_waitcnt lgkmcnt(6)
    v_mfma_f32_32x32x16_bf16 a[96:111], a[212:215], v[156:159], a[96:111]
    ds_read_b128 a[208:211], v9 offset:33280
    buffer_load_dwordx4 a[40:43], v24, s[76:79], s51 offen offset:0 sc1
    buffer_load_dwordx4 a[44:47], v25, s[76:79], s51 offen offset:0 sc1
    v_mfma_f32_32x32x16_bf16 v[112:127], a[216:219], v[252:255], v[112:127]
    ds_read_b64_tr_b16 a[212:213], v22 offset:16640
    ds_read_b64_tr_b16 a[214:215], v22 offset:17680
    v_add_f32 v48, v48, v61
    v_cvt_pk_bf16_f32 v143, v60, v61
    v_cmp_lt_f32 vcc, s36, v48
    buffer_load_dwordx4 a[48:51], v24, s[76:79], s51 offen offset:2048 sc1
    v_mfma_f32_32x32x16_bf16 a[112:127], a[220:223], v[156:159], a[112:127]
    ds_read_b128 a[216:219], v9 offset:33312
    s_cbranch_vccnz L_stub18
L_back18:
    v_add_f32 v46, v46, v48
    buffer_load_dwordx4 a[52:55], v25, s[76:79], s51 offen offset:2048 sc1
    s_add_u32 s51, s51, 4096
    s_waitcnt lgkmcnt(6)
    v_mfma_f32_32x32x16_bf16 v[80:95], a[192:195], v[224:227], v[176:191]
    ds_read_b64_tr_b16 a[220:221], v23 offset:16640
    ds_read_b64_tr_b16 a[222:223], v23 offset:17680
    buffer_load_dwordx4 a[56:59], v24, s[76:79], s51 offen offset:0 sc1
    buffer_load_dwordx4 a[60:63], v25, s[76:79], s51 offen offset:0 sc1
    v_mfma_f32_32x32x16_bf16 a[64:79], a[196:199], v[136:139], a[64:79]
    ds_read_b128 a[192:195], v10 offset:33280
    v_exp_f32 v54, v112
    v_exp_f32 v55, v113
    v_exp_f32 v56, v114
    v_mfma_f32_32x32x16_bf16 v[80:95], a[200:203], v[228:231], v[80:95]
    ds_read_b64_tr_b16 a[196:197], v20 offset:20800
    ds_read_b64_tr_b16 a[198:199], v20 offset:21840
    v_add_f32 v48, v54, v55
    v_cvt_pk_bf16_f32 v152, v54, v55
    v_exp_f32 v57, v115
    v_add_f32 v48, v48, v56
    s_waitcnt lgkmcnt(6)
    v_mfma_f32_32x32x16_bf16 a[80:95], a[204:207], v[136:139], a[80:95]
    ds_read_b128 a[200:203], v10 offset:33312
    v_exp_f32 v58, v116
    v_add_f32 v48, v48, v57
    v_cvt_pk_bf16_f32 v153, v56, v57
    v_exp_f32 v59, v117
    v_mfma_f32_32x32x16_bf16 v[80:95], a[208:211], v[232:235], v[80:95]
    ds_read_b64_tr_b16 a[204:205], v21 offset:20800
    ds_read_b64_tr_b16 a[206:207], v21 offset:21840
    v_add_f32 v48, v48, v58
    v_exp_f32 v60, v118
    v_add_f32 v48, v48, v59
    v_cvt_pk_bf16_f32 v154, v58, v59
    v_mfma_f32_32x32x16_bf16 a[96:111], a[212:215], v[136:139], a[96:111]
    ds_read_b128 a[208:211], v11 offset:33280
    v_exp_f32 v61, v119
    v_add_f32 v48, v48, v60
    v_exp_f32 v54, v120
    v_add_f32 v48, v48, v61
    s_waitcnt lgkmcnt(5)
    v_mfma_f32_32x32x16_bf16 v[80:95], a[216:219], v[236:239], v[80:95]
    ds_read_b64_tr_b16 a[212:213], v22 offset:20800
    ds_read_b64_tr_b16 a[214:215], v22 offset:21840
    v_cvt_pk_bf16_f32 v155, v60, v61
    v_exp_f32 v55, v121
    v_add_f32 v48, v48, v54
    v_mfma_f32_32x32x16_bf16 a[112:127], a[220:223], v[136:139], a[112:127]
    ds_read_b128 a[216:219], v11 offset:33312
    v_exp_f32 v56, v122
    v_add_f32 v48, v48, v55
    v_cvt_pk_bf16_f32 v156, v54, v55
    v_exp_f32 v57, v123
    v_mfma_f32_32x32x16_bf16 v[80:95], a[192:195], v[240:243], v[80:95]
    ds_read_b64_tr_b16 a[220:221], v23 offset:20800
    ds_read_b64_tr_b16 a[222:223], v23 offset:21840
    v_add_f32 v48, v48, v56
    v_exp_f32 v58, v124
    v_add_f32 v48, v48, v57
    v_cvt_pk_bf16_f32 v157, v56, v57
    s_waitcnt lgkmcnt(6)
    v_mfma_f32_32x32x16_bf16 a[64:79], a[196:199], v[140:143], a[64:79]
    ds_read_b128 a[192:195], v8 offset:41600
    v_exp_f32 v59, v125
    v_add_f32 v48, v48, v58
    v_exp_f32 v60, v126
    v_add_f32 v48, v48, v59
    v_mfma_f32_32x32x16_bf16 v[80:95], a[200:203], v[244:247], v[80:95]
    ds_read_b64_tr_b16 a[196:197], v20 offset:24960
    ds_read_b64_tr_b16 a[198:199], v20 offset:26000
    v_cvt_pk_bf16_f32 v158, v58, v59
    v_exp_f32 v61, v127
    v_add_f32 v48, v48, v60
    v_mfma_f32_32x32x16_bf16 a[80:95], a[204:207], v[140:143], a[80:95]
    ds_read_b128 a[200:203], v8 offset:41632
    s_add_u32 m0, s50, 64512
    s_nop 0
    buffer_load_dwordx4 v44, s[76:79], s51 offen offset:2048 sc1 lds
    s_waitcnt lgkmcnt(6)
    v_mfma_f32_32x32x16_bf16 v[80:95], a[208:211], v[248:251], v[80:95]
    ds_read_b64_tr_b16 a[204:205], v21 offset:24960
    ds_read_b64_tr_b16 a[206:207], v21 offset:26000
    buffer_load_dwordx4 v44, s[76:79], s51 offen offset:3072 sc1 lds
    s_add_u32 s51, s51, 4096
    v_mfma_f32_32x32x16_bf16 a[96:111], a[212:215], v[140:143], a[96:111]
    ds_read_b128 a[208:211], v9 offset:41600
    s_add_u32 m0, s50, 74752
    s_nop 0
    buffer_load_dwordx4 v44, s[76:79], s51 offen offset:0 sc1 lds
    buffer_load_dwordx4 v44, s[76:79], s51 offen offset:1024 sc1 lds
    v_mfma_f32_32x32x16_bf16 v[80:95], a[216:219], v[252:255], v[80:95]
    ds_read_b64_tr_b16 a[212:213], v22 offset:24960
    ds_read_b64_tr_b16 a[214:215], v22 offset:26000
    v_add_f32 v48, v48, v61
    v_cvt_pk_bf16_f32 v159, v60, v61
    v_cmp_lt_f32 vcc, s36, v48
    s_waitcnt lgkmcnt(7)
    v_mfma_f32_32x32x16_bf16 a[112:127], a[220:223], v[140:143], a[112:127]
    ds_read_b128 a[216:219], v9 offset:41632
    s_cbranch_vccnz L_stub19
L_back19:
    v_add_f32 v46, v46, v48
    v_mfma_f32_32x32x16_bf16 v[112:127], a[192:195], v[224:227], v[176:191]
    ds_read_b64_tr_b16 a[220:221], v23 offset:24960
    ds_read_b64_tr_b16 a[222:223], v23 offset:26000
    s_add_u32 m0, s50, 14592
    s_nop 0
    buffer_load_dwordx4 v44, s[76:79], s51 offen offset:2048 sc1 lds
    s_waitcnt lgkmcnt(8)
    v_mfma_f32_32x32x16_bf16 a[64:79], a[196:199], v[152:155], a[64:79]
    ds_read_b128 a[192:195], v10 offset:41600
    v_exp_f32 v54, v80
    v_exp_f32 v55, v81
    v_exp_f32 v56, v82
    v_mfma_f32_32x32x16_bf16 v[112:127], a[200:203], v[228:231], v[112:127]
    ds_read_b64_tr_b16 a[196:197], v20 offset:29120
    ds_read_b64_tr_b16 a[198:199], v20 offset:30160
    v_add_f32 v48, v54, v55
    v_cvt_pk_bf16_f32 v136, v54, v55
    v_exp_f32 v57, v83
    v_add_f32 v48, v48, v56
    s_waitcnt lgkmcnt(6)
    v_mfma_f32_32x32x16_bf16 a[80:95], a[204:207], v[152:155], a[80:95]
    ds_read_b128 a[200:203], v10 offset:41632
    v_exp_f32 v58, v84
    v_add_f32 v48, v48, v57
    v_cvt_pk_bf16_f32 v137, v56, v57
    v_exp_f32 v59, v85
    v_mfma_f32_32x32x16_bf16 v[112:127], a[208:211], v[232:235], v[112:127]
    ds_read_b64_tr_b16 a[204:205], v21 offset:29120
    ds_read_b64_tr_b16 a[206:207], v21 offset:30160
    v_add_f32 v48, v48, v58
    v_exp_f32 v60, v86
    v_add_f32 v48, v48, v59
    v_cvt_pk_bf16_f32 v138, v58, v59
    v_mfma_f32_32x32x16_bf16 a[96:111], a[212:215], v[152:155], a[96:111]
    ds_read_b128 a[208:211], v11 offset:41600
    v_exp_f32 v61, v87
    v_add_f32 v48, v48, v60
    v_exp_f32 v54, v88
    v_add_f32 v48, v48, v61
    s_waitcnt lgkmcnt(5)
    v_mfma_f32_32x32x16_bf16 v[112:127], a[216:219], v[236:239], v[112:127]
    ds_read_b64_tr_b16 a[212:213], v22 offset:29120
    ds_read_b64_tr_b16 a[214:215], v22 offset:30160
    v_cvt_pk_bf16_f32 v139, v60, v61
    v_exp_f32 v55, v89
    v_add_f32 v48, v48, v54
    v_mfma_f32_32x32x16_bf16 a[112:127], a[220:223], v[152:155], a[112:127]
    ds_read_b128 a[216:219], v11 offset:41632
    v_exp_f32 v56, v90
    v_add_f32 v48, v48, v55
    v_cvt_pk_bf16_f32 v140, v54, v55
    v_exp_f32 v57, v91
    v_mfma_f32_32x32x16_bf16 v[112:127], a[192:195], v[240:243], v[112:127]
    ds_read_b64_tr_b16 a[220:221], v23 offset:29120
    ds_read_b64_tr_b16 a[222:223], v23 offset:30160
    v_add_f32 v48, v48, v56
    v_exp_f32 v58, v92
    v_add_f32 v48, v48, v57
    v_cvt_pk_bf16_f32 v141, v56, v57
    s_waitcnt lgkmcnt(6)
    v_mfma_f32_32x32x16_bf16 a[64:79], a[196:199], v[156:159], a[64:79]
    ds_read_b64_tr_b16 a[192:193], v20 offset:33280
    ds_read_b64_tr_b16 a[194:195], v20 offset:34320
    v_exp_f32 v59, v93
    v_add_f32 v48, v48, v58
    v_exp_f32 v60, v94
    v_mfma_f32_32x32x16_bf16 v[112:127], a[200:203], v[244:247], v[112:127]
    ds_read_b64_tr_b16 a[196:197], v21 offset:33280
    ds_read_b64_tr_b16 a[198:199], v21 offset:34320
    v_add_f32 v48, v48, v59
    v_cvt_pk_bf16_f32 v142, v58, v59
    v_exp_f32 v61, v95
    v_add_f32 v48, v48, v60
    v_mfma_f32_32x32x16_bf16 a[80:95], a[204:207], v[156:159], a[80:95]
    ds_read_b64_tr_b16 a[200:201], v22 offset:33280
    ds_read_b64_tr_b16 a[202:203], v22 offset:34320
    buffer_load_dwordx4 v44, s[76:79], s51 offen offset:3072 sc1 lds
    s_add_u32 s51, s51, 4096
    s_and_b32 s51, s51, 0x1ffff
    s_waitcnt lgkmcnt(7)
    v_mfma_f32_32x32x16_bf16 v[112:127], a[208:211], v[248:251], v[112:127]
    ds_read_b64_tr_b16 a[204:205], v23 offset:33280
    ds_read_b64_tr_b16 a[206:207], v23 offset:34320
    s_add_u32 m0, s50, 24832
    s_nop 0
    buffer_load_dwordx4 v44, s[76:79], s51 offen offset:0 sc1 lds
    buffer_load_dwordx4 v44, s[76:79], s51 offen offset:1024 sc1 lds
    v_mfma_f32_32x32x16_bf16 a[96:111], a[212:215], v[156:159], a[96:111]
    ds_read_b64_tr_b16 a[208:209], v20 offset:37440
    ds_read_b64_tr_b16 a[210:211], v20 offset:38480
    s_add_u32 m0, s50, 6144
    s_nop 0
    buffer_load_dwordx4 v44, s[76:79], s51 offen offset:2048 sc1 lds
    v_mfma_f32_32x32x16_bf16 v[112:127], a[216:219], v[252:255], v[112:127]
    ds_read_b64_tr_b16 a[212:213], v21 offset:37440
    ds_read_b64_tr_b16 a[214:215], v21 offset:38480
    v_add_f32 v48, v48, v61
    v_cvt_pk_bf16_f32 v143, v60, v61
    v_cmp_lt_f32 vcc, s36, v48
    buffer_load_dwordx4 v44, s[76:79], s51 offen offset:3072 sc1 lds
    s_add_u32 s51, s51, 4096
    s_waitcnt lgkmcnt(8)
    v_mfma_f32_32x32x16_bf16 a[112:127], a[220:223], v[156:159], a[112:127]
    ds_read_b64_tr_b16 a[216:217], v22 offset:37440
    ds_read_b64_tr_b16 a[218:219], v22 offset:38480
    s_cbranch_vccnz L_stub20
L_back20:
    v_add_f32 v46, v46, v48
    v_mfma_f32_32x32x16_bf16 a[64:79], a[192:195], v[136:139], a[64:79]
    ds_read_b64_tr_b16 a[220:221], v23 offset:37440
    ds_read_b64_tr_b16 a[222:223], v23 offset:38480
    s_add_u32 m0, s50, 0
    s_nop 0
    buffer_load_dwordx4 v44, s[76:79], s51 offen offset:0 sc1 lds
    buffer_load_dwordx4 v44, s[76:79], s51 offen offset:1024 sc1 lds
    v_mfma_f32_32x32x16_bf16 a[80:95], a[196:199], v[136:139], a[80:95]
    ds_read_b64_tr_b16 a[192:193], v20 offset:41600
    ds_read_b64_tr_b16 a[194:195], v20 offset:42640
    v_exp_f32 v54, v112
    v_exp_f32 v55, v113
    v_exp_f32 v56, v114
    v_add_f32 v48, v54, v55
    v_cvt_pk_bf16_f32 v152, v54, v55
    v_exp_f32 v57, v115
    v_add_f32 v48, v48, v56
    s_waitcnt lgkmcnt(6)
    v_mfma_f32_32x32x16_bf16 a[96:111], a[200:203], v[136:139], a[96:111]
    ds_read_b64_tr_b16 a[196:197], v21 offset:41600
    ds_read_b64_tr_b16 a[198:199], v21 offset:42640
    v_exp_f32 v58, v116
    v_add_f32 v48, v48, v57
    v_cvt_pk_bf16_f32 v153, v56, v57
    v_exp_f32 v59, v117
    v_add_f32 v48, v48, v58
    v_exp_f32 v60, v118
    v_add_f32 v48, v48, v59
    v_cvt_pk_bf16_f32 v154, v58, v59
    v_mfma_f32_32x32x16_bf16 a[112:127], a[204:207], v[136:139], a[112:127]
    ds_read_b64_tr_b16 a[200:201], v22 offset:41600
    ds_read_b64_tr_b16 a[202:203], v22 offset:42640
    v_exp_f32 v61, v119
    v_add_f32 v48, v48, v60
    v_exp_f32 v54, v120
    v_add_f32 v48, v48, v61
    v_cvt_pk_bf16_f32 v155, v60, v61
    v_exp_f32 v55, v121
    v_add_f32 v48, v48, v54
    v_mfma_f32_32x32x16_bf16 a[64:79], a[208:211], v[140:143], a[64:79]
    ds_read_b64_tr_b16 a[204:205], v23 offset:41600
    ds_read_b64_tr_b16 a[206:207], v23 offset:42640
    v_exp_f32 v56, v122
    v_add_f32 v48, v48, v55
    v_cvt_pk_bf16_f32 v156, v54, v55
    v_exp_f32 v57, v123
    v_add_f32 v48, v48, v56
    v_exp_f32 v58, v124
    v_add_f32 v48, v48, v57
    v_cvt_pk_bf16_f32 v157, v56, v57
    v_mfma_f32_32x32x16_bf16 a[80:95], a[212:215], v[140:143], a[80:95]
    ds_read_b64_tr_b16 a[208:209], v20 offset:45760
    ds_read_b64_tr_b16 a[210:211], v20 offset:46800
    v_exp_f32 v59, v125
    v_add_f32 v48, v48, v58
    v_exp_f32 v60, v126
    v_add_f32 v48, v48, v59
    v_cvt_pk_bf16_f32 v158, v58, v59
    v_exp_f32 v61, v127
    v_add_f32 v48, v48, v60
    s_waitcnt lgkmcnt(4)
    v_mfma_f32_32x32x16_bf16 a[96:111], a[216:219], v[140:143], a[96:111]
    ds_read_b64_tr_b16 a[212:213], v21 offset:45760
    ds_read_b64_tr_b16 a[214:215], v21 offset:46800
    v_add_f32 v48, v48, v61
    v_cvt_pk_bf16_f32 v159, v60, v61
    v_cmp_lt_f32 vcc, s36, v48
    s_add_u32 m0, s50, 47872
    s_nop 0
    buffer_load_dwordx4 v44, s[76:79], s51 offen offset:2048 sc1 lds
    v_mfma_f32_32x32x16_bf16 a[112:127], a[220:223], v[140:143], a[112:127]
    ds_read_b64_tr_b16 a[216:217], v22 offset:45760
    ds_read_b64_tr_b16 a[218:219], v22 offset:46800
    s_cbranch_vccnz L_stub21
L_back21:
    v_add_f32 v46, v46, v48
    buffer_load_dwordx4 v44, s[76:79], s51 offen offset:3072 sc1 lds
    s_add_u32 s51, s51, 4096
    v_mfma_f32_32x32x16_bf16 a[64:79], a[192:195], v[152:155], a[64:79]
    ds_read_b64_tr_b16 a[220:221], v23 offset:45760
    ds_read_b64_tr_b16 a[222:223], v23 offset:46800
    v_mov_b32 v63, v46
    v_mfma_f32_32x32x16_bf16 a[80:95], a[196:199], v[152:155], a[80:95]
    s_add_u32 m0, s50, 58112
    s_nop 0
    buffer_load_dwordx4 v44, s[76:79], s51 offen offset:0 sc1 lds
    v_mfma_f32_32x32x16_bf16 a[96:111], a[200:203], v[152:155], a[96:111]
    buffer_load_dwordx4 v44, s[76:79], s51 offen offset:1024 sc1 lds
    buffer_load_dword v27, v31, s[28:31], s41 offen offset:0 sc1
    s_waitcnt lgkmcnt(6)
    v_mfma_f32_32x32x16_bf16 a[112:127], a[204:207], v[152:155], a[112:127]
    s_nop 0
    v_permlane32_swap_b32 v46, v63
    v_add_f32 v46, v46, v63
    v_mfma_f32_32x32x16_bf16 a[64:79], a[208:211], v[156:159], a[64:79]
    v_rcp_f32 v46, v46
    s_waitcnt lgkmcnt(4)
    v_mfma_f32_32x32x16_bf16 a[80:95], a[212:215], v[156:159], a[80:95]
    s_waitcnt lgkmcnt(2)
    v_mfma_f32_32x32x16_bf16 a[96:111], a[216:219], v[156:159], a[96:111]
    s_waitcnt lgkmcnt(0)
    v_mfma_f32_32x32x16_bf16 a[112:127], a[220:223], v[156:159], a[112:127]
L_post:
    s_waitcnt vmcnt(0)
    v_cmp_ne_u32 vcc, 0, v27
    s_nop 0
    s_mov_b32 s37, vcc_lo
    s_bitcmp1_b32 s37, 0
    s_cbranch_scc0 L_hspin00
L_hok00:
    s_add_u32 s34, s52, 0
    s_and_b32 s34, s34, 0xffff
    buffer_load_dwordx4 v[224:227], v44, s[8:11], s34 offen offset:0 sc1
    buffer_load_dwordx4 v[228:231], v44, s[8:11], s34 offen offset:1024 sc1
    buffer_load_dwordx4 v[232:235], v44, s[8:11], s34 offen offset:2048 sc1
    buffer_load_dwordx4 v[236:239], v44, s[8:11], s34 offen offset:3072 sc1
    s_add_u32 s34, s52, 4096
    s_and_b32 s34, s34, 0xffff
    buffer_load_dwordx4 v[240:243], v44, s[8:11], s34 offen offset:0 sc1
    buffer_load_dwordx4 v[244:247], v44, s[8:11], s34 offen offset:1024 sc1
    buffer_load_dwordx4 v[248:251], v44, s[8:11], s34 offen offset:2048 sc1
    buffer_load_dwordx4 v[252:255], v44, s[8:11], s34 offen offset:3072 sc1
    s_bitcmp1_b32 s37, 1
    s_cbranch_scc0 L_hspin01
L_hok01:
    s_add_u32 s34, s52, 8192
    s_and_b32 s34, s34, 0xffff
    buffer_load_dwordx4 v[176:179], v44, s[8:11], s34 offen offset:0 sc1
    buffer_load_dwordx4 v[180:183], v44, s[8:11], s34 offen offset:1024 sc1
    buffer_load_dwordx4 v[184:187], v44, s[8:11], s34 offen offset:2048 sc1
    buffer_load_dwordx4 v[188:191], v44, s[8:11], s34 offen offset:3072 sc1
    s_add_u32 s34, s52, 12288
    s_and_b32 s34, s34, 0xffff
    buffer_load_dwordx4 v[136:139], v44, s[8:11], s34 offen offset:0 sc1
    buffer_load_dwordx4 v[140:143], v44, s[8:11], s34 offen offset:1024 sc1
    buffer_load_dwordx4 v[152:155], v44, s[8:11], s34 offen offset:2048 sc1
    buffer_load_dwordx4 v[156:159], v44, s[8:11], s34 offen offset:3072 sc1
    buffer_load_dwordx4 a[208:211], v24, s[76:79], s51 offen offset:2048 sc1
    buffer_load_dwordx4 a[212:215], v25, s[76:79], s51 offen offset:2048 sc1
    s_add_u32 s51, s51, 4096
    buffer_load_dwordx4 a[216:219], v24, s[76:79], s51 offen offset:0 sc1
    buffer_load_dwordx4 a[220:223], v25, s[76:79], s51 offen offset:0 sc1
    v_accvgpr_read_b32 v80, a64
    v_accvgpr_read_b32 v81, a65
    v_accvgpr_read_b32 v82, a66
    v_accvgpr_read_b32 v83, a67
    v_accvgpr_read_b32 v84, a68
    v_accvgpr_read_b32 v85, a69
    v_accvgpr_read_b32 v86, a70
    v_accvgpr_read_b32 v87, a71
    v_pk_mul_f32 v[80:81], v[80:81], v[46:47] op_sel_hi:[1,0]
    v_pk_mul_f32 v[82:83], v[82:83], v[46:47] op_sel_hi:[1,0]
    v_pk_mul_f32 v[84:85], v[84:85], v[46:47] op_sel_hi:[1,0]
    v_pk_mul_f32 v[86:87], v[86:87], v[46:47] op_sel_hi:[1,0]
    v_cvt_pk_bf16_f32 v88, v80, v81
    v_cvt_pk_bf16_f32 v89, v82, v83
    v_cvt_pk_bf16_f32 v90, v84, v85
    v_cvt_pk_bf16_f32 v91, v86, v87
    buffer_store_dwordx4 v[88:91], v44, s[24:27], s40 offen offset:0 sc1
    v_accvgpr_read_b32 v112, a72
    v_accvgpr_read_b32 v113, a73
    v_accvgpr_read_b32 v114, a74
    v_accvgpr_read_b32 v115, a75
    v_accvgpr_read_b32 v116, a76
    v_accvgpr_read_b32 v117, a77
    v_accvgpr_read_b32 v118, a78
    v_accvgpr_read_b32 v119, a79
    v_pk_mul_f32 v[112:113], v[112:113], v[46:47] op_sel_hi:[1,0]
    v_pk_mul_f32 v[114:115], v[114:115], v[46:47] op_sel_hi:[1,0]
    v_pk_mul_f32 v[116:117], v[116:117], v[46:47] op_sel_hi:[1,0]
    v_pk_mul_f32 v[118:119], v[118:119], v[46:47] op_sel_hi:[1,0]
    v_cvt_pk_bf16_f32 v120, v112, v113
    v_cvt_pk_bf16_f32 v121, v114, v115
    v_cvt_pk_bf16_f32 v122, v116, v117
    v_cvt_pk_bf16_f32 v123, v118, v119
    buffer_store_dwordx4 v[120:123], v44, s[24:27], s40 offen offset:1024 sc1
    v_accvgpr_read_b32 v80, a80
    v_accvgpr_read_b32 v81, a81
    v_accvgpr_read_b32 v82, a82
    v_accvgpr_read_b32 v83, a83
    v_accvgpr_read_b32 v84, a84
    v_accvgpr_read_b32 v85, a85
    v_accvgpr_read_b32 v86, a86
    v_accvgpr_read_b32 v87, a87
    v_pk_mul_f32 v[80:81], v[80:81], v[46:47] op_sel_hi:[1,0]
    v_pk_mul_f32 v[82:83], v[82:83], v[46:47] op_sel_hi:[1,0]
    v_pk_mul_f32 v[84:85], v[84:85], v[46:47] op_sel_hi:[1,0]
    v_pk_mul_f32 v[86:87], v[86:87], v[46:47] op_sel_hi:[1,0]
    v_cvt_pk_bf16_f32 v88, v80, v81
    v_cvt_pk_bf16_f32 v89, v82, v83
    v_cvt_pk_bf16_f32 v90, v84, v85
    v_cvt_pk_bf16_f32 v91, v86, v87
    buffer_store_dwordx4 v[88:91], v44, s[24:27], s40 offen offset:2048 sc1
    v_accvgpr_read_b32 v112, a88
    v_accvgpr_read_b32 v113, a89
    v_accvgpr_read_b32 v114, a90
    v_accvgpr_read_b32 v115, a91
    v_accvgpr_read_b32 v116, a92
    v_accvgpr_read_b32 v117, a93
    v_accvgpr_read_b32 v118, a94
    v_accvgpr_read_b32 v119, a95
    v_pk_mul_f32 v[112:113], v[112:113], v[46:47] op_sel_hi:[1,0]
    v_pk_mul_f32 v[114:115], v[114:115], v[46:47] op_sel_hi:[1,0]
    v_pk_mul_f32 v[116:117], v[116:117], v[46:47] op_sel_hi:[1,0]
    v_pk_mul_f32 v[118:119], v[118:119], v[46:47] op_sel_hi:[1,0]
    v_cvt_pk_bf16_f32 v120, v112, v113
    v_cvt_pk_bf16_f32 v121, v114, v115
    v_cvt_pk_bf16_f32 v122, v116, v117
    v_cvt_pk_bf16_f32 v123, v118, v119
    buffer_store_dwordx4 v[120:123], v44, s[24:27], s40 offen offset:3072 sc1
    v_accvgpr_read_b32 v80, a96
    v_accvgpr_read_b32 v81, a97
    v_accvgpr_read_b32 v82, a98
    v_accvgpr_read_b32 v83, a99
    v_accvgpr_read_b32 v84, a100
    v_accvgpr_read_b32 v85, a101
    v_accvgpr_read_b32 v86, a102
    v_accvgpr_read_b32 v87, a103
    v_pk_mul_f32 v[80:81], v[80:81], v[46:47] op_sel_hi:[1,0]
    v_pk_mul_f32 v[82:83], v[82:83], v[46:47] op_sel_hi:[1,0]
    v_pk_mul_f32 v[84:85], v[84:85], v[46:47] op_sel_hi:[1,0]
    v_pk_mul_f32 v[86:87], v[86:87], v[46:47] op_sel_hi:[1,0]
    v_cvt_pk_bf16_f32 v88, v80, v81
    v_cvt_pk_bf16_f32 v89, v82, v83
    v_cvt_pk_bf16_f32 v90, v84, v85
    v_cvt_pk_bf16_f32 v91, v86, v87
    buffer_store_dwordx4 v[88:91], v44, s[24:27], s45 offen offset:0 sc1
    v_accvgpr_read_b32 v112, a104
    v_accvgpr_read_b32 v113, a105
    v_accvgpr_read_b32 v114, a106
    v_accvgpr_read_b32 v115, a107
    v_accvgpr_read_b32 v116, a108
    v_accvgpr_read_b32 v117, a109
    v_accvgpr_read_b32 v118, a110
    v_accvgpr_read_b32 v119, a111
    v_pk_mul_f32 v[112:113], v[112:113], v[46:47] op_sel_hi:[1,0]
    v_pk_mul_f32 v[114:115], v[114:115], v[46:47] op_sel_hi:[1,0]
    v_pk_mul_f32 v[116:117], v[116:117], v[46:47] op_sel_hi:[1,0]
    v_pk_mul_f32 v[118:119], v[118:119], v[46:47] op_sel_hi:[1,0]
    v_cvt_pk_bf16_f32 v120, v112, v113
    v_cvt_pk_bf16_f32 v121, v114, v115
    v_cvt_pk_bf16_f32 v122, v116, v117
    v_cvt_pk_bf16_f32 v123, v118, v119
    buffer_store_dwordx4 v[120:123], v44, s[24:27], s45 offen offset:1024 sc1
    v_accvgpr_read_b32 v80, a112
    v_accvgpr_read_b32 v81, a113
    v_accvgpr_read_b32 v82, a114
    v_accvgpr_read_b32 v83, a115
    v_accvgpr_read_b32 v84, a116
    v_accvgpr_read_b32 v85, a117
    v_accvgpr_read_b32 v86, a118
    v_accvgpr_read_b32 v87, a119
    v_pk_mul_f32 v[80:81], v[80:81], v[46:47] op_sel_hi:[1,0]
    v_pk_mul_f32 v[82:83], v[82:83], v[46:47] op_sel_hi:[1,0]
    v_pk_mul_f32 v[84:85], v[84:85], v[46:47] op_sel_hi:[1,0]
    v_pk_mul_f32 v[86:87], v[86:87], v[46:47] op_sel_hi:[1,0]
    v_cvt_pk_bf16_f32 v88, v80, v81
    v_cvt_pk_bf16_f32 v89, v82, v83
    v_cvt_pk_bf16_f32 v90, v84, v85
    v_cvt_pk_bf16_f32 v91, v86, v87
    buffer_store_dwordx4 v[88:91], v44, s[24:27], s45 offen offset:2048 sc1
    v_accvgpr_read_b32 v112, a120
    v_accvgpr_read_b32 v113, a121
    v_accvgpr_read_b32 v114, a122
    v_accvgpr_read_b32 v115, a123
    v_accvgpr_read_b32 v116, a124
    v_accvgpr_read_b32 v117, a125
    v_accvgpr_read_b32 v118, a126
    v_accvgpr_read_b32 v119, a127
    v_pk_mul_f32 v[112:113], v[112:113], v[46:47] op_sel_hi:[1,0]
    v_pk_mul_f32 v[114:115], v[114:115], v[46:47] op_sel_hi:[1,0]
    v_pk_mul_f32 v[116:117], v[116:117], v[46:47] op_sel_hi:[1,0]
    v_pk_mul_f32 v[118:119], v[118:119], v[46:47] op_sel_hi:[1,0]
    v_cvt_pk_bf16_f32 v120, v112, v113
    v_cvt_pk_bf16_f32 v121, v114, v115
    v_cvt_pk_bf16_f32 v122, v116, v117
    v_cvt_pk_bf16_f32 v123, v118, v119
    buffer_store_dwordx4 v[120:123], v44, s[24:27], s45 offen offset:3072 sc1
    v_add_u32 v8, s50, v24
    v_add_u32 v9, s50, v25
    v_add_u32 v10, 65536, v8
    v_add_u32 v11, 65536, v9
    v_add_u32 v12, 131072, v8
    v_add_u32 v13, 131072, v9
    v_and_b32 v5, 63, v33
    v_bfe_u32 v29, v5, 1, 3
    v_lshrrev_b32 v28, 5, v2
    v_xor_b32 v29, v29, v28
    s_and_b32 s16, s32, 1
    s_lshl_b32 s16, s16, 2
    v_xor_b32 v29, s16, v29
    v_lshlrev_b32 v29, 4, v29
    v_lshl_add_u32 v28, v5, 7, v29
    v_add_u32 v28, 141056, v28
    v_xor_b32 v29, 32, v28
    ds_read_b128 v[16:19], v28 offset:0
    ds_read_b128 v[20:23], v29 offset:0
    s_waitcnt vmcnt(27)
    v_mfma_f32_32x32x16_bf16 v[64:79], a[152:155], v[224:227], 0
    buffer_load_dwordx4 a[64:67], v24, s[76:79], s51 offen offset:2048 sc1
    buffer_load_dwordx4 a[68:71], v25, s[76:79], s51 offen offset:2048 sc1
    s_add_u32 s51, s51, 4096
    s_and_b32 s51, s51, 0x1ffff
    buffer_load_dword v27, v31, s[28:31], s41 offen offset:0 sc1
    v_mfma_f32_32x32x16_bf16 v[96:111], a[156:159], v[224:227], 0
    s_bitcmp1_b32 s37, 2
    s_cbranch_scc0 L_hspin02
L_hok02:
    s_add_u32 s34, s52, 16384
    s_and_b32 s34, s34, 0xffff
    buffer_load_dwordx4 v[224:227], v44, s[8:11], s34 offen offset:0 sc1
    s_waitcnt vmcnt(30)
    v_mfma_f32_32x32x16_bf16 v[64:79], a[160:163], v[228:231], v[64:79]
    v_lshlrev_b32 v112, 16, v51
    v_and_b32 v113, s47, v51
    v_accvgpr_read_b32 v116, a128
    v_accvgpr_read_b32 v117, a132
    v_lshlrev_b32 v114, 16, v116
    v_and_b32 v115, s47, v116
    v_mul_f32 v80, v114, v112
    v_mfma_f32_32x32x16_bf16 v[96:111], a[164:167], v[228:231], v[96:111]
    buffer_load_dwordx4 v[228:231], v44, s[8:11], s34 offen offset:1024 sc1
    v_mul_f32 v81, v115, v112
    v_lshlrev_b32 v114, 16, v117
    v_and_b32 v115, s47, v117
    v_fmac_f32 v80, v114, v113
    v_fmac_f32 v81, v115, v113
    s_waitcnt vmcnt(30)
    v_mfma_f32_32x32x16_bf16 v[64:79], a[168:171], v[232:235], v[64:79]
    buffer_load_dwordx4 a[72:75], v24, s[76:79], s51 offen offset:0 sc1
    buffer_load_dwordx4 a[76:79], v25, s[76:79], s51 offen offset:0 sc1
    v_accvgpr_read_b32 v116, a129
    v_accvgpr_read_b32 v117, a133
    v_mfma_f32_32x32x16_bf16 v[96:111], a[172:175], v[232:235], v[96:111]
    buffer_load_dwordx4 v[232:235], v44, s[8:11], s34 offen offset:2048 sc1
    v_lshlrev_b32 v114, 16, v116
    v_and_b32 v115, s47, v116
    v_mul_f32 v82, v114, v112
    v_mul_f32 v83, v115, v112
    v_lshlrev_b32 v114, 16, v117
    s_waitcnt vmcnt(32)
    v_mfma_f32_32x32x16_bf16 v[64:79], a[176:179], v[236:239], v[64:79]
    v_and_b32 v115, s47, v117
    v_fmac_f32 v82, v114, v113
    v_fmac_f32 v83, v115, v113
    v_accvgpr_read_b32 v116, a130
    v_accvgpr_read_b32 v117, a134
    v_lshlrev_b32 v114, 16, v116
    v_and_b32 v115, s47, v116
    v_mul_f32 v84, v114, v112
    v_mfma_f32_32x32x16_bf16 v[96:111], a[180:183], v[236:239], v[96:111]
    buffer_load_dwordx4 v[236:239], v44, s[8:11], s34 offen offset:3072 sc1
    v_mul_f32 v85, v115, v112
    v_lshlrev_b32 v114, 16, v117
    v_and_b32 v115, s47, v117
    v_fmac_f32 v84, v114, v113
    v_fmac_f32 v85, v115, v113
    s_waitcnt vmcnt(32)
    v_mfma_f32_32x32x16_bf16 v[64:79], a[184:187], v[240:243], v[64:79]
    buffer_load_dwordx4 a[80:83], v24, s[76:79], s51 offen offset:2048 sc1
    buffer_load_dwordx4 a[84:87], v25, s[76:79], s51 offen offset:2048 sc1
    s_add_u32 s51, s51, 4096
    v_accvgpr_read_b32 v116, a131
    v_mfma_f32_32x32x16_bf16 v[96:111], a[188:191], v[240:243], v[96:111]
    s_add_u32 s34, s52, 20480
    s_and_b32 s34, s34, 0xffff
    buffer_load_dwordx4 v[240:243], v44, s[8:11], s34 offen offset:0 sc1
    v_accvgpr_read_b32 v117, a135
    v_lshlrev_b32 v114, 16, v116
    v_and_b32 v115, s47, v116
    s_waitcnt vmcnt(34)
    v_mfma_f32_32x32x16_bf16 v[64:79], a[224:227], v[244:247], v[64:79]
    v_mul_f32 v86, v114, v112
    v_mul_f32 v87, v115, v112
    v_lshlrev_b32 v114, 16, v117
    v_and_b32 v115, s47, v117
    v_fmac_f32 v86, v114, v113
    v_fmac_f32 v87, v115, v113
    v_accvgpr_read_b32 v116, a136
    v_accvgpr_read_b32 v117, a140
    v_mfma_f32_32x32x16_bf16 v[96:111], a[228:231], v[244:247], v[96:111]
    buffer_load_dwordx4 v[244:247], v44, s[8:11], s34 offen offset:1024 sc1
    v_lshlrev_b32 v114, 16, v116
    v_and_b32 v115, s47, v116
    v_mul_f32 v88, v114, v112
    v_mul_f32 v89, v115, v112
    v_lshlrev_b32 v114, 16, v117
    s_waitcnt vmcnt(34)
    v_mfma_f32_32x32x16_bf16 v[64:79], a[232:235], v[248:251], v[64:79]
    buffer_load_dwordx4 a[88:91], v24, s[76:79], s51 offen offset:0 sc1
    buffer_load_dwordx4 a[92:95], v25, s[76:79], s51 offen offset:0 sc1
    v_and_b32 v115, s47, v117
    v_fmac_f32 v88, v114, v113
    v_mfma_f32_32x32x16_bf16 v[96:111], a[236:239], v[248:251], v[96:111]
    buffer_load_dwordx4 v[248:251], v44, s[8:11], s34 offen offset:2048 sc1
    v_fmac_f32 v89, v115, v113
    v_accvgpr_read_b32 v116, a137
    v_accvgpr_read_b32 v117, a141
    v_lshlrev_b32 v114, 16, v116
    v_and_b32 v115, s47, v116
    s_waitcnt vmcnt(36)
    v_mfma_f32_32x32x16_bf16 v[64:79], a[240:243], v[252:255], v[64:79]
    ds_read_b128 a[192:195], v10 offset:50944
    ds_read_b128 a[196:199], v11 offset:50944
    v_mul_f32 v90, v114, v112
    v_mul_f32 v91, v115, v112
    v_lshlrev_b32 v114, 16, v117
    v_and_b32 v115, s47, v117
    v_fmac_f32 v90, v114, v113
    v_mfma_f32_32x32x16_bf16 v[96:111], a[244:247], v[252:255], v[96:111]
    buffer_load_dwordx4 v[252:255], v44, s[8:11], s34 offen offset:3072 sc1
    s_waitcnt vmcnt(14)
    v_cmp_ne_u32 vcc, 0, v27
    s_nop 0
    s_mov_b32 s37, vcc_lo
    v_fmac_f32 v91, v115, v113
    v_accvgpr_read_b32 v116, a138
    v_accvgpr_read_b32 v117, a142
    v_mfma_f32_32x32x16_bf16 v[64:79], a[248:251], v[176:179], v[64:79]
    ds_read_b128 a[200:203], v10 offset:59136
    ds_read_b128 a[204:207], v11 offset:59136
    buffer_load_dwordx4 a[96:99], v24, s[76:79], s51 offen offset:2048 sc1
    buffer_load_dwordx4 a[100:103], v25, s[76:79], s51 offen offset:2048 sc1
    s_add_u32 s51, s51, 4096
    v_mfma_f32_32x32x16_bf16 v[96:111], a[252:255], v[176:179], v[96:111]
    s_bitcmp1_b32 s37, 3
    s_cbranch_scc0 L_hspin03
L_hok03:
    s_add_u32 s34, s52, 24576
    s_and_b32 s34, s34, 0xffff
    buffer_load_dwordx4 v[176:179], v44, s[8:11], s34 offen offset:0 sc1
    s_waitcnt lgkmcnt(2)
    v_mfma_f32_32x32x16_bf16 v[64:79], a[192:195], v[180:183], v[64:79]
    v_lshlrev_b32 v114, 16, v116
    v_and_b32 v115, s47, v116
    v_mul_f32 v92, v114, v112
    v_mul_f32 v93, v115, v112
    v_lshlrev_b32 v114, 16, v117
    v_and_b32 v115, s47, v117
    v_fmac_f32 v92, v114, v113
    v_fmac_f32 v93, v115, v113
    v_mfma_f32_32x32x16_bf16 v[96:111], a[196:199], v[180:183], v[96:111]
    buffer_load_dwordx4 v[180:183], v44, s[8:11], s34 offen offset:1024 sc1
    v_accvgpr_read_b32 v116, a139
    v_accvgpr_read_b32 v117, a143
    v_lshlrev_b32 v114, 16, v116
    v_and_b32 v115, s47, v116
    v_mul_f32 v94, v114, v112
    s_waitcnt lgkmcnt(0)
    v_mfma_f32_32x32x16_bf16 v[64:79], a[200:203], v[184:187], v[64:79]
    ds_read_b128 a[192:195], v12 offset:1792
    ds_read_b128 a[196:199], v13 offset:1792
    buffer_load_dwordx4 a[104:107], v24, s[76:79], s51 offen offset:0 sc1
    buffer_load_dwordx4 a[108:111], v25, s[76:79], s51 offen offset:0 sc1
    s_barrier
    buffer_store_dword v35, v26, s[28:31], s48 offen offset:128 sc1
    v_mfma_f32_32x32x16_bf16 v[96:111], a[204:207], v[184:187], v[96:111]
    buffer_load_dwordx4 v[184:187], v44, s[8:11], s34 offen offset:2048 sc1
    v_mul_f32 v95, v115, v112
    v_lshlrev_b32 v114, 16, v117
    v_and_b32 v115, s47, v117
    v_fmac_f32 v94, v114, v113
    v_fmac_f32 v95, v115, v113
    s_waitcnt lgkmcnt(1)
    v_mfma_f32_32x32x16_bf16 v[64:79], a[192:195], v[188:191], v[64:79]
    v_add_f32_dpp v80, v80, v80 quad_perm:[1,0,3,2] row_mask:0xf bank_mask:0xf
    v_add_f32_dpp v81, v81, v81 quad_perm:[1,0,3,2] row_mask:0xf bank_mask:0xf
    v_add_f32_dpp v82, v82, v82 quad_perm:[1,0,3,2] row_mask:0xf bank_mask:0xf
    v_add_f32_dpp v83, v83, v83 quad_perm:[1,0,3,2] row_mask:0xf bank_mask:0xf
    v_add_f32_dpp v84, v84, v84 quad_perm:[1,0,3,2] row_mask:0xf bank_mask:0xf
    v_add_f32_dpp v85, v85, v85 quad_perm:[1,0,3,2] row_mask:0xf bank_mask:0xf
    v_add_f32_dpp v86, v86, v86 quad_perm:[1,0,3,2] row_mask:0xf bank_mask:0xf
    v_add_f32_dpp v87, v87, v87 quad_perm:[1,0,3,2] row_mask:0xf bank_mask:0xf
    s_waitcnt lgkmcnt(0)
    v_mfma_f32_32x32x16_bf16 v[96:111], a[196:199], v[188:191], v[96:111]
    buffer_load_dwordx4 v[188:191], v44, s[8:11], s34 offen offset:3072 sc1
    v_add_f32_dpp v88, v88, v88 quad_perm:[1,0,3,2] row_mask:0xf bank_mask:0xf
    v_add_f32_dpp v89, v89, v89 quad_perm:[1,0,3,2] row_mask:0xf bank_mask:0xf
    v_add_f32_dpp v90, v90, v90 quad_perm:[1,0,3,2] row_mask:0xf bank_mask:0xf
    v_add_f32_dpp v91, v91, v91 quad_perm:[1,0,3,2] row_mask:0xf bank_mask:0xf
    v_add_f32_dpp v92, v92, v92 quad_perm:[1,0,3,2] row_mask:0xf bank_mask:0xf
    v_mfma_f32_32x32x16_bf16 v[64:79], v[36:39], v[136:139], v[64:79]
    buffer_load_dwordx4 a[112:115], v24, s[76:79], s51 offen offset:2048 sc1
    buffer_load_dwordx4 a[116:119], v25, s[76:79], s51 offen offset:2048 sc1
    s_add_u32 s51, s51, 4096
    v_add_f32_dpp v93, v93, v93 quad_perm:[1,0,3,2] row_mask:0xf bank_mask:0xf
    v_mfma_f32_32x32x16_bf16 v[96:111], v[40:43], v[136:139], v[96:111]
    s_add_u32 s34, s52, 28672
    s_and_b32 s34, s34, 0xffff
    buffer_load_dwordx4 v[136:139], v44, s[8:11], s34 offen offset:0 sc1
    v_add_f32_dpp v94, v94, v94 quad_perm:[1,0,3,2] row_mask:0xf bank_mask:0xf
    v_add_f32_dpp v95, v95, v95 quad_perm:[1,0,3,2] row_mask:0xf bank_mask:0xf
    v_add_f32_dpp v80, v80, v80 quad_perm:[2,3,0,1] row_mask:0xf bank_mask:0xf
    v_mfma_f32_32x32x16_bf16 v[64:79], v[192:195], v[140:143], v[64:79]
    v_add_f32_dpp v81, v81, v81 quad_perm:[2,3,0,1] row_mask:0xf bank_mask:0xf
    v_add_f32_dpp v82, v82, v82 quad_perm:[2,3,0,1] row_mask:0xf bank_mask:0xf
    v_add_f32_dpp v83, v83, v83 quad_perm:[2,3,0,1] row_mask:0xf bank_mask:0xf
    v_add_f32_dpp v84, v84, v84 quad_perm:[2,3,0,1] row_mask:0xf bank_mask:0xf
    v_add_f32_dpp v85, v85, v85 quad_perm:[2,3,0,1] row_mask:0xf bank_mask:0xf
    v_add_f32_dpp v86, v86, v86 quad_perm:[2,3,0,1] row_mask:0xf bank_mask:0xf
    v_add_f32_dpp v87, v87, v87 quad_perm:[2,3,0,1] row_mask:0xf bank_mask:0xf
    v_add_f32_dpp v88, v88, v88 quad_perm:[2,3,0,1] row_mask:0xf bank_mask:0xf
    v_mfma_f32_32x32x16_bf16 v[96:111], v[196:199], v[140:143], v[96:111]
    buffer_load_dwordx4 v[140:143], v44, s[8:11], s34 offen offset:1024 sc1
    v_add_f32_dpp v89, v89, v89 quad_perm:[2,3,0,1] row_mask:0xf bank_mask:0xf
    v_add_f32_dpp v90, v90, v90 quad_perm:[2,3,0,1] row_mask:0xf bank_mask:0xf
    v_add_f32_dpp v91, v91, v91 quad_perm:[2,3,0,1] row_mask:0xf bank_mask:0xf
    v_add_f32_dpp v92, v92, v92 quad_perm:[2,3,0,1] row_mask:0xf bank_mask:0xf
    v_add_f32_dpp v93, v93, v93 quad_perm:[2,3,0,1] row_mask:0xf bank_mask:0xf
    v_mfma_f32_32x32x16_bf16 v[64:79], v[200:203], v[152:155], v[64:79]
    buffer_load_dwordx4 a[120:123], v24, s[76:79], s51 offen offset:0 sc1
    buffer_load_dwordx4 a[124:127], v25, s[76:79], s51 offen offset:0 sc1
    v_add_f32_dpp v94, v94, v94 quad_perm:[2,3,0,1] row_mask:0xf bank_mask:0xf
    v_add_f32_dpp v95, v95, v95 quad_perm:[2,3,0,1] row_mask:0xf bank_mask:0xf
    v_mfma_f32_32x32x16_bf16 v[96:111], v[204:207], v[152:155], v[96:111]
    buffer_load_dwordx4 v[152:155], v44, s[8:11], s34 offen offset:2048 sc1
    v_add_f32_dpp v80, v80, v80 row_half_mirror row_mask:0xf bank_mask:0xf
    v_add_f32_dpp v81, v81, v81 row_half_mirror row_mask:0xf bank_mask:0xf
    v_add_f32_dpp v82, v82, v82 row_half_mirror row_mask:0xf bank_mask:0xf
    v_add_f32_dpp v83, v83, v83 row_half_mirror row_mask:0xf bank_mask:0xf
    v_add_f32_dpp v84, v84, v84 row_half_mirror row_mask:0xf bank_mask:0xf
    v_mfma_f32_32x32x16_bf16 v[64:79], v[208:211], v[156:159], v[64:79]
    v_add_f32_dpp v85, v85, v85 row_half_mirror row_mask:0xf bank_mask:0xf
    v_add_f32_dpp v86, v86, v86 row_half_mirror row_mask:0xf bank_mask:0xf
    v_add_f32_dpp v87, v87, v87 row_half_mirror row_mask:0xf bank_mask:0xf
    v_add_f32_dpp v88, v88, v88 row_half_mirror row_mask:0xf bank_mask:0xf
    v_add_f32_dpp v89, v89, v89 row_half_mirror row_mask:0xf bank_mask:0xf
    v_add_f32_dpp v90, v90, v90 row_half_mirror row_mask:0xf bank_mask:0xf
    v_add_f32_dpp v91, v91, v91 row_half_mirror row_mask:0xf bank_mask:0xf
    v_add_f32_dpp v92, v92, v92 row_half_mirror row_mask:0xf bank_mask:0xf
    v_mfma_f32_32x32x16_bf16 v[96:111], v[212:215], v[156:159], v[96:111]
    buffer_load_dwordx4 v[156:159], v44, s[8:11], s34 offen offset:3072 sc1
    v_add_f32_dpp v93, v93, v93 row_half_mirror row_mask:0xf bank_mask:0xf
    v_add_f32_dpp v94, v94, v94 row_half_mirror row_mask:0xf bank_mask:0xf
    v_add_f32_dpp v95, v95, v95 row_half_mirror row_mask:0xf bank_mask:0xf
    v_add_f32_dpp v80, v80, v80 row_mirror row_mask:0xf bank_mask:0xf
    v_add_f32_dpp v81, v81, v81 row_mirror row_mask:0xf bank_mask:0xf
    s_waitcnt vmcnt(30)
    v_mfma_f32_32x32x16_bf16 v[64:79], v[216:219], v[224:227], v[64:79]
    s_add_u32 m0, s50, 31232
    s_nop 0
    buffer_load_dwordx4 v44, s[76:79], s51 offen offset:2048 sc1 lds
    buffer_load_dwordx4 v44, s[76:79], s51 offen offset:3072 sc1 lds
    s_add_u32 s51, s51, 4096
    s_and_b32 s51, s51, 0x1ffff
    v_mfma_f32_32x32x16_bf16 v[96:111], v[220:223], v[224:227], v[96:111]
    s_bitcmp1_b32 s37, 4
    s_cbranch_scc0 L_hspin04
L_hok04:
    s_add_u32 s34, s52, 32768
    s_and_b32 s34, s34, 0xffff
    buffer_load_dwordx4 v[224:227], v44, s[8:11], s34 offen offset:0 sc1
    s_waitcnt vmcnt(32)
    v_mfma_f32_32x32x16_bf16 v[64:79], v[160:163], v[228:231], v[64:79]
    v_add_f32_dpp v82, v82, v82 row_mirror row_mask:0xf bank_mask:0xf
    v_add_f32_dpp v83, v83, v83 row_mirror row_mask:0xf bank_mask:0xf
    v_add_f32_dpp v84, v84, v84 row_mirror row_mask:0xf bank_mask:0xf
    v_add_f32_dpp v85, v85, v85 row_mirror row_mask:0xf bank_mask:0xf
    v_add_f32_dpp v86, v86, v86 row_mirror row_mask:0xf bank_mask:0xf
    v_add_f32_dpp v87, v87, v87 row_mirror row_mask:0xf bank_mask:0xf
    v_add_f32_dpp v88, v88, v88 row_mirror row_mask:0xf bank_mask:0xf
    v_add_f32_dpp v89, v89, v89 row_mirror row_mask:0xf bank_mask:0xf
    v_mfma_f32_32x32x16_bf16 v[96:111], v[164:167], v[228:231], v[96:111]
    buffer_load_dwordx4 v[228:231], v44, s[8:11], s34 offen offset:1024 sc1
    v_add_f32_dpp v90, v90, v90 row_mirror row_mask:0xf bank_mask:0xf
    v_add_f32_dpp v91, v91, v91 row_mirror row_mask:0xf bank_mask:0xf
    v_add_f32_dpp v92, v92, v92 row_mirror row_mask:0xf bank_mask:0xf
    v_add_f32_dpp v93, v93, v93 row_mirror row_mask:0xf bank_mask:0xf
    v_add_f32_dpp v94, v94, v94 row_mirror row_mask:0xf bank_mask:0xf
    s_waitcnt vmcnt(30)
    v_mfma_f32_32x32x16_bf16 v[64:79], v[168:171], v[232:235], v[64:79]
    s_add_u32 m0, s50, 41472
    s_nop 0
    buffer_load_dwordx4 v44, s[76:79], s51 offen offset:0 sc1 lds
    buffer_load_dwordx4 v44, s[76:79], s51 offen offset:1024 sc1 lds
    v_add_f32_dpp v95, v95, v95 row_mirror row_mask:0xf bank_mask:0xf
    v_mfma_f32_32x32x16_bf16 v[96:111], v[172:175], v[232:235], v[96:111]
    buffer_load_dwordx4 v[232:235], v44, s[8:11], s34 offen offset:2048 sc1
    v_lshrrev_b32 v4, 4, v0
    v_lshlrev_b32 v4, 6, v4
    v_add_u32 v4, 157696, v4
    ds_write_b128 v4, v[80:83] offset:1024
    ds_write_b128 v4, v[84:87] offset:1040
    s_waitcnt vmcnt(32)
    v_mfma_f32_32x32x16_bf16 v[64:79], v[128:131], v[236:239], v[64:79]
    ds_write_b128 v4, v[88:91] offset:1056
    ds_write_b128 v4, v[92:95] offset:1072
    v_mov_b32 v62, 1073741824
    s_lshr_b32 s16, s4, 6
    v_lshlrev_b32 v63, 15, v0
    v_cmp_gt_u32 vcc, 8, v0
    s_nop 1
    v_cndmask_b32 v34, v62, v63, vcc
    v_mfma_f32_32x32x16_bf16 v[96:111], v[132:135], v[236:239], v[96:111]
    buffer_load_dwordx4 v[236:239], v44, s[8:11], s34 offen offset:3072 sc1
    s_and_b32 s17, s16, 3
    s_lshl_b32 s17, s17, 3
    s_lshr_b32 s16, s16, 2
    s_add_u32 s16, s16, s17
    s_lshl_b32 s16, s16, 10
    s_waitcnt vmcnt(30)
    v_mfma_f32_32x32x16_bf16 v[64:79], v[144:147], v[240:243], v[64:79]
    s_add_u32 m0, s50, 81152
    s_nop 0
    buffer_load_dwordx4 v44, s[76:79], s51 offen offset:2048 sc1 lds
    buffer_load_dwordx4 v44, s[76:79], s51 offen offset:3072 sc1 lds
    s_add_u32 s51, s51, 4096
    v_mfma_f32_32x32x16_bf16 v[96:111], v[148:151], v[240:243], v[96:111]
    s_add_u32 s34, s52, 36864
    s_and_b32 s34, s34, 0xffff
    buffer_load_dwordx4 v[240:243], v44, s[8:11], s34 offen offset:0 sc1
    s_add_u32 s16, s16, 20340992
    s_lshl_b32 s17, s5, 2
    s_add_u32 s16, s16, s17
    s_waitcnt vmcnt(32)
    v_mfma_f32_32x32x16_bf16 v[64:79], a[0:3], v[244:247], v[64:79]
    s_cmp_lt_u32 s5, 172
    s_cselect_b32 s38, s16, 1073741824
    v_mfma_f32_32x32x16_bf16 v[96:111], a[4:7], v[244:247], v[96:111]
    buffer_load_dwordx4 v[244:247], v44, s[8:11], s34 offen offset:1024 sc1
    s_waitcnt vmcnt(30)
    v_mfma_f32_32x32x16_bf16 v[64:79], a[8:11], v[248:251], v[64:79]
    s_add_u32 m0, s50, 91392
    s_nop 0
    buffer_load_dwordx4 v44, s[76:79], s51 offen offset:0 sc1 lds
    buffer_load_dwordx4 v44, s[76:79], s51 offen offset:1024 sc1 lds
    s_waitcnt lgkmcnt(0)
    s_barrier
    v_mfma_f32_32x32x16_bf16 v[96:111], a[12:15], v[248:251], v[96:111]
    buffer_load_dwordx4 v[248:251], v44, s[8:11], s34 offen offset:2048 sc1
    v_lshlrev_b32 v4, 2, v2
    v_add_u32 v4, 157696, v4
    ds_read_b32 v80, v4 offset:1024
    ds_read_b32 v81, v4 offset:1280
    ds_read_b32 v82, v4 offset:1536
    s_waitcnt vmcnt(32)
    v_mfma_f32_32x32x16_bf16 v[64:79], a[16:19], v[252:255], v[64:79]
    ds_read_b32 v83, v4 offset:1792
    s_waitcnt lgkmcnt(2)
    v_add_f32 v80, v80, v81
    s_waitcnt lgkmcnt(0)
    v_add_f32 v82, v82, v83
    v_add_f32 v80, v80, v82
    v_mov_b32 v81, v80
    s_nop 1
    v_permlane32_swap_b32 v80, v81
    v_add_f32 v80, v80, v81
    v_mov_b32 v81, v80
    v_mfma_f32_32x32x16_bf16 v[96:111], a[20:23], v[252:255], v[96:111]
    buffer_load_dwordx4 v[252:255], v44, s[8:11], s34 offen offset:3072 sc1
    v_permlane16_swap_b32 v80, v81
    v_add_f32 v80, v80, v81
    v_cvt_pk_bf16_f32 v80, v80, v80
    v_lshlrev_b32 v80, 16, v80
    v_mul_f32 v112, 0xbfb8aa3b, v80
    s_waitcnt vmcnt(30)
    v_mfma_f32_32x32x16_bf16 v[64:79], a[24:27], v[176:179], v[64:79]
    s_add_u32 m0, s50, 97792
    s_nop 0
    buffer_load_dwordx4 v44, s[76:79], s51 offen offset:2048 sc1 lds
    buffer_load_dwordx4 v44, s[76:79], s51 offen offset:3072 sc1 lds
    s_add_u32 s51, s51, 4096
    v_mfma_f32_32x32x16_bf16 v[96:111], a[28:31], v[176:179], v[96:111]
    s_bitcmp1_b32 s37, 5
    s_cbranch_scc0 L_hspin05
L_hok05:
    s_add_u32 s34, s52, 40960
    s_and_b32 s34, s34, 0xffff
    buffer_load_dwordx4 v[176:179], v44, s[8:11], s34 offen offset:0 sc1
    s_waitcnt vmcnt(32)
    v_mfma_f32_32x32x16_bf16 v[64:79], a[32:35], v[180:183], v[64:79]
    v_exp_f32 v112, v112
    s_nop 0
    v_add_f32 v112, 1.0, v112
    v_rcp_f32 v112, v112
    s_nop 0
    v_mul_f32 v112, v112, v80
    v_cvt_pk_bf16_f32 v112, v112, v112
    v_lshlrev_b32 v112, 16, v112
    v_mfma_f32_32x32x16_bf16 v[96:111], a[36:39], v[180:183], v[96:111]
    buffer_load_dwordx4 v[180:183], v44, s[8:11], s34 offen offset:1024 sc1
    v_mov_b32_dpp v113, v80 row_ror:8 row_mask:0xf bank_mask:0xf
    v_mul_f32 v112, v112, v113
    v_cvt_pk_bf16_f32 v112, v112, v112
    v_lshlrev_b32 v112, 16, v112
    s_nop 0
    v_readlane_b32 s12, v112, 0
    s_waitcnt vmcnt(29)
    v_mfma_f32_32x32x16_bf16 v[64:79], a[40:43], v[184:187], v[64:79]
    s_add_u32 m0, s50, 108032
    s_nop 0
    buffer_load_dwordx4 v44, s[76:79], s51 offen offset:0 sc1 lds
    buffer_load_dwordx4 v44, s[76:79], s51 offen offset:1024 sc1 lds
    v_readlane_b32 s13, v112, 1
    v_mfma_f32_32x32x16_bf16 v[96:111], a[44:47], v[184:187], v[96:111]
    buffer_load_dwordx4 v[184:187], v44, s[8:11], s34 offen offset:2048 sc1
    v_readlane_b32 s14, v112, 2
    v_readlane_b32 s15, v112, 3
    v_readlane_b32 s16, v112, 4
    v_readlane_b32 s17, v112, 5
    v_readlane_b32 s18, v112, 6
    s_waitcnt vmcnt(31)
    v_mfma_f32_32x32x16_bf16 v[64:79], a[48:51], v[188:191], v[64:79]
    ds_read_b128 a[200:203], v10 offset:1024
    ds_read_b128 a[204:207], v11 offset:1024
    v_readlane_b32 s19, v112, 7
    v_mov_b32 v84, 0
    v_mov_b32 v85, 0
    v_accvgpr_read_b32 v115, a144
    v_lshlrev_b32 v114, 16, v115
    v_mfma_f32_32x32x16_bf16 v[96:111], a[52:55], v[188:191], v[96:111]
    buffer_load_dwordx4 v[188:191], v44, s[8:11], s34 offen offset:3072 sc1
    v_and_b32 v115, s47, v115
    v_fmac_f32 v84, s12, v114
    v_fmac_f32 v85, s12, v115
    v_accvgpr_read_b32 v115, a145
    v_lshlrev_b32 v114, 16, v115
    s_waitcnt vmcnt(29)
    v_mfma_f32_32x32x16_bf16 v[64:79], a[56:59], v[136:139], v[64:79]
    ds_read_b128 a[192:195], v10 offset:9216
    ds_read_b128 a[196:199], v11 offset:9216
    buffer_load_dword v27, v31, s[28:31], s41 offen offset:128 sc1
    v_and_b32 v115, s47, v115
    v_fmac_f32 v84, s13, v114
    v_mfma_f32_32x32x16_bf16 v[96:111], a[60:63], v[136:139], v[96:111]
    s_add_u32 s34, s52, 45056
    s_and_b32 s34, s34, 0xffff
    buffer_load_dwordx4 v[136:139], v44, s[8:11], s34 offen offset:0 sc1
    v_fmac_f32 v85, s13, v115
    v_accvgpr_read_b32 v115, a146
    v_lshlrev_b32 v114, 16, v115
    s_waitcnt vmcnt(30) lgkmcnt(2)
    v_mfma_f32_32x32x16_bf16 v[64:79], a[200:203], v[140:143], v[64:79]
    v_and_b32 v115, s47, v115
    v_fmac_f32 v84, s14, v114
    v_fmac_f32 v85, s14, v115
    v_accvgpr_read_b32 v115, a147
    v_lshlrev_b32 v114, 16, v115
    v_and_b32 v115, s47, v115
    v_fmac_f32 v84, s15, v114
    v_fmac_f32 v85, s15, v115
    v_mfma_f32_32x32x16_bf16 v[96:111], a[204:207], v[140:143], v[96:111]
    buffer_load_dwordx4 v[140:143], v44, s[8:11], s34 offen offset:1024 sc1
    v_accvgpr_read_b32 v115, a148
    v_lshlrev_b32 v114, 16, v115
    v_and_b32 v115, s47, v115
    v_fmac_f32 v84, s16, v114
    v_fmac_f32 v85, s16, v115
    s_waitcnt vmcnt(28) lgkmcnt(0)
    v_mfma_f32_32x32x16_bf16 v[64:79], a[192:195], v[152:155], v[64:79]
    ds_read_b128 a[200:203], v8 offset:16640
    ds_read_b128 a[204:207], v9 offset:16640
    v_accvgpr_read_b32 v115, a149
    v_lshlrev_b32 v114, 16, v115
    v_and_b32 v115, s47, v115
    v_fmac_f32 v84, s17, v114
    v_fmac_f32 v85, s17, v115
    v_mfma_f32_32x32x16_bf16 v[96:111], a[196:199], v[152:155], v[96:111]
    buffer_load_dwordx4 v[152:155], v44, s[8:11], s34 offen offset:2048 sc1
    v_accvgpr_read_b32 v115, a150
    v_lshlrev_b32 v114, 16, v115
    v_and_b32 v115, s47, v115
    v_fmac_f32 v84, s18, v114
    v_fmac_f32 v85, s18, v115
    s_waitcnt vmcnt(28) lgkmcnt(1)
    v_mfma_f32_32x32x16_bf16 v[64:79], a[200:203], v[156:159], v[64:79]
    ds_read_b128 a[192:195], v8 offset:24832
    ds_read_b128 a[196:199], v9 offset:24832
    v_accvgpr_read_b32 v115, a151
    v_lshlrev_b32 v114, 16, v115
    v_and_b32 v115, s47, v115
    v_fmac_f32 v84, s19, v114
    v_fmac_f32 v85, s19, v115
    s_waitcnt lgkmcnt(2)
    v_mfma_f32_32x32x16_bf16 v[96:111], a[204:207], v[156:159], v[96:111]
    buffer_load_dwordx4 v[156:159], v44, s[8:11], s34 offen offset:3072 sc1
    v_lshlrev_b32 v86, 3, v0
    s_lshl_b32 s13, s5, 11
    s_add_u32 s13, s13, 19988480
    s_waitcnt vmcnt(26) lgkmcnt(1)
    v_mfma_f32_32x32x16_bf16 v[64:79], a[192:195], v[224:227], v[64:79]
    ds_read_b128 a[200:203], v8 offset:8192
    ds_read_b128 a[204:207], v9 offset:8192
    buffer_store_dwordx2 v[84:85], v86, s[28:31], s13 offen sc1
    s_waitcnt lgkmcnt(2)
    v_mfma_f32_32x32x16_bf16 v[96:111], a[196:199], v[224:227], v[96:111]
    s_waitcnt vmcnt(26) lgkmcnt(1)
    v_mfma_f32_32x32x16_bf16 v[64:79], a[200:203], v[228:231], v[64:79]
    ds_read_b128 a[192:195], v8 offset:0
    ds_read_b128 a[196:199], v9 offset:0
    s_waitcnt lgkmcnt(2)
    v_mfma_f32_32x32x16_bf16 v[96:111], a[204:207], v[228:231], v[96:111]
    buffer_load_dwordx4 a[128:131], v24, s[76:79], s51 offen offset:2048 sc1
    buffer_load_dwordx4 a[132:135], v25, s[76:79], s51 offen offset:2048 sc1
    s_add_u32 s51, s51, 4096
    v_lshlrev_b32 v80, 16, v16
    v_and_b32 v81, s47, v16
    v_lshlrev_b32 v82, 16, v17
    s_waitcnt vmcnt(25) lgkmcnt(1)
    v_mfma_f32_32x32x16_bf16 v[64:79], a[192:195], v[232:235], v[64:79]
    ds_read_b128 a[200:203], v8 offset:49920
    ds_read_b128 a[204:207], v9 offset:49920
    v_and_b32 v83, s47, v17
    v_lshlrev_b32 v84, 16, v18
    v_and_b32 v85, s47, v18
    v_lshlrev_b32 v86, 16, v19
    v_and_b32 v87, s47, v19
    v_lshlrev_b32 v88, 16, v20
    v_and_b32 v89, s47, v20
    s_waitcnt lgkmcnt(2)
    v_mfma_f32_32x32x16_bf16 v[96:111], a[196:199], v[232:235], v[96:111]
    v_lshlrev_b32 v90, 16, v21
    v_and_b32 v91, s47, v21
    v_lshlrev_b32 v92, 16, v22
    v_and_b32 v93, s47, v22
    v_lshlrev_b32 v94, 16, v23
    v_and_b32 v95, s47, v23
    v_mul_f32 v112, 0xbfb8aa3b, v80
    v_mul_f32 v113, 0xbfb8aa3b, v81
    v_mul_f32 v114, 0xbfb8aa3b, v82
    v_mul_f32 v115, 0xbfb8aa3b, v83
    s_waitcnt vmcnt(24) lgkmcnt(1)
    v_mfma_f32_32x32x16_bf16 v[64:79], a[200:203], v[236:239], v[64:79]
    ds_read_b128 a[192:195], v8 offset:58112
    ds_read_b128 a[196:199], v9 offset:58112
    v_mul_f32 v116, 0xbfb8aa3b, v84
    v_mul_f32 v117, 0xbfb8aa3b, v85
    v_mul_f32 v118, 0xbfb8aa3b, v86
    v_mul_f32 v119, 0xbfb8aa3b, v87
    v_mul_f32 v120, 0xbfb8aa3b, v88
    v_mul_f32 v121, 0xbfb8aa3b, v89
    v_mul_f32 v122, 0xbfb8aa3b, v90
    s_waitcnt lgkmcnt(2)
    v_mfma_f32_32x32x16_bf16 v[96:111], a[204:207], v[236:239], v[96:111]
    buffer_load_dwordx4 a[136:139], v24, s[76:79], s51 offen offset:0 sc1
    buffer_load_dwordx4 a[140:143], v25, s[76:79], s51 offen offset:0 sc1
    s_waitcnt vmcnt(9)
    v_cmp_ne_u32 vcc, 0, v27
    s_nop 0
    s_mov_b32 s42, vcc_lo
    v_mul_f32 v123, 0xbfb8aa3b, v91
    v_mul_f32 v124, 0xbfb8aa3b, v92
    s_waitcnt lgkmcnt(1)
    v_mfma_f32_32x32x16_bf16 v[64:79], a[192:195], v[240:243], v[64:79]
    s_bitcmp1_b32 s42, 0
    s_cbranch_scc0 L_hspin10
L_hok10:
    s_add_u32 s34, s52, 0
    s_and_b32 s34, s34, 0xffff
    buffer_load_dwordx4 v[224:227], v44, s[20:23], s34 offen offset:0 sc1
    buffer_load_dwordx4 v[228:231], v44, s[20:23], s34 offen offset:1024 sc1
    buffer_load_dword v27, v31, s[28:31], s41 offen offset:128 sc1
    s_waitcnt lgkmcnt(0)
    v_mfma_f32_32x32x16_bf16 v[96:111], a[196:199], v[240:243], v[96:111]
    buffer_load_dwordx4 v[232:235], v44, s[20:23], s34 offen offset:2048 sc1
    buffer_load_dwordx4 v[236:239], v44, s[20:23], s34 offen offset:3072 sc1
    v_mul_f32 v125, 0xbfb8aa3b, v93
    v_mul_f32 v126, 0xbfb8aa3b, v94
    v_mul_f32 v127, 0xbfb8aa3b, v95
    v_mfma_f32_32x32x16_bf16 v[64:79], a[208:211], v[244:247], v[64:79]
    s_add_u32 s34, s52, 4096
    s_and_b32 s34, s34, 0xffff
    buffer_load_dwordx4 v[240:243], v44, s[20:23], s34 offen offset:0 sc1
    v_exp_f32 v112, v112
    v_exp_f32 v113, v113
    v_mfma_f32_32x32x16_bf16 v[96:111], a[212:215], v[244:247], v[96:111]
    buffer_load_dwordx4 v[244:247], v44, s[20:23], s34 offen offset:1024 sc1
    buffer_load_dwordx4 a[144:147], v24, s[76:79], s51 offen offset:2048 sc1
    buffer_load_dwordx4 a[148:151], v25, s[76:79], s51 offen offset:2048 sc1
    s_add_u32 s51, s51, 4096
    s_and_b32 s51, s51, 0x1ffff
    v_mfma_f32_32x32x16_bf16 v[64:79], a[216:219], v[248:251], v[64:79]
    v_exp_f32 v114, v114
    v_exp_f32 v115, v115
    v_exp_f32 v116, v116
    v_exp_f32 v117, v117
    v_exp_f32 v118, v118
    v_mfma_f32_32x32x16_bf16 v[96:111], a[220:223], v[248:251], v[96:111]
    buffer_load_dwordx4 v[248:251], v44, s[20:23], s34 offen offset:2048 sc1
    v_exp_f32 v119, v119
    v_exp_f32 v120, v120
    v_exp_f32 v121, v121
    v_mfma_f32_32x32x16_bf16 v[64:79], a[64:67], v[252:255], v[64:79]
    v_exp_f32 v122, v122
    v_exp_f32 v123, v123
    v_exp_f32 v124, v124
    v_exp_f32 v125, v125
    v_exp_f32 v126, v126
    v_mfma_f32_32x32x16_bf16 v[96:111], a[68:71], v[252:255], v[96:111]
    buffer_load_dwordx4 v[252:255], v44, s[20:23], s34 offen offset:3072 sc1
    v_exp_f32 v127, v127
    v_add_f32 v112, 1.0, v112
    v_add_f32 v113, 1.0, v113
    v_add_f32 v114, 1.0, v114
    v_add_f32 v115, 1.0, v115
    v_add_f32 v116, 1.0, v116
    v_mfma_f32_32x32x16_bf16 v[64:79], a[72:75], v[176:179], v[64:79]
    v_add_f32 v117, 1.0, v117
    v_add_f32 v118, 1.0, v118
    v_add_f32 v119, 1.0, v119
    v_add_f32 v120, 1.0, v120
    v_add_f32 v121, 1.0, v121
    v_add_f32 v122, 1.0, v122
    v_add_f32 v123, 1.0, v123
    v_add_f32 v124, 1.0, v124
    v_add_f32 v125, 1.0, v125
    v_add_f32 v126, 1.0, v126
    v_mfma_f32_32x32x16_bf16 v[96:111], a[76:79], v[176:179], v[96:111]
    s_bitcmp1_b32 s42, 1
    s_cbranch_scc0 L_hspin11
L_hok11:
    s_add_u32 s34, s52, 8192
    s_and_b32 s34, s34, 0xffff
    buffer_load_dwordx4 v[176:179], v44, s[20:23], s34 offen offset:0 sc1
    v_add_f32 v127, 1.0, v127
    v_mfma_f32_32x32x16_bf16 v[64:79], a[80:83], v[180:183], v[64:79]
    v_rcp_f32 v112, v112
    v_rcp_f32 v113, v113
    v_rcp_f32 v114, v114
    v_rcp_f32 v115, v115
    v_rcp_f32 v116, v116
    v_mfma_f32_32x32x16_bf16 v[96:111], a[84:87], v[180:183], v[96:111]
    buffer_load_dwordx4 v[180:183], v44, s[20:23], s34 offen offset:1024 sc1
    v_rcp_f32 v117, v117
    v_rcp_f32 v118, v118
    v_rcp_f32 v119, v119
    v_mfma_f32_32x32x16_bf16 v[64:79], a[88:91], v[184:187], v[64:79]
    v_rcp_f32 v120, v120
    v_rcp_f32 v121, v121
    v_rcp_f32 v122, v122
    v_rcp_f32 v123, v123
    v_rcp_f32 v124, v124
    v_mfma_f32_32x32x16_bf16 v[96:111], a[92:95], v[184:187], v[96:111]
    buffer_load_dwordx4 v[184:187], v44, s[20:23], s34 offen offset:2048 sc1
    v_rcp_f32 v125, v125
    v_rcp_f32 v126, v126
    v_rcp_f32 v127, v127
    v_mul_f32 v112, v112, v80
    v_mfma_f32_32x32x16_bf16 v[64:79], a[96:99], v[188:191], v[64:79]
    v_mul_f32 v113, v113, v81
    v_mul_f32 v114, v114, v82
    v_mul_f32 v115, v115, v83
    v_mul_f32 v116, v116, v84
    v_mul_f32 v117, v117, v85
    v_mul_f32 v118, v118, v86
    v_mul_f32 v119, v119, v87
    v_mul_f32 v120, v120, v88
    v_mul_f32 v121, v121, v89
    v_mul_f32 v122, v122, v90
    v_mfma_f32_32x32x16_bf16 v[96:111], a[100:103], v[188:191], v[96:111]
    buffer_load_dwordx4 v[188:191], v44, s[20:23], s34 offen offset:3072 sc1
    v_mul_f32 v123, v123, v91
    v_mul_f32 v124, v124, v92
    v_mul_f32 v125, v125, v93
    v_mul_f32 v126, v126, v94
    v_mul_f32 v127, v127, v95
    v_cvt_pk_bf16_f32 v54, v112, v113
    v_cvt_pk_bf16_f32 v55, v114, v115
    s_waitcnt vmcnt(23)
    v_mfma_f32_32x32x16_bf16 v[64:79], a[104:107], v[136:139], v[64:79]
    v_cvt_pk_bf16_f32 v56, v116, v117
    v_cvt_pk_bf16_f32 v57, v118, v119
    v_cvt_pk_bf16_f32 v58, v120, v121
    v_cvt_pk_bf16_f32 v59, v122, v123
    v_cvt_pk_bf16_f32 v60, v124, v125
    v_cvt_pk_bf16_f32 v61, v126, v127
    ds_read_b128 v[16:19], v28 offset:8192
    ds_read_b128 v[20:23], v29 offset:8192
    v_mfma_f32_32x32x16_bf16 v[96:111], a[108:111], v[136:139], v[96:111]
    s_add_u32 s34, s52, 12288
    s_and_b32 s34, s34, 0xffff
    buffer_load_dwordx4 v[136:139], v44, s[20:23], s34 offen offset:0 sc1
    s_waitcnt vmcnt(23)
    v_mfma_f32_32x32x16_bf16 v[64:79], a[112:115], v[140:143], v[64:79]
    ds_read_b128 a[200:203], v8 offset:33280
    ds_read_b128 a[204:207], v9 offset:33280
    v_mfma_f32_32x32x16_bf16 v[96:111], a[116:119], v[140:143], v[96:111]
    buffer_load_dwordx4 v[140:143], v44, s[20:23], s34 offen offset:1024 sc1
    s_waitcnt vmcnt(23)
    v_mfma_f32_32x32x16_bf16 v[64:79], a[120:123], v[152:155], v[64:79]
    s_waitcnt vmcnt(21)
    s_waitcnt lgkmcnt(0)
    s_barrier
    buffer_store_dword v35, v34, s[28:31], s38 offen sc1
    v_mfma_f32_32x32x16_bf16 v[96:111], a[124:127], v[152:155], v[96:111]
    buffer_load_dwordx4 v[152:155], v44, s[20:23], s34 offen offset:2048 sc1
    v_mfma_f32_32x32x16_bf16 v[64:79], a[200:203], v[156:159], v[64:79]
    s_add_u32 m0, s50, 141056
    s_nop 0
    buffer_load_dwordx4 v44, s[76:79], s51 offen offset:0 sc1 lds
    buffer_load_dwordx4 v44, s[76:79], s51 offen offset:1024 sc1 lds
    v_mfma_f32_32x32x16_bf16 v[96:111], a[204:207], v[156:159], v[96:111]
    buffer_load_dwordx4 v[156:159], v44, s[20:23], s34 offen offset:3072 sc1
    s_waitcnt vmcnt(21)
    v_mfma_f32_32x32x16_bf16 v[80:95], a[152:155], v[224:227], 0
    s_waitcnt vmcnt(19)
    v_cmp_ne_u32 vcc, 0, v27
    s_nop 0
    s_mov_b32 s42, vcc_lo
    v_mfma_f32_32x32x16_bf16 v[112:127], a[156:159], v[224:227], 0
    s_bitcmp1_b32 s42, 2
    s_cbranch_scc0 L_hspin12
L_hok12:
    s_add_u32 s34, s52, 16384
    s_and_b32 s34, s34, 0xffff
    buffer_load_dwordx4 v[224:227], v44, s[20:23], s34 offen offset:0 sc1
    v_mfma_f32_32x32x16_bf16 v[80:95], a[160:163], v[228:231], v[80:95]
    s_add_u32 m0, s50, 147200
    s_nop 0
    buffer_load_dwordx4 v44, s[76:79], s51 offen offset:2048 sc1 lds
    buffer_load_dwordx4 v44, s[76:79], s51 offen offset:3072 sc1 lds
    s_add_u32 s51, s51, 4096
    v_mfma_f32_32x32x16_bf16 v[112:127], a[164:167], v[228:231], v[112:127]
    buffer_load_dwordx4 v[228:231], v44, s[20:23], s34 offen offset:1024 sc1
    s_waitcnt vmcnt(22)
    v_mfma_f32_32x32x16_bf16 v[80:95], a[168:171], v[232:235], v[80:95]
    buffer_load_dwordx4 v[50:53], v44, s[28:31], s41 offen offset:256 sc1
    v_mfma_f32_32x32x16_bf16 v[112:127], a[172:175], v[232:235], v[112:127]
    buffer_load_dwordx4 v[232:235], v44, s[20:23], s34 offen offset:2048 sc1
    s_waitcnt vmcnt(23)
    v_mfma_f32_32x32x16_bf16 v[80:95], a[176:179], v[236:239], v[80:95]
    v_mfma_f32_32x32x16_bf16 v[112:127], a[180:183], v[236:239], v[112:127]
    buffer_load_dwordx4 v[236:239], v44, s[20:23], s34 offen offset:3072 sc1
    s_waitcnt vmcnt(23)
    v_mfma_f32_32x32x16_bf16 v[80:95], a[184:187], v[240:243], v[80:95]
    v_mfma_f32_32x32x16_bf16 v[112:127], a[188:191], v[240:243], v[112:127]
    s_add_u32 s34, s52, 20480
    s_and_b32 s34, s34, 0xffff
    buffer_load_dwordx4 v[240:243], v44, s[20:23], s34 offen offset:0 sc1
    s_waitcnt vmcnt(23)
    v_mfma_f32_32x32x16_bf16 v[80:95], a[224:227], v[244:247], v[80:95]
    s_sub_u32 s43, s4, s6
    s_lshl_b32 s16, s7, 8
    s_add_u32 s16, s16, 19988480
    v_mfma_f32_32x32x16_bf16 v[112:127], a[228:231], v[244:247], v[112:127]
    buffer_load_dwordx4 v[244:247], v44, s[20:23], s34 offen offset:1024 sc1
    s_waitcnt vmcnt(21)
    v_mfma_f32_32x32x16_bf16 v[80:95], a[232:235], v[248:251], v[80:95]
    s_cmp_lt_u32 s43, 64
    s_cselect_b32 s16, s16, 1073741824
    s_cselect_b32 s18, -1, 0
    s_cselect_b32 s19, 0x7ff, 0
    v_mfma_f32_32x32x16_bf16 v[112:127], a[236:239], v[248:251], v[112:127]
    buffer_load_dwordx4 v[248:251], v44, s[20:23], s34 offen offset:2048 sc1
    v_and_b32 v4, 15, v0
    s_waitcnt vmcnt(21)
    v_mfma_f32_32x32x16_bf16 v[80:95], a[240:243], v[252:255], v[80:95]
    ds_read_b128 a[192:195], v10 offset:50944
    ds_read_b128 a[196:199], v11 offset:50944
    v_lshrrev_b32 v30, 4, v0
    v_mfma_f32_32x32x16_bf16 v[112:127], a[244:247], v[252:255], v[112:127]
    buffer_load_dwordx4 v[252:255], v44, s[20:23], s34 offen offset:3072 sc1
    v_lshlrev_b32 v30, 11, v30
    s_waitcnt vmcnt(21)
    v_mfma_f32_32x32x16_bf16 v[80:95], a[248:251], v[176:179], v[80:95]
    ds_read_b128 a[200:203], v10 offset:59136
    ds_read_b128 a[204:207], v11 offset:59136
    v_lshl_add_u32 v4, v4, 4, v30
    v_mfma_f32_32x32x16_bf16 v[112:127], a[252:255], v[176:179], v[112:127]
    s_bitcmp1_b32 s42, 3
    s_cbranch_scc0 L_hspin13
L_hok13:
    s_add_u32 s34, s52, 24576
    s_and_b32 s34, s34, 0xffff
    buffer_load_dwordx4 v[176:179], v44, s[20:23], s34 offen offset:0 sc1
    s_waitcnt vmcnt(21) lgkmcnt(3)
    v_mfma_f32_32x32x16_bf16 v[80:95], a[192:195], v[180:183], v[80:95]
    s_waitcnt lgkmcnt(2)
    v_mfma_f32_32x32x16_bf16 v[112:127], a[196:199], v[180:183], v[112:127]
    buffer_load_dwordx4 v[180:183], v44, s[20:23], s34 offen offset:1024 sc1
    s_waitcnt vmcnt(21) lgkmcnt(1)
    v_mfma_f32_32x32x16_bf16 v[80:95], a[200:203], v[184:187], v[80:95]
    ds_read_b128 a[192:195], v12 offset:1792
    ds_read_b128 a[196:199], v13 offset:1792
    s_waitcnt lgkmcnt(2)
    v_mfma_f32_32x32x16_bf16 v[112:127], a[204:207], v[184:187], v[112:127]
    buffer_load_dwordx4 v[184:187], v44, s[20:23], s34 offen offset:2048 sc1
    s_waitcnt vmcnt(21) lgkmcnt(1)
    v_mfma_f32_32x32x16_bf16 v[80:95], a[192:195], v[188:191], v[80:95]
    s_add_u32 m0, s50, 116480
    s_nop 0
    buffer_load_dwordx4 v44, s[76:79], s51 offen offset:0 sc1 lds
    buffer_load_dwordx4 v44, s[76:79], s51 offen offset:1024 sc1 lds
    s_waitcnt lgkmcnt(0)
    v_mfma_f32_32x32x16_bf16 v[112:127], a[196:199], v[188:191], v[112:127]
    buffer_load_dwordx4 v[188:191], v44, s[20:23], s34 offen offset:3072 sc1
    s_waitcnt vmcnt(23)
    v_mfma_f32_32x32x16_bf16 v[80:95], v[36:39], v[136:139], v[80:95]
    s_add_u32 m0, s50, 122624
    s_nop 0
    buffer_load_dwordx4 v44, s[76:79], s51 offen offset:2048 sc1 lds
    buffer_load_dwordx4 v44, s[76:79], s51 offen offset:3072 sc1 lds
    s_add_u32 s51, s51, 4096
    v_mfma_f32_32x32x16_bf16 v[112:127], v[40:43], v[136:139], v[112:127]
    s_add_u32 s34, s52, 28672
    s_and_b32 s34, s34, 0xffff
    buffer_load_dwordx4 v[136:139], v44, s[20:23], s34 offen offset:0 sc1
    s_waitcnt vmcnt(25)
    v_mfma_f32_32x32x16_bf16 v[80:95], v[192:195], v[140:143], v[80:95]
    s_add_u32 m0, s50, 132864
    s_nop 0
    buffer_load_dwordx4 v44, s[76:79], s51 offen offset:0 sc1 lds
    buffer_load_dwordx4 v44, s[76:79], s51 offen offset:1024 sc1 lds
    v_mfma_f32_32x32x16_bf16 v[112:127], v[196:199], v[140:143], v[112:127]
    buffer_load_dwordx4 v[140:143], v44, s[20:23], s34 offen offset:1024 sc1
    s_waitcnt vmcnt(26)
    v_mfma_f32_32x32x16_bf16 v[80:95], v[200:203], v[152:155], v[80:95]
    buffer_load_dwordx4 a[232:235], v24, s[76:79], s51 offen offset:2048 sc1
    buffer_load_dwordx4 a[236:239], v25, s[76:79], s51 offen offset:2048 sc1
    s_add_u32 s51, s51, 4096
    v_mfma_f32_32x32x16_bf16 v[112:127], v[204:207], v[152:155], v[112:127]
    buffer_load_dwordx4 v[152:155], v44, s[20:23], s34 offen offset:2048 sc1
    s_waitcnt vmcnt(26)
    v_mfma_f32_32x32x16_bf16 v[80:95], v[208:211], v[156:159], v[80:95]
    buffer_load_dwordx4 a[240:243], v24, s[76:79], s51 offen offset:0 sc1
    buffer_load_dwordx4 a[244:247], v25, s[76:79], s51 offen offset:0 sc1
    v_mfma_f32_32x32x16_bf16 v[112:127], v[212:215], v[156:159], v[112:127]
    buffer_load_dwordx4 v[156:159], v44, s[20:23], s34 offen offset:3072 sc1
    s_waitcnt vmcnt(28)
    v_mfma_f32_32x32x16_bf16 v[80:95], v[216:219], v[224:227], v[80:95]
    buffer_load_dwordx4 a[248:251], v24, s[76:79], s51 offen offset:2048 sc1
    buffer_load_dwordx4 a[252:255], v25, s[76:79], s51 offen offset:2048 sc1
    s_add_u32 s51, s51, 4096
    s_and_b32 s51, s51, 0x1ffff
    v_mfma_f32_32x32x16_bf16 v[112:127], v[220:223], v[224:227], v[112:127]
    s_bitcmp1_b32 s42, 4
    s_cbranch_scc0 L_hspin14
L_hok14:
    s_add_u32 s34, s52, 32768
    s_and_b32 s34, s34, 0xffff
    buffer_load_dwordx4 v[224:227], v44, s[20:23], s34 offen offset:0 sc1
    s_waitcnt vmcnt(28)
    v_mfma_f32_32x32x16_bf16 v[80:95], v[160:163], v[228:231], v[80:95]
    s_waitcnt vmcnt(27)
    v_and_b32 v50, v50, v51
    v_and_b32 v52, v52, v53
    v_and_b32 v50, v50, v52
    v_cmp_eq_u32 vcc, 0, v50
    s_nop 0
    s_and_b64 vcc, vcc, s[18:19]
    s_cbranch_scc1 L_yspin
L_yok:
    v_mfma_f32_32x32x16_bf16 v[112:127], v[164:167], v[228:231], v[112:127]
    buffer_load_dwordx4 v[228:231], v44, s[20:23], s34 offen offset:1024 sc1
    s_waitcnt vmcnt(27)
    v_mfma_f32_32x32x16_bf16 v[80:95], v[168:171], v[232:235], v[80:95]
    s_cmp_lg_u32 s18, 0
    s_cbranch_scc1 L_yld
L_yldb:
    v_mfma_f32_32x32x16_bf16 v[112:127], v[172:175], v[232:235], v[112:127]
    buffer_load_dwordx4 v[232:235], v44, s[20:23], s34 offen offset:2048 sc1
    s_waitcnt vmcnt(27)
    v_mfma_f32_32x32x16_bf16 v[80:95], v[128:131], v[236:239], v[80:95]
    s_lshl_b32 s43, s4, 10
    s_lshl_b32 s17, s7, 7
    s_add_u32 s43, s43, s17
    v_lshlrev_b32 v30, 1, v2
    v_mfma_f32_32x32x16_bf16 v[112:127], v[132:135], v[236:239], v[112:127]
    buffer_load_dwordx4 v[236:239], v44, s[20:23], s34 offen offset:3072 sc1
    s_waitcnt vmcnt(27)
    v_mfma_f32_32x32x16_bf16 v[80:95], v[144:147], v[240:243], v[80:95]
    v_mfma_f32_32x32x16_bf16 v[112:127], v[148:151], v[240:243], v[112:127]
    s_add_u32 s34, s52, 36864
    s_and_b32 s34, s34, 0xffff
    buffer_load_dwordx4 v[240:243], v44, s[20:23], s34 offen offset:0 sc1
    s_waitcnt vmcnt(27)
    v_mfma_f32_32x32x16_bf16 v[80:95], a[0:3], v[244:247], v[80:95]
    buffer_load_ushort v29, v30, s[28:31], s43 offen sc1
    v_mfma_f32_32x32x16_bf16 v[112:127], a[4:7], v[244:247], v[112:127]
    buffer_load_dwordx4 v[244:247], v44, s[20:23], s34 offen offset:1024 sc1
    s_waitcnt vmcnt(28)
    v_mfma_f32_32x32x16_bf16 v[80:95], a[8:11], v[248:251], v[80:95]
    v_mfma_f32_32x32x16_bf16 v[112:127], a[12:15], v[248:251], v[112:127]
    buffer_load_dwordx4 v[248:251], v44, s[20:23], s34 offen offset:2048 sc1
    s_waitcnt vmcnt(28)
    v_mfma_f32_32x32x16_bf16 v[80:95], a[16:19], v[252:255], v[80:95]
    v_mfma_f32_32x32x16_bf16 v[112:127], a[20:23], v[252:255], v[112:127]
    buffer_load_dwordx4 v[252:255], v44, s[20:23], s34 offen offset:3072 sc1
    s_waitcnt vmcnt(28)
    v_mfma_f32_32x32x16_bf16 v[80:95], a[24:27], v[176:179], v[80:95]
    v_mfma_f32_32x32x16_bf16 v[112:127], a[28:31], v[176:179], v[112:127]
    s_bitcmp1_b32 s42, 5
    s_cbranch_scc0 L_hspin15
L_hok15:
    s_add_u32 s34, s52, 40960
    s_and_b32 s34, s34, 0xffff
    buffer_load_dwordx4 v[176:179], v44, s[20:23], s34 offen offset:0 sc1
    s_waitcnt vmcnt(28)
    v_mfma_f32_32x32x16_bf16 v[80:95], a[32:35], v[180:183], v[80:95]
    v_mfma_f32_32x32x16_bf16 v[112:127], a[36:39], v[180:183], v[112:127]
    buffer_load_dwordx4 v[180:183], v44, s[20:23], s34 offen offset:1024 sc1
    s_waitcnt vmcnt(28)
    v_mfma_f32_32x32x16_bf16 v[80:95], a[40:43], v[184:187], v[80:95]
    v_mfma_f32_32x32x16_bf16 v[112:127], a[44:47], v[184:187], v[112:127]
    buffer_load_dwordx4 v[184:187], v44, s[20:23], s34 offen offset:2048 sc1
    s_waitcnt vmcnt(26)
    v_mfma_f32_32x32x16_bf16 v[80:95], a[48:51], v[188:191], v[80:95]
    ds_read_b128 a[200:203], v10 offset:1024
    ds_read_b128 a[204:207], v11 offset:1024
    v_mfma_f32_32x32x16_bf16 v[112:127], a[52:55], v[188:191], v[112:127]
    buffer_load_dwordx4 v[188:191], v44, s[20:23], s34 offen offset:3072 sc1
    s_waitcnt vmcnt(24)
    v_mfma_f32_32x32x16_bf16 v[80:95], a[56:59], v[136:139], v[80:95]
    ds_read_b128 a[192:195], v10 offset:9216
    ds_read_b128 a[196:199], v11 offset:9216
    v_mfma_f32_32x32x16_bf16 v[112:127], a[60:63], v[136:139], v[112:127]
    s_add_u32 s34, s52, 45056
    s_and_b32 s34, s34, 0xffff
    buffer_load_dwordx4 v[136:139], v44, s[20:23], s34 offen offset:0 sc1
    s_waitcnt vmcnt(22) lgkmcnt(3)
    v_mfma_f32_32x32x16_bf16 v[80:95], a[200:203], v[140:143], v[80:95]
    s_waitcnt lgkmcnt(2)
    v_mfma_f32_32x32x16_bf16 v[112:127], a[204:207], v[140:143], v[112:127]
    buffer_load_dwordx4 v[140:143], v44, s[20:23], s34 offen offset:1024 sc1
    s_waitcnt vmcnt(20) lgkmcnt(1)
    v_mfma_f32_32x32x16_bf16 v[80:95], a[192:195], v[152:155], v[80:95]
    ds_read_b128 a[200:203], v8 offset:16640
    ds_read_b128 a[204:207], v9 offset:16640
    s_waitcnt lgkmcnt(2)
    v_mfma_f32_32x32x16_bf16 v[112:127], a[196:199], v[152:155], v[112:127]
    buffer_load_dwordx4 v[152:155], v44, s[20:23], s34 offen offset:2048 sc1
    s_waitcnt vmcnt(18) lgkmcnt(1)
    v_mfma_f32_32x32x16_bf16 v[80:95], a[200:203], v[156:159], v[80:95]
    ds_read_b128 a[192:195], v8 offset:24832
    ds_read_b128 a[196:199], v9 offset:24832
    s_waitcnt lgkmcnt(2)
    v_mfma_f32_32x32x16_bf16 v[112:127], a[204:207], v[156:159], v[112:127]
    buffer_load_dwordx4 v[156:159], v44, s[20:23], s34 offen offset:3072 sc1
    s_waitcnt vmcnt(16) lgkmcnt(1)
    v_mfma_f32_32x32x16_bf16 v[80:95], a[192:195], v[224:227], v[80:95]
    ds_read_b128 a[200:203], v8 offset:8192
    ds_read_b128 a[204:207], v9 offset:8192
    s_waitcnt lgkmcnt(2)
    v_mfma_f32_32x32x16_bf16 v[112:127], a[196:199], v[224:227], v[112:127]
    s_bitcmp1_b32 s37, 6
    s_cbranch_scc0 L_hspin06
L_hok06:
    s_add_u32 s34, s52, 49152
    s_and_b32 s34, s34, 0xffff
    buffer_load_dwordx4 v[224:227], v44, s[8:11], s34 offen offset:0 sc1
    s_waitcnt vmcnt(16) lgkmcnt(1)
    v_mfma_f32_32x32x16_bf16 v[80:95], a[200:203], v[228:231], v[80:95]
    ds_read_b128 a[192:195], v8 offset:0
    ds_read_b128 a[196:199], v9 offset:0
    s_waitcnt lgkmcnt(2)
    v_mfma_f32_32x32x16_bf16 v[112:127], a[204:207], v[228:231], v[112:127]
    s_bitcmp1_b32 s42, 6
    s_cbranch_scc0 L_hspin16
L_hok16:
    buffer_load_dwordx4 v[228:231], v44, s[20:23], s34 offen offset:0 sc1
    s_waitcnt vmcnt(16) lgkmcnt(1)
    v_mfma_f32_32x32x16_bf16 v[80:95], a[192:195], v[232:235], v[80:95]
    ds_read_b128 a[200:203], v8 offset:49920
    ds_read_b128 a[204:207], v9 offset:49920
    s_waitcnt lgkmcnt(2)
    v_mfma_f32_32x32x16_bf16 v[112:127], a[196:199], v[232:235], v[112:127]
    buffer_load_dwordx4 v[232:235], v44, s[8:11], s34 offen offset:1024 sc1
    s_waitcnt vmcnt(16) lgkmcnt(1)
    v_mfma_f32_32x32x16_bf16 v[80:95], a[200:203], v[236:239], v[80:95]
    ds_read_b128 a[192:195], v8 offset:58112
    ds_read_b128 a[196:199], v9 offset:58112
    s_waitcnt lgkmcnt(2)
    v_mfma_f32_32x32x16_bf16 v[112:127], a[204:207], v[236:239], v[112:127]
    buffer_load_dwordx4 v[236:239], v44, s[20:23], s34 offen offset:1024 sc1
    s_waitcnt vmcnt(16) lgkmcnt(1)
    v_mfma_f32_32x32x16_bf16 v[80:95], a[192:195], v[240:243], v[80:95]
    v_accvgpr_read_b32 v46, a152
    v_accvgpr_read_b32 v47, a153
    v_accvgpr_read_b32 v48, a154
    v_accvgpr_read_b32 v49, a155
    v_accvgpr_read_b32 v50, a156
    v_accvgpr_read_b32 v51, a157
    v_accvgpr_read_b32 v52, a158
    s_waitcnt lgkmcnt(0)
    v_mfma_f32_32x32x16_bf16 v[112:127], a[196:199], v[240:243], v[112:127]
    buffer_load_dwordx4 v[240:243], v44, s[8:11], s34 offen offset:2048 sc1
    v_accvgpr_read_b32 v53, a159
    v_add_f32 v46, v46, v50
    v_add_f32 v47, v47, v51
    v_add_f32 v48, v48, v52
    s_waitcnt vmcnt(15)
    v_mfma_f32_32x32x16_bf16 v[80:95], a[208:211], v[244:247], v[80:95]
    v_add_f32 v49, v49, v53
    v_accvgpr_read_b32 v50, a160
    v_accvgpr_read_b32 v51, a161
    v_accvgpr_read_b32 v52, a162
    v_accvgpr_read_b32 v53, a163
    v_add_f32 v46, v46, v50
    v_add_f32 v47, v47, v51
    v_mfma_f32_32x32x16_bf16 v[112:127], a[212:215], v[244:247], v[112:127]
    buffer_load_dwordx4 v[244:247], v44, s[20:23], s34 offen offset:2048 sc1
    v_add_f32 v48, v48, v52
    v_add_f32 v49, v49, v53
    v_accvgpr_read_b32 v50, a164
    v_accvgpr_read_b32 v51, a165
    s_waitcnt vmcnt(15)
    v_mfma_f32_32x32x16_bf16 v[80:95], a[216:219], v[248:251], v[80:95]
    v_accvgpr_read_b32 v52, a166
    v_accvgpr_read_b32 v53, a167
    v_add_f32 v46, v46, v50
    v_add_f32 v47, v47, v51
    v_add_f32 v48, v48, v52
    v_add_f32 v49, v49, v53
    v_accvgpr_read_b32 v50, a168
    v_mfma_f32_32x32x16_bf16 v[112:127], a[220:223], v[248:251], v[112:127]
    buffer_load_dwordx4 v[248:251], v44, s[8:11], s34 offen offset:3072 sc1
    v_accvgpr_read_b32 v51, a169
    v_accvgpr_read_b32 v52, a170
    v_accvgpr_read_b32 v53, a171
    v_add_f32 v46, v46, v50
    s_waitcnt vmcnt(15)
    v_mfma_f32_32x32x16_bf16 v[80:95], a[64:67], v[252:255], v[80:95]
    v_add_f32 v47, v47, v51
    v_add_f32 v48, v48, v52
    v_add_f32 v49, v49, v53
    v_accvgpr_read_b32 v50, a172
    v_accvgpr_read_b32 v51, a173
    v_accvgpr_read_b32 v52, a174
    v_accvgpr_read_b32 v53, a175
    v_mfma_f32_32x32x16_bf16 v[112:127], a[68:71], v[252:255], v[112:127]
    buffer_load_dwordx4 v[252:255], v44, s[20:23], s34 offen offset:3072 sc1
    v_add_f32 v46, v46, v50
    v_add_f32 v47, v47, v51
    v_add_f32 v48, v48, v52
    v_add_f32 v49, v49, v53
    s_waitcnt vmcnt(15)
    v_mfma_f32_32x32x16_bf16 v[80:95], a[72:75], v[176:179], v[80:95]
    v_accvgpr_read_b32 v50, a176
    v_accvgpr_read_b32 v51, a177
    v_accvgpr_read_b32 v52, a178
    v_accvgpr_read_b32 v53, a179
    v_add_f32 v46, v46, v50
    v_add_f32 v47, v47, v51
    v_add_f32 v48, v48, v52
    v_mfma_f32_32x32x16_bf16 v[112:127], a[76:79], v[176:179], v[112:127]
    s_add_u32 s34, s52, 53248
    s_and_b32 s34, s34, 0xffff
    buffer_load_dwordx4 v[176:179], v44, s[8:11], s34 offen offset:0 sc1
    v_add_f32 v49, v49, v53
    v_accvgpr_read_b32 v50, a180
    s_waitcnt vmcnt(15)
    v_mfma_f32_32x32x16_bf16 v[80:95], a[80:83], v[180:183], v[80:95]
    v_accvgpr_read_b32 v51, a181
    v_accvgpr_read_b32 v52, a182
    v_accvgpr_read_b32 v53, a183
    v_add_f32 v46, v46, v50
    v_add_f32 v47, v47, v51
    v_add_f32 v48, v48, v52
    v_add_f32 v49, v49, v53
    v_mfma_f32_32x32x16_bf16 v[112:127], a[84:87], v[180:183], v[112:127]
    buffer_load_dwordx4 v[180:183], v44, s[20:23], s34 offen offset:0 sc1
    v_accvgpr_read_b32 v50, a184
    v_accvgpr_read_b32 v51, a185
    v_accvgpr_read_b32 v52, a186
    v_accvgpr_read_b32 v53, a187
    s_waitcnt vmcnt(15)
    v_mfma_f32_32x32x16_bf16 v[80:95], a[88:91], v[184:187], v[80:95]
    v_add_f32 v46, v46, v50
    v_add_f32 v47, v47, v51
    v_add_f32 v48, v48, v52
    v_add_f32 v49, v49, v53
    v_accvgpr_read_b32 v50, a188
    v_accvgpr_read_b32 v51, a189
    v_accvgpr_read_b32 v52, a190
    v_mfma_f32_32x32x16_bf16 v[112:127], a[92:95], v[184:187], v[112:127]
    buffer_load_dwordx4 v[184:187], v44, s[8:11], s34 offen offset:1024 sc1
    v_accvgpr_read_b32 v53, a191
    v_add_f32 v46, v46, v50
    v_add_f32 v47, v47, v51
    v_add_f32 v48, v48, v52
    s_waitcnt vmcnt(15)
    v_mfma_f32_32x32x16_bf16 v[80:95], a[96:99], v[188:191], v[80:95]
    v_add_f32 v49, v49, v53
    v_accvgpr_read_b32 v50, a224
    v_accvgpr_read_b32 v51, a225
    v_accvgpr_read_b32 v52, a226
    v_accvgpr_read_b32 v53, a227
    v_add_f32 v46, v46, v50
    v_add_f32 v47, v47, v51
    v_mfma_f32_32x32x16_bf16 v[112:127], a[100:103], v[188:191], v[112:127]
    buffer_load_dwordx4 v[188:191], v44, s[20:23], s34 offen offset:1024 sc1
    v_add_f32 v48, v48, v52
    v_add_f32 v49, v49, v53
    v_mov_b32 v50, v46
    v_mov_b32 v51, v47
    s_waitcnt vmcnt(15)
    v_mfma_f32_32x32x16_bf16 v[80:95], a[104:107], v[136:139], v[80:95]
    v_mov_b32 v52, v48
    v_mov_b32 v53, v49
    v_permlane32_swap_b32 v46, v50
    v_permlane32_swap_b32 v47, v51
    v_permlane32_swap_b32 v48, v52
    v_permlane32_swap_b32 v49, v53
    v_add_f32 v46, v46, v50
    v_mfma_f32_32x32x16_bf16 v[112:127], a[108:111], v[136:139], v[112:127]
    buffer_load_dwordx4 v[136:139], v44, s[8:11], s34 offen offset:2048 sc1
    v_add_f32 v47, v47, v51
    v_add_f32 v48, v48, v52
    v_add_f32 v49, v49, v53
    v_mov_b32 v50, v46
    s_waitcnt vmcnt(15)
    v_mfma_f32_32x32x16_bf16 v[80:95], a[112:115], v[140:143], v[80:95]
    ds_read_b128 a[200:203], v8 offset:33280
    ds_read_b128 a[204:207], v9 offset:33280
    v_mov_b32 v51, v47
    v_mov_b32 v52, v48
    v_mov_b32 v53, v49
    v_permlane16_swap_b32 v46, v50
    v_mfma_f32_32x32x16_bf16 v[112:127], a[116:119], v[140:143], v[112:127]
    buffer_load_dwordx4 v[140:143], v44, s[20:23], s34 offen offset:2048 sc1
    v_permlane16_swap_b32 v47, v51
    v_permlane16_swap_b32 v48, v52
    v_permlane16_swap_b32 v49, v53
    v_add_f32 v46, v46, v50
    s_waitcnt vmcnt(15)
    v_mfma_f32_32x32x16_bf16 v[80:95], a[120:123], v[152:155], v[80:95]
    ds_read_b128 a[192:195], v8 offset:41472
    ds_read_b128 a[196:199], v9 offset:41472
    v_add_f32 v47, v47, v51
    v_add_f32 v48, v48, v52
    v_add_f32 v49, v49, v53
    v_and_b32 v4, 15, v0
    v_mfma_f32_32x32x16_bf16 v[112:127], a[124:127], v[152:155], v[112:127]
    buffer_load_dwordx4 v[152:155], v44, s[8:11], s34 offen offset:3072 sc1
    v_lshlrev_b32 v4, 4, v4
    s_lshl_b32 s17, s32, 8
    s_add_u32 s17, s17, 157696
    v_add_u32 v4, s17, v4
    s_waitcnt vmcnt(15) lgkmcnt(3)
    v_mfma_f32_32x32x16_bf16 v[80:95], a[200:203], v[156:159], v[80:95]
    ds_write_b128 v4, v[46:49] offset:2048
    s_waitcnt lgkmcnt(3)
    v_mfma_f32_32x32x16_bf16 v[112:127], a[204:207], v[156:159], v[112:127]
    buffer_load_dwordx4 v[156:159], v44, s[20:23], s34 offen offset:3072 sc1
    s_waitcnt vmcnt(15) lgkmcnt(2)
    v_mfma_f32_32x32x16_bf16 v[64:79], a[192:195], v[224:227], v[64:79]
    ds_read_b128 a[200:203], v10 offset:17664
    ds_read_b128 a[204:207], v11 offset:17664
    s_waitcnt lgkmcnt(0)
    s_barrier
    v_mfma_f32_32x32x16_bf16 v[96:111], a[196:199], v[224:227], v[96:111]
    s_bitcmp1_b32 s37, 7
    s_cbranch_scc0 L_hspin07
L_hok07:
    s_add_u32 s34, s52, 57344
    s_and_b32 s34, s34, 0xffff
    buffer_load_dwordx4 v[224:227], v44, s[8:11], s34 offen offset:0 sc1
    s_waitcnt vmcnt(15)
    v_mfma_f32_32x32x16_bf16 v[80:95], a[192:195], v[228:231], v[80:95]
    v_lshlrev_b32 v4, 2, v2
    v_add_u32 v4, 157696, v4
    ds_read_b32 v46, v4 offset:2048
    ds_read_b32 v47, v4 offset:2304
    ds_read_b32 v48, v4 offset:2560
    v_mfma_f32_32x32x16_bf16 v[112:127], a[196:199], v[228:231], v[112:127]
    s_bitcmp1_b32 s42, 7
    s_cbranch_scc0 L_hspin17
L_hok17:
    buffer_load_dwordx4 v[228:231], v44, s[20:23], s34 offen offset:0 sc1
    s_waitcnt vmcnt(15)
    v_mfma_f32_32x32x16_bf16 v[64:79], a[200:203], v[232:235], v[64:79]
    ds_read_b128 a[192:195], v10 offset:25856
    ds_read_b128 a[196:199], v11 offset:25856
    ds_read_b32 v49, v4 offset:2816
    s_and_b32 s43, s3, 0xffff0000
    v_mfma_f32_32x32x16_bf16 v[96:111], a[204:207], v[232:235], v[96:111]
    buffer_load_dwordx4 v[232:235], v44, s[8:11], s34 offen offset:1024 sc1
    s_ashr_i32 s16, s43, 31
    s_not_b32 s16, s16
    s_waitcnt vmcnt(15)
    v_mfma_f32_32x32x16_bf16 v[80:95], a[200:203], v[236:239], v[80:95]
    s_or_b32 s16, s16, 0x80000000
    s_xor_b32 s43, s43, s16
    s_and_b32 s43, s43, 0xffff0000
    v_mov_b32 v30, s43
    v_mul_f32 v30, 0xbfb8aa3b, v30
    v_mfma_f32_32x32x16_bf16 v[112:127], a[204:207], v[236:239], v[112:127]
    buffer_load_dwordx4 v[236:239], v44, s[20:23], s34 offen offset:1024 sc1
    v_exp_f32 v30, v30
    s_waitcnt vmcnt(15) lgkmcnt(2)
    v_mfma_f32_32x32x16_bf16 v[64:79], a[192:195], v[240:243], v[64:79]
    ds_read_b128 a[200:203], v10 offset:34304
    ds_read_b128 a[204:207], v11 offset:34304
    v_lshlrev_b32 v29, 16, v29
    v_add_f32 v30, 1.0, v30
    s_waitcnt lgkmcnt(3)
    v_mfma_f32_32x32x16_bf16 v[96:111], a[196:199], v[240:243], v[96:111]
    buffer_load_dwordx4 v[240:243], v44, s[8:11], s34 offen offset:2048 sc1
    v_rcp_f32 v30, v30
    s_waitcnt vmcnt(15)
    v_mfma_f32_32x32x16_bf16 v[80:95], a[192:195], v[244:247], v[80:95]
    v_add_f32 v46, v46, v47
    s_waitcnt lgkmcnt(2)
    v_add_f32 v48, v48, v49
    v_cvt_pk_bf16_f32 v30, v30, v30
    v_lshlrev_b32 v30, 16, v30
    v_add_f32 v46, v46, v48
    v_mfma_f32_32x32x16_bf16 v[112:127], a[196:199], v[244:247], v[112:127]
    buffer_load_dwordx4 v[244:247], v44, s[20:23], s34 offen offset:2048 sc1
    v_cvt_pk_bf16_f32 v46, v46, v46
    v_lshlrev_b32 v46, 16, v46
    s_waitcnt vmcnt(15) lgkmcnt(1)
    v_mfma_f32_32x32x16_bf16 v[64:79], a[200:203], v[248:251], v[64:79]
    ds_read_b128 a[192:195], v10 offset:42496
    ds_read_b128 a[196:199], v11 offset:42496
    v_mul_f32 v46, v46, v30
    v_cvt_pk_bf16_f32 v46, v46, v46
    s_waitcnt lgkmcnt(2)
    v_mfma_f32_32x32x16_bf16 v[96:111], a[204:207], v[248:251], v[96:111]
    buffer_load_dwordx4 v[248:251], v44, s[8:11], s34 offen offset:3072 sc1
    v_lshlrev_b32 v46, 16, v46
    v_add_f32 v46, v46, v29
    s_waitcnt vmcnt(15)
    v_mfma_f32_32x32x16_bf16 v[80:95], a[200:203], v[252:255], v[80:95]
    v_cvt_pk_bf16_f32 v46, v46, v46
    v_lshlrev_b32 v46, 16, v46
    v_mul_f32 v30, 0xbfb8aa3b, v46
    v_exp_f32 v30, v30
    v_mfma_f32_32x32x16_bf16 v[112:127], a[204:207], v[252:255], v[112:127]
    buffer_load_dwordx4 v[252:255], v44, s[20:23], s34 offen offset:3072 sc1
    v_lshlrev_b32 v4, 1, v2
    v_add_f32 v30, 1.0, v30
    s_waitcnt vmcnt(15) lgkmcnt(1)
    v_mfma_f32_32x32x16_bf16 v[64:79], a[192:195], v[176:179], v[64:79]
    v_rcp_f32 v30, v30
    s_lshl_b32 s43, s32, 7
    v_mul_f32 v30, v30, v46
    v_cvt_pk_bf16_f32 v30, v30, v30
    s_waitcnt lgkmcnt(0)
    v_mfma_f32_32x32x16_bf16 v[96:111], a[196:199], v[176:179], v[96:111]
    s_add_u32 s34, s52, 61440
    s_and_b32 s34, s34, 0xffff
    buffer_load_dwordx4 v[176:179], v44, s[8:11], s34 offen offset:0 sc1
    s_waitcnt vmcnt(15)
    v_mfma_f32_32x32x16_bf16 v[80:95], a[192:195], v[180:183], v[80:95]
    s_add_u32 s43, s43, 160768
    v_add_u32 v4, s43, v4
    ds_write_b16 v4, v30
    s_and_b32 s17, s32, 1
    s_lshl_b32 s17, s17, 6
    v_mfma_f32_32x32x16_bf16 v[112:127], a[196:199], v[180:183], v[112:127]
    buffer_load_dwordx4 v[180:183], v44, s[20:23], s34 offen offset:0 sc1
    s_add_u32 s43, s43, s17
    v_lshrrev_b32 v4, 5, v2
    s_waitcnt vmcnt(15)
    v_mfma_f32_32x32x16_bf16 v[64:79], a[128:131], v[184:187], v[64:79]
    v_lshlrev_b32 v4, 4, v4
    v_add_u32 v4, s43, v4
    s_waitcnt lgkmcnt(0)
    ds_read_b128 v[50:53], v4
    ds_read_b128 v[46:49], v4 offset:32
    v_mfma_f32_32x32x16_bf16 v[96:111], a[132:135], v[184:187], v[96:111]
    buffer_load_dwordx4 v[184:187], v44, s[8:11], s34 offen offset:1024 sc1
    v_cmp_eq_u32 vcc, s4, v33
    s_waitcnt vmcnt(15)
    v_mfma_f32_32x32x16_bf16 v[80:95], a[128:131], v[188:191], v[80:95]
    s_nop 1
    s_waitcnt lgkmcnt(1)
    v_cndmask_b32 v54, v54, v50, vcc
    v_cndmask_b32 v55, v55, v51, vcc
    v_cndmask_b32 v56, v56, v52, vcc
    v_mfma_f32_32x32x16_bf16 v[112:127], a[132:135], v[188:191], v[112:127]
    buffer_load_dwordx4 v[188:191], v44, s[20:23], s34 offen offset:1024 sc1
    v_cndmask_b32 v57, v57, v53, vcc
    s_waitcnt vmcnt(15)
    v_mfma_f32_32x32x16_bf16 v[64:79], a[136:139], v[136:139], v[64:79]
    s_waitcnt lgkmcnt(0)
    v_cndmask_b32 v58, v58, v46, vcc
    v_cndmask_b32 v59, v59, v47, vcc
    v_cndmask_b32 v60, v60, v48, vcc
    v_cndmask_b32 v61, v61, v49, vcc
    v_mfma_f32_32x32x16_bf16 v[96:111], a[140:143], v[136:139], v[96:111]
    buffer_load_dwordx4 v[136:139], v44, s[8:11], s34 offen offset:2048 sc1
    s_waitcnt vmcnt(15)
    v_mfma_f32_32x32x16_bf16 v[80:95], a[136:139], v[140:143], v[80:95]
    v_mfma_f32_32x32x16_bf16 v[112:127], a[140:143], v[140:143], v[112:127]
    buffer_load_dwordx4 v[140:143], v44, s[20:23], s34 offen offset:2048 sc1
    v_and_b32 v209, s47, v54
    s_waitcnt vmcnt(15)
    v_mfma_f32_32x32x16_bf16 v[64:79], a[144:147], v[152:155], v[64:79]
    ds_read_b128 a[200:203], v12 offset:9984
    ds_read_b128 a[204:207], v13 offset:9984
    v_lshlrev_b32 v208, 16, v54
    v_mfma_f32_32x32x16_bf16 v[96:111], a[148:151], v[152:155], v[96:111]
    buffer_load_dwordx4 v[152:155], v44, s[8:11], s34 offen offset:3072 sc1
    v_and_b32 v193, s47, v16
    s_waitcnt vmcnt(15)
    v_mfma_f32_32x32x16_bf16 v[80:95], a[144:147], v[156:159], v[80:95]
    v_lshlrev_b32 v192, 16, v16
    v_and_b32 v211, s47, v55
    v_lshlrev_b32 v210, 16, v55
    v_and_b32 v195, s47, v17
    v_mfma_f32_32x32x16_bf16 v[112:127], a[148:151], v[156:159], v[112:127]
    buffer_load_dwordx4 v[156:159], v44, s[20:23], s34 offen offset:3072 sc1
    v_lshlrev_b32 v194, 16, v17
    s_waitcnt vmcnt(15) lgkmcnt(1)
    v_mfma_f32_32x32x16_bf16 v[64:79], a[200:203], v[224:227], v[64:79]
    ds_read_b128 a[192:195], v12 offset:18176
    ds_read_b128 a[196:199], v13 offset:18176
    v_and_b32 v213, s47, v56
    s_waitcnt lgkmcnt(2)
    v_mfma_f32_32x32x16_bf16 v[96:111], a[204:207], v[224:227], v[96:111]
    v_lshlrev_b32 v212, 16, v56
    v_and_b32 v197, s47, v18
    v_lshlrev_b32 v196, 16, v18
    v_and_b32 v215, s47, v57
    s_waitcnt vmcnt(14)
    v_mfma_f32_32x32x16_bf16 v[80:95], a[200:203], v[228:231], v[80:95]
    v_lshlrev_b32 v214, 16, v57
    v_and_b32 v199, s47, v19
    v_lshlrev_b32 v198, 16, v19
    v_and_b32 v217, s47, v58
    v_mfma_f32_32x32x16_bf16 v[112:127], a[204:207], v[228:231], v[112:127]
    v_lshlrev_b32 v216, 16, v58
    v_and_b32 v201, s47, v20
    v_lshlrev_b32 v200, 16, v20
    v_and_b32 v219, s47, v59
    s_waitcnt vmcnt(13) lgkmcnt(1)
    v_mfma_f32_32x32x16_bf16 v[64:79], a[192:195], v[232:235], v[64:79]
    ds_read_b128 a[200:203], v10 offset:50944
    ds_read_b128 a[204:207], v11 offset:50944
    v_lshlrev_b32 v218, 16, v59
    s_waitcnt lgkmcnt(2)
    v_mfma_f32_32x32x16_bf16 v[96:111], a[196:199], v[232:235], v[96:111]
    v_and_b32 v203, s47, v21
    v_lshlrev_b32 v202, 16, v21
    v_and_b32 v221, s47, v60
    v_lshlrev_b32 v220, 16, v60
    s_waitcnt vmcnt(12)
    v_mfma_f32_32x32x16_bf16 v[80:95], a[192:195], v[236:239], v[80:95]
    v_and_b32 v205, s47, v22
    v_lshlrev_b32 v204, 16, v22
    v_and_b32 v223, s47, v61
    v_lshlrev_b32 v222, 16, v61
    v_mfma_f32_32x32x16_bf16 v[112:127], a[196:199], v[236:239], v[112:127]
    v_and_b32 v207, s47, v23
    v_lshlrev_b32 v206, 16, v23
    s_waitcnt vmcnt(11) lgkmcnt(1)
    v_mfma_f32_32x32x16_bf16 v[64:79], a[200:203], v[240:243], v[64:79]
    ds_read_b128 a[192:195], v10 offset:59136
    ds_read_b128 a[196:199], v11 offset:59136
    s_waitcnt lgkmcnt(2)
    v_mfma_f32_32x32x16_bf16 v[96:111], a[204:207], v[240:243], v[96:111]
    s_waitcnt vmcnt(10)
    v_mfma_f32_32x32x16_bf16 v[80:95], a[200:203], v[244:247], v[80:95]
    v_mfma_f32_32x32x16_bf16 v[112:127], a[204:207], v[244:247], v[112:127]
    s_or_b32 s16, s32, 1
    s_and_b32 s16, s16, 3
    s_xor_b32 s18, s16, 2
    s_waitcnt vmcnt(9) lgkmcnt(1)
    v_mfma_f32_32x32x16_bf16 v[64:79], a[192:195], v[248:251], v[64:79]
    ds_read_b128 a[200:203], v12 offset:1792
    ds_read_b128 a[204:207], v13 offset:1792
    s_xor_b32 s17, s32, s16
    s_lshr_b32 s19, s17, 1
    s_add_u32 s17, s17, s19
    s_mul_i32 s17, s17, 16640
    s_waitcnt lgkmcnt(2)
    v_mfma_f32_32x32x16_bf16 v[96:111], a[196:199], v[248:251], v[96:111]
    s_lshl_b32 s19, s16, 12
    s_add_u32 s17, s17, s19
    s_sub_u32 s17, s17, 4096
    v_add_u32 v13, s17, v44
    s_waitcnt vmcnt(8)
    v_mfma_f32_32x32x16_bf16 v[80:95], a[192:195], v[252:255], v[80:95]
    s_xor_b32 s17, s32, s18
    s_lshr_b32 s19, s17, 1
    s_add_u32 s17, s17, s19
    s_mul_i32 s17, s17, 16640
    v_mfma_f32_32x32x16_bf16 v[112:127], a[196:199], v[252:255], v[112:127]
    s_lshl_b32 s19, s18, 12
    s_add_u32 s17, s17, s19
    s_sub_u32 s17, s17, 4096
    v_add_u32 v15, s17, v44
    s_waitcnt vmcnt(7) lgkmcnt(1)
    v_mfma_f32_32x32x16_bf16 v[64:79], a[200:203], v[176:179], v[64:79]
    s_xor_b32 s17, s32, 2
    s_lshr_b32 s19, s17, 1
    s_add_u32 s17, s17, s19
    s_mul_i32 s17, s17, 16640
    s_waitcnt lgkmcnt(0)
    v_mfma_f32_32x32x16_bf16 v[96:111], a[204:207], v[176:179], v[96:111]
    s_add_u32 s17, s17, 4096
    v_add_u32 v14, s17, v44
    s_waitcnt vmcnt(6)
    v_mfma_f32_32x32x16_bf16 v[80:95], a[200:203], v[180:183], v[80:95]
    v_mfma_f32_32x32x16_bf16 v[112:127], a[204:207], v[180:183], v[112:127]
    s_waitcnt vmcnt(4)
    v_mfma_f32_32x32x16_bf16 v[112:127], a[236:239], v[188:191], v[112:127]
    s_waitcnt vmcnt(2)
    v_mfma_f32_32x32x16_bf16 v[112:127], a[244:247], v[140:143], v[112:127]
    s_waitcnt vmcnt(0)
    v_mfma_f32_32x32x16_bf16 v[112:127], a[252:255], v[156:159], v[112:127]
    v_mfma_f32_32x32x16_bf16 v[96:111], a[236:239], v[184:187], v[96:111]
    v_mfma_f32_32x32x16_bf16 v[96:111], a[244:247], v[136:139], v[96:111]
    v_mfma_f32_32x32x16_bf16 v[96:111], a[252:255], v[152:155], v[96:111]
    s_nop 8
    ds_write_b128 v15, v[112:115] offset:0
    ds_write_b128 v15, v[116:119] offset:1024
    ds_write_b128 v15, v[120:123] offset:2048
    ds_write_b128 v15, v[124:127] offset:3072
    v_mfma_f32_32x32x16_bf16 v[80:95], a[232:235], v[188:191], v[80:95]
    v_mfma_f32_32x32x16_bf16 v[80:95], a[240:243], v[140:143], v[80:95]
    v_mfma_f32_32x32x16_bf16 v[80:95], a[248:251], v[156:159], v[80:95]
    ds_write_b128 v13, v[96:99] offset:0
    ds_write_b128 v13, v[100:103] offset:1024
    ds_write_b128 v13, v[104:107] offset:2048
    ds_write_b128 v13, v[108:111] offset:3072
    v_mfma_f32_32x32x16_bf16 v[64:79], a[232:235], v[184:187], v[64:79]
    v_mfma_f32_32x32x16_bf16 v[64:79], a[240:243], v[136:139], v[64:79]
    v_mfma_f32_32x32x16_bf16 v[64:79], a[248:251], v[152:155], v[64:79]
    s_cmp_lt_u32 s32, 2
    s_cbranch_scc0 L_nw2
    s_nop 2
    ds_write_b128 v14, v[80:83] offset:0
    ds_write_b128 v14, v[84:87] offset:1024
    ds_write_b128 v14, v[88:91] offset:2048
    ds_write_b128 v14, v[92:95] offset:3072
L_nw2:
    s_cmp_lt_u32 s32, 2
    s_cselect_b64 s[18:19], 0, -1
    s_cbranch_scc1 L_nw0
    ds_write_b128 v14, v[64:67] offset:0
    ds_write_b128 v14, v[68:71] offset:1024
    ds_write_b128 v14, v[72:75] offset:2048
    s_waitcnt lgkmcnt(14)
    ds_write_b128 v14, v[76:79] offset:3072
L_nw0:
    s_mov_b32 s17, s32
    s_lshr_b32 s16, s17, 1
    s_add_u32 s17, s17, s16
    s_mul_i32 s17, s17, 16640
    v_add_u32 v4, s17, v44
    s_waitcnt lgkmcnt(0)
    s_barrier
    ds_read_b128 v[128:131], v4 offset:0
    ds_read_b128 v[132:135], v4 offset:1024
    ds_read_b128 v[136:139], v4 offset:2048
    ds_read_b128 v[140:143], v4 offset:3072
    ds_read_b128 v[144:147], v4 offset:4096
    ds_read_b128 v[148:151], v4 offset:5120
    ds_read_b128 v[152:155], v4 offset:6144
    ds_read_b128 v[156:159], v4 offset:7168
    ds_read_b128 v[160:163], v4 offset:8192
    ds_read_b128 v[164:167], v4 offset:9216
    ds_read_b128 v[168:171], v4 offset:10240
    ds_read_b128 v[172:175], v4 offset:11264
    v_cndmask_b32 v64, v64, v80, s[18:19]
    v_cndmask_b32 v65, v65, v81, s[18:19]
    v_cndmask_b32 v66, v66, v82, s[18:19]
    v_cndmask_b32 v67, v67, v83, s[18:19]
    v_cndmask_b32 v68, v68, v84, s[18:19]
    v_cndmask_b32 v69, v69, v85, s[18:19]
    v_cndmask_b32 v70, v70, v86, s[18:19]
    v_cndmask_b32 v71, v71, v87, s[18:19]
    v_cndmask_b32 v72, v72, v88, s[18:19]
    v_cndmask_b32 v73, v73, v89, s[18:19]
    v_cndmask_b32 v74, v74, v90, s[18:19]
    v_cndmask_b32 v75, v75, v91, s[18:19]
    v_cndmask_b32 v76, v76, v92, s[18:19]
    v_cndmask_b32 v77, v77, v93, s[18:19]
    v_cndmask_b32 v78, v78, v94, s[18:19]
    v_cndmask_b32 v79, v79, v95, s[18:19]
    s_waitcnt lgkmcnt(8)
    v_pk_add_f32 v[128:129], v[128:129], v[64:65]
    v_pk_add_f32 v[130:131], v[130:131], v[66:67]
    v_pk_add_f32 v[132:133], v[132:133], v[68:69]
    v_pk_add_f32 v[134:135], v[134:135], v[70:71]
    v_pk_add_f32 v[136:137], v[136:137], v[72:73]
    v_pk_add_f32 v[138:139], v[138:139], v[74:75]
    v_pk_add_f32 v[140:141], v[140:141], v[76:77]
    v_pk_add_f32 v[142:143], v[142:143], v[78:79]
    s_waitcnt lgkmcnt(0)
    v_pk_add_f32 v[144:145], v[144:145], v[160:161]
    v_pk_add_f32 v[146:147], v[146:147], v[162:163]
    v_pk_add_f32 v[148:149], v[148:149], v[164:165]
    v_pk_add_f32 v[150:151], v[150:151], v[166:167]
    v_pk_add_f32 v[152:153], v[152:153], v[168:169]
    v_pk_add_f32 v[154:155], v[154:155], v[170:171]
    v_pk_add_f32 v[156:157], v[156:157], v[172:173]
    v_pk_add_f32 v[158:159], v[158:159], v[174:175]
    v_pk_add_f32 v[128:129], v[128:129], v[144:145]
    v_pk_add_f32 v[130:131], v[130:131], v[146:147]
    v_pk_add_f32 v[132:133], v[132:133], v[148:149]
    v_pk_add_f32 v[134:135], v[134:135], v[150:151]
    v_pk_add_f32 v[136:137], v[136:137], v[152:153]
    v_pk_add_f32 v[138:139], v[138:139], v[154:155]
    v_pk_add_f32 v[140:141], v[140:141], v[156:157]
    v_pk_add_f32 v[142:143], v[142:143], v[158:159]
    v_cvt_pk_bf16_f32 v128, v128, v129
    v_cvt_pk_bf16_f32 v130, v130, v131
    v_cvt_pk_bf16_f32 v132, v132, v133
    v_cvt_pk_bf16_f32 v134, v134, v135
    v_cvt_pk_bf16_f32 v136, v136, v137
    v_cvt_pk_bf16_f32 v138, v138, v139
    v_cvt_pk_bf16_f32 v140, v140, v141
    v_cvt_pk_bf16_f32 v142, v142, v143
    v_and_b32 v129, s47, v128
    v_lshlrev_b32 v128, 16, v128
    v_and_b32 v131, s47, v130
    v_lshlrev_b32 v130, 16, v130
    v_and_b32 v133, s47, v132
    v_lshlrev_b32 v132, 16, v132
    v_and_b32 v135, s47, v134
    v_lshlrev_b32 v134, 16, v134
    v_and_b32 v137, s47, v136
    v_lshlrev_b32 v136, 16, v136
    v_and_b32 v139, s47, v138
    v_lshlrev_b32 v138, 16, v138
    v_and_b32 v141, s47, v140
    v_lshlrev_b32 v140, 16, v140
    v_and_b32 v143, s47, v142
    v_lshlrev_b32 v142, 16, v142
    v_pk_mul_f32 v[208:209], v[208:209], v[128:129]
    v_pk_mul_f32 v[210:211], v[210:211], v[130:131]
    v_pk_mul_f32 v[212:213], v[212:213], v[132:133]
    v_pk_mul_f32 v[214:215], v[214:215], v[134:135]
    v_pk_mul_f32 v[216:217], v[216:217], v[136:137]
    v_pk_mul_f32 v[218:219], v[218:219], v[138:139]
    v_pk_mul_f32 v[220:221], v[220:221], v[140:141]
    v_pk_mul_f32 v[222:223], v[222:223], v[142:143]
    v_cvt_pk_bf16_f32 v208, v208, v209
    v_cvt_pk_bf16_f32 v210, v210, v211
    v_cvt_pk_bf16_f32 v212, v212, v213
    v_cvt_pk_bf16_f32 v214, v214, v215
    v_cvt_pk_bf16_f32 v216, v216, v217
    v_cvt_pk_bf16_f32 v218, v218, v219
    v_cvt_pk_bf16_f32 v220, v220, v221
    v_cvt_pk_bf16_f32 v222, v222, v223
    v_and_b32 v209, s47, v208
    v_lshlrev_b32 v208, 16, v208
    v_and_b32 v211, s47, v210
    v_lshlrev_b32 v210, 16, v210
    v_and_b32 v213, s47, v212
    v_lshlrev_b32 v212, 16, v212
    v_and_b32 v215, s47, v214
    v_lshlrev_b32 v214, 16, v214
    v_and_b32 v217, s47, v216
    v_lshlrev_b32 v216, 16, v216
    v_and_b32 v219, s47, v218
    v_lshlrev_b32 v218, 16, v218
    v_and_b32 v221, s47, v220
    v_lshlrev_b32 v220, 16, v220
    v_and_b32 v223, s47, v222
    v_lshlrev_b32 v222, 16, v222
    v_pk_add_f32 v[208:209], v[208:209], v[192:193]
    v_pk_add_f32 v[210:211], v[210:211], v[194:195]
    v_pk_add_f32 v[212:213], v[212:213], v[196:197]
    v_pk_add_f32 v[214:215], v[214:215], v[198:199]
    v_pk_add_f32 v[216:217], v[216:217], v[200:201]
    v_pk_add_f32 v[218:219], v[218:219], v[202:203]
    v_pk_add_f32 v[220:221], v[220:221], v[204:205]
    v_pk_add_f32 v[222:223], v[222:223], v[206:207]
    v_cvt_pk_bf16_f32 v128, v208, v209
    v_cvt_pk_bf16_f32 v129, v210, v211
    v_cvt_pk_bf16_f32 v130, v212, v213
    v_cvt_pk_bf16_f32 v131, v214, v215
    buffer_store_dwordx4 v[128:131], v32, s[92:95], s49 offen offset:0
    v_cvt_pk_bf16_f32 v132, v216, v217
    v_cvt_pk_bf16_f32 v133, v218, v219
    v_cvt_pk_bf16_f32 v134, v220, v221
    v_cvt_pk_bf16_f32 v135, v222, v223
    buffer_store_dwordx4 v[132:135], v32, s[92:95], s49 offen offset:32
L_end:
    s_endpgm
L_spin0:
    s_mov_b32 s62, 0x8000
L_spinl0:
    s_sleep 4
    buffer_load_dword v5, v50, s[72:75], 0 offen sc1
    s_waitcnt vmcnt(0)
    v_and_b32 v5, s49, v5
    v_cmp_ne_u32 vcc, s49, v5
    s_cbranch_vccz L_ok0
    s_sub_u32 s62, s62, 1
    s_cmp_lg_u32 s62, 0
    s_cbranch_scc1 L_spinl0
    s_branch L_ok0

L_spin1:
    s_mov_b32 s62, 0x8000
L_spinl1:
    s_sleep 4
    buffer_load_dword v5, v27, s[72:75], 0 offen sc1
    s_waitcnt vmcnt(0)
    v_and_b32 v5, s49, v5
    v_cmp_ne_u32 vcc, s49, v5
    s_cbranch_vccz L_ok1
    s_sub_u32 s62, s62, 1
    s_cmp_lg_u32 s62, 0
    s_cbranch_scc1 L_spinl1
    s_branch L_ok1

L_stub0:
    s_call_b64 s[60:61], L_rare10
    s_call_b64 s[60:61], L_rare11
    s_branch L_back0

L_stub1:
    s_call_b64 s[60:61], L_rare00
    s_call_b64 s[60:61], L_rare01
    s_branch L_back1

L_stub2:
    s_call_b64 s[60:61], L_rare10
    s_call_b64 s[60:61], L_rare11
    s_branch L_back2

L_stub3:
    s_call_b64 s[60:61], L_rare00
    s_call_b64 s[60:61], L_rare01
    s_branch L_back3

L_stub4:
    s_call_b64 s[60:61], L_rare10
    s_call_b64 s[60:61], L_rare11
    s_branch L_back4

L_stub5:
    s_call_b64 s[60:61], L_rare00
    s_call_b64 s[60:61], L_rare01
    s_branch L_back5

L_stub6:
    s_call_b64 s[60:61], L_rare10
    s_call_b64 s[60:61], L_rare11
    s_branch L_back6

L_stub7:
    s_call_b64 s[60:61], L_rare00
    s_call_b64 s[60:61], L_rare01
    s_branch L_back7

L_stub8:
    s_call_b64 s[60:61], L_rare10
    s_branch L_back8

L_stub9:
    s_call_b64 s[60:61], L_rare00
    s_branch L_back9

L_stub10:
    s_call_b64 s[60:61], L_rare10
    s_branch L_back10

L_stub11:
    s_call_b64 s[60:61], L_rare00
    s_branch L_back11

L_stub12:
    s_call_b64 s[60:61], L_rare10
    s_branch L_back12

L_stub13:
    s_call_b64 s[60:61], L_rare00
    s_branch L_back13

L_stub14:
    s_call_b64 s[60:61], L_rare10
    s_branch L_back14

L_stub15:
    s_call_b64 s[60:61], L_rare11
    s_branch L_back15

L_stub16:
    s_call_b64 s[60:61], L_rare01
    s_branch L_back16

L_stub17:
    s_call_b64 s[60:61], L_rare11
    s_branch L_back17

L_stub18:
    s_call_b64 s[60:61], L_rare01
    s_branch L_back18

L_stub19:
    s_call_b64 s[60:61], L_rare11
    s_branch L_back19

L_stub20:
    s_call_b64 s[60:61], L_rare01
    s_branch L_back20

L_stub21:
    s_call_b64 s[60:61], L_rare11
    s_branch L_back21

L_hspin00:
    s_mov_b32 s62, 0x8000
L_hspinl00:
    buffer_load_dword v5, v31, s[28:31], s41 offen offset:0 sc1
    s_waitcnt vmcnt(0)
    v_cmp_ne_u32 vcc, 0, v5
    s_nop 0
    s_mov_b32 s37, vcc_lo
    s_bitcmp1_b32 s37, 0
    s_cbranch_scc1 L_hok00
    s_sleep 1
    s_sub_u32 s62, s62, 1
    s_cmp_lg_u32 s62, 0
    s_cbranch_scc1 L_hspinl00
    s_branch L_hok00

L_hspin01:
    s_mov_b32 s62, 0x8000
L_hspinl01:
    buffer_load_dword v5, v31, s[28:31], s41 offen offset:0 sc1
    s_waitcnt vmcnt(0)
    v_cmp_ne_u32 vcc, 0, v5
    s_nop 0
    s_mov_b32 s37, vcc_lo
    s_bitcmp1_b32 s37, 1
    s_cbranch_scc1 L_hok01
    s_sleep 1
    s_sub_u32 s62, s62, 1
    s_cmp_lg_u32 s62, 0
    s_cbranch_scc1 L_hspinl01
    s_branch L_hok01

L_hspin02:
    s_mov_b32 s62, 0x8000
L_hspinl02:
    buffer_load_dword v5, v31, s[28:31], s41 offen offset:0 sc1
    s_waitcnt vmcnt(0)
    v_cmp_ne_u32 vcc, 0, v5
    s_nop 0
    s_mov_b32 s37, vcc_lo
    s_bitcmp1_b32 s37, 2
    s_cbranch_scc1 L_hok02
    s_sleep 1
    s_sub_u32 s62, s62, 1
    s_cmp_lg_u32 s62, 0
    s_cbranch_scc1 L_hspinl02
    s_branch L_hok02

L_hspin03:
    s_mov_b32 s62, 0x8000
L_hspinl03:
    buffer_load_dword v5, v31, s[28:31], s41 offen offset:0 sc1
    s_waitcnt vmcnt(0)
    v_cmp_ne_u32 vcc, 0, v5
    s_nop 0
    s_mov_b32 s37, vcc_lo
    s_bitcmp1_b32 s37, 3
    s_cbranch_scc1 L_hok03
    s_sleep 1
    s_sub_u32 s62, s62, 1
    s_cmp_lg_u32 s62, 0
    s_cbranch_scc1 L_hspinl03
    s_branch L_hok03

L_hspin04:
    s_mov_b32 s62, 0x8000
L_hspinl04:
    buffer_load_dword v5, v31, s[28:31], s41 offen offset:0 sc1
    s_waitcnt vmcnt(0)
    v_cmp_ne_u32 vcc, 0, v5
    s_nop 0
    s_mov_b32 s37, vcc_lo
    s_bitcmp1_b32 s37, 4
    s_cbranch_scc1 L_hok04
    s_sleep 1
    s_sub_u32 s62, s62, 1
    s_cmp_lg_u32 s62, 0
    s_cbranch_scc1 L_hspinl04
    s_branch L_hok04

L_hspin05:
    s_mov_b32 s62, 0x8000
L_hspinl05:
    buffer_load_dword v5, v31, s[28:31], s41 offen offset:0 sc1
    s_waitcnt vmcnt(0)
    v_cmp_ne_u32 vcc, 0, v5
    s_nop 0
    s_mov_b32 s37, vcc_lo
    s_bitcmp1_b32 s37, 5
    s_cbranch_scc1 L_hok05
    s_sleep 1
    s_sub_u32 s62, s62, 1
    s_cmp_lg_u32 s62, 0
    s_cbranch_scc1 L_hspinl05
    s_branch L_hok05

L_hspin10:
    s_mov_b32 s62, 0x8000
L_hspinl10:
    buffer_load_dword v5, v31, s[28:31], s41 offen offset:128 sc1
    s_waitcnt vmcnt(0)
    v_cmp_ne_u32 vcc, 0, v5
    s_nop 0
    s_mov_b32 s42, vcc_lo
    s_bitcmp1_b32 s42, 0
    s_cbranch_scc1 L_hok10
    s_sleep 1
    s_sub_u32 s62, s62, 1
    s_cmp_lg_u32 s62, 0
    s_cbranch_scc1 L_hspinl10
    s_branch L_hok10

L_hspin11:
    s_mov_b32 s62, 0x8000
L_hspinl11:
    buffer_load_dword v5, v31, s[28:31], s41 offen offset:128 sc1
    s_waitcnt vmcnt(0)
    v_cmp_ne_u32 vcc, 0, v5
    s_nop 0
    s_mov_b32 s42, vcc_lo
    s_bitcmp1_b32 s42, 1
    s_cbranch_scc1 L_hok11
    s_sleep 1
    s_sub_u32 s62, s62, 1
    s_cmp_lg_u32 s62, 0
    s_cbranch_scc1 L_hspinl11
    s_branch L_hok11

L_hspin12:
    s_mov_b32 s62, 0x8000
L_hspinl12:
    buffer_load_dword v5, v31, s[28:31], s41 offen offset:128 sc1
    s_waitcnt vmcnt(0)
    v_cmp_ne_u32 vcc, 0, v5
    s_nop 0
    s_mov_b32 s42, vcc_lo
    s_bitcmp1_b32 s42, 2
    s_cbranch_scc1 L_hok12
    s_sleep 1
    s_sub_u32 s62, s62, 1
    s_cmp_lg_u32 s62, 0
    s_cbranch_scc1 L_hspinl12
    s_branch L_hok12

L_hspin13:
    s_mov_b32 s62, 0x8000
L_hspinl13:
    buffer_load_dword v5, v31, s[28:31], s41 offen offset:128 sc1
    s_waitcnt vmcnt(0)
    v_cmp_ne_u32 vcc, 0, v5
    s_nop 0
    s_mov_b32 s42, vcc_lo
    s_bitcmp1_b32 s42, 3
    s_cbranch_scc1 L_hok13
    s_sleep 1
    s_sub_u32 s62, s62, 1
    s_cmp_lg_u32 s62, 0
    s_cbranch_scc1 L_hspinl13
    s_branch L_hok13

L_hspin14:
    s_mov_b32 s62, 0x8000
L_hspinl14:
    buffer_load_dword v5, v31, s[28:31], s41 offen offset:128 sc1
    s_waitcnt vmcnt(0)
    v_cmp_ne_u32 vcc, 0, v5
    s_nop 0
    s_mov_b32 s42, vcc_lo
    s_bitcmp1_b32 s42, 4
    s_cbranch_scc1 L_hok14
    s_sleep 1
    s_sub_u32 s62, s62, 1
    s_cmp_lg_u32 s62, 0
    s_cbranch_scc1 L_hspinl14
    s_branch L_hok14

L_hspin15:
    s_mov_b32 s62, 0x8000
L_hspinl15:
    buffer_load_dword v5, v31, s[28:31], s41 offen offset:128 sc1
    s_waitcnt vmcnt(0)
    v_cmp_ne_u32 vcc, 0, v5
    s_nop 0
    s_mov_b32 s42, vcc_lo
    s_bitcmp1_b32 s42, 5
    s_cbranch_scc1 L_hok15
    s_sleep 1
    s_sub_u32 s62, s62, 1
    s_cmp_lg_u32 s62, 0
    s_cbranch_scc1 L_hspinl15
    s_branch L_hok15

L_hspin06:
    s_mov_b32 s62, 0x8000
L_hspinl06:
    buffer_load_dword v5, v31, s[28:31], s41 offen offset:0 sc1
    s_waitcnt vmcnt(0)
    v_cmp_ne_u32 vcc, 0, v5
    s_nop 0
    s_mov_b32 s37, vcc_lo
    s_bitcmp1_b32 s37, 6
    s_cbranch_scc1 L_hok06
    s_sleep 1
    s_sub_u32 s62, s62, 1
    s_cmp_lg_u32 s62, 0
    s_cbranch_scc1 L_hspinl06
    s_branch L_hok06

L_hspin16:
    s_mov_b32 s62, 0x8000
L_hspinl16:
    buffer_load_dword v5, v31, s[28:31], s41 offen offset:128 sc1
    s_waitcnt vmcnt(0)
    v_cmp_ne_u32 vcc, 0, v5
    s_nop 0
    s_mov_b32 s42, vcc_lo
    s_bitcmp1_b32 s42, 6
    s_cbranch_scc1 L_hok16
    s_sleep 1
    s_sub_u32 s62, s62, 1
    s_cmp_lg_u32 s62, 0
    s_cbranch_scc1 L_hspinl16
    s_branch L_hok16

L_hspin07:
    s_mov_b32 s62, 0x8000
L_hspinl07:
    buffer_load_dword v5, v31, s[28:31], s41 offen offset:0 sc1
    s_waitcnt vmcnt(0)
    v_cmp_ne_u32 vcc, 0, v5
    s_nop 0
    s_mov_b32 s37, vcc_lo
    s_bitcmp1_b32 s37, 7
    s_cbranch_scc1 L_hok07
    s_sleep 1
    s_sub_u32 s62, s62, 1
    s_cmp_lg_u32 s62, 0
    s_cbranch_scc1 L_hspinl07
    s_branch L_hok07

L_hspin17:
    s_mov_b32 s62, 0x8000
L_hspinl17:
    buffer_load_dword v5, v31, s[28:31], s41 offen offset:128 sc1
    s_waitcnt vmcnt(0)
    v_cmp_ne_u32 vcc, 0, v5
    s_nop 0
    s_mov_b32 s42, vcc_lo
    s_bitcmp1_b32 s42, 7
    s_cbranch_scc1 L_hok17
    s_sleep 1
    s_sub_u32 s62, s62, 1
    s_cmp_lg_u32 s62, 0
    s_cbranch_scc1 L_hspinl17
    s_branch L_hok17

L_yspin:
    s_mov_b32 s62, 0x8000
L_yspinl:
    buffer_load_dwordx4 v[50:53], v44, s[28:31], s41 offen offset:256 sc1
    s_waitcnt vmcnt(0)
    v_and_b32 v50, v50, v51
    v_and_b32 v52, v52, v53
    v_and_b32 v50, v50, v52
    v_cmp_eq_u32 vcc, 0, v50
    s_nop 1
    s_and_b64 vcc, vcc, s[18:19]
    s_cbranch_scc0 L_yok
    s_sleep 2
    s_sub_u32 s62, s62, 1
    s_cmp_lg_u32 s62, 0
    s_cbranch_scc1 L_yspinl
    s_branch L_yok

L_yld:
    buffer_load_dwordx4 a[152:155], v4, s[28:31], s16 offen sc1
    s_add_u32 s16, s16, 32768
    buffer_load_dwordx4 a[156:159], v4, s[28:31], s16 offen sc1
    s_add_u32 s16, s16, 32768
    buffer_load_dwordx4 a[160:163], v4, s[28:31], s16 offen sc1
    s_add_u32 s16, s16, 32768
    buffer_load_dwordx4 a[164:167], v4, s[28:31], s16 offen sc1
    s_add_u32 s16, s16, 32768
    buffer_load_dwordx4 a[168:171], v4, s[28:31], s16 offen sc1
    s_add_u32 s16, s16, 32768
    buffer_load_dwordx4 a[172:175], v4, s[28:31], s16 offen sc1
    s_add_u32 s16, s16, 32768
    buffer_load_dwordx4 a[176:179], v4, s[28:31], s16 offen sc1
    s_add_u32 s16, s16, 32768
    buffer_load_dwordx4 a[180:183], v4, s[28:31], s16 offen sc1
    s_add_u32 s16, s16, 32768
    buffer_load_dwordx4 a[184:187], v4, s[28:31], s16 offen sc1
    s_add_u32 s16, s16, 32768
    buffer_load_dwordx4 a[188:191], v4, s[28:31], s16 offen sc1
    s_add_u32 s16, s16, 32768
    buffer_load_dwordx4 a[224:227], v4, s[28:31], s16 offen sc1
    s_add_u32 s16, s16, 32768
    s_branch L_yldb

L_rare00:
    s_nop 15
    v_max3_f32 v62, v64, v65, 0
    v_max3_f32 v62, v66, v67, v62
    v_max3_f32 v62, v68, v69, v62
    v_max3_f32 v62, v70, v71, v62
    v_max3_f32 v62, v72, v73, v62
    v_max3_f32 v62, v74, v75, v62
    v_max3_f32 v62, v76, v77, v62
    v_max3_f32 v62, v78, v79, v62
    v_mov_b32 v63, v62
    s_nop 1
    v_permlane32_swap_b32 v62, v63
    v_max_f32 v62, v62, v63
    v_exp_f32 v63, -v62
    v_sub_f32 v64, v64, v62
    v_sub_f32 v96, v96, v62
    v_sub_f32 v160, v160, v62
    v_sub_f32 v65, v65, v62
    v_sub_f32 v97, v97, v62
    v_sub_f32 v161, v161, v62
    v_sub_f32 v66, v66, v62
    v_sub_f32 v98, v98, v62
    v_sub_f32 v162, v162, v62
    v_sub_f32 v67, v67, v62
    v_sub_f32 v99, v99, v62
    v_sub_f32 v163, v163, v62
    v_sub_f32 v68, v68, v62
    v_sub_f32 v100, v100, v62
    v_sub_f32 v164, v164, v62
    v_sub_f32 v69, v69, v62
    v_sub_f32 v101, v101, v62
    v_sub_f32 v165, v165, v62
    v_sub_f32 v70, v70, v62
    v_sub_f32 v102, v102, v62
    v_sub_f32 v166, v166, v62
    v_sub_f32 v71, v71, v62
    v_sub_f32 v103, v103, v62
    v_sub_f32 v167, v167, v62
    v_sub_f32 v72, v72, v62
    v_sub_f32 v104, v104, v62
    v_sub_f32 v168, v168, v62
    v_sub_f32 v73, v73, v62
    v_sub_f32 v105, v105, v62
    v_sub_f32 v169, v169, v62
    v_sub_f32 v74, v74, v62
    v_sub_f32 v106, v106, v62
    v_sub_f32 v170, v170, v62
    v_sub_f32 v75, v75, v62
    v_sub_f32 v107, v107, v62
    v_sub_f32 v171, v171, v62
    v_sub_f32 v76, v76, v62
    v_sub_f32 v108, v108, v62
    v_sub_f32 v172, v172, v62
    v_sub_f32 v77, v77, v62
    v_sub_f32 v109, v109, v62
    v_sub_f32 v173, v173, v62
    v_sub_f32 v78, v78, v62
    v_sub_f32 v110, v110, v62
    v_sub_f32 v174, v174, v62
    v_sub_f32 v79, v79, v62
    v_sub_f32 v111, v111, v62
    v_sub_f32 v175, v175, v62
    v_mul_f32 v45, v45, v63
    v_accvgpr_read_b32 v54, a0
    v_mul_f32 v54, v54, v63
    v_accvgpr_write_b32 a0, v54
    v_accvgpr_read_b32 v55, a1
    v_mul_f32 v55, v55, v63
    v_accvgpr_write_b32 a1, v55
    v_accvgpr_read_b32 v56, a2
    v_mul_f32 v56, v56, v63
    v_accvgpr_write_b32 a2, v56
    v_accvgpr_read_b32 v57, a3
    v_mul_f32 v57, v57, v63
    v_accvgpr_write_b32 a3, v57
    v_accvgpr_read_b32 v54, a4
    v_mul_f32 v54, v54, v63
    v_accvgpr_write_b32 a4, v54
    v_accvgpr_read_b32 v55, a5
    v_mul_f32 v55, v55, v63
    v_accvgpr_write_b32 a5, v55
    v_accvgpr_read_b32 v56, a6
    v_mul_f32 v56, v56, v63
    v_accvgpr_write_b32 a6, v56
    v_accvgpr_read_b32 v57, a7
    v_mul_f32 v57, v57, v63
    v_accvgpr_write_b32 a7, v57
    v_accvgpr_read_b32 v54, a8
    v_mul_f32 v54, v54, v63
    v_accvgpr_write_b32 a8, v54
    v_accvgpr_read_b32 v55, a9
    v_mul_f32 v55, v55, v63
    v_accvgpr_write_b32 a9, v55
    v_accvgpr_read_b32 v56, a10
    v_mul_f32 v56, v56, v63
    v_accvgpr_write_b32 a10, v56
    v_accvgpr_read_b32 v57, a11
    v_mul_f32 v57, v57, v63
    v_accvgpr_write_b32 a11, v57
    v_accvgpr_read_b32 v54, a12
    v_mul_f32 v54, v54, v63
    v_accvgpr_write_b32 a12, v54
    v_accvgpr_read_b32 v55, a13
    v_mul_f32 v55, v55, v63
    v_accvgpr_write_b32 a13, v55
    v_accvgpr_read_b32 v56, a14
    v_mul_f32 v56, v56, v63
    v_accvgpr_write_b32 a14, v56
    v_accvgpr_read_b32 v57, a15
    v_mul_f32 v57, v57, v63
    v_accvgpr_write_b32 a15, v57
    v_accvgpr_read_b32 v54, a16
    v_mul_f32 v54, v54, v63
    v_accvgpr_write_b32 a16, v54
    v_accvgpr_read_b32 v55, a17
    v_mul_f32 v55, v55, v63
    v_accvgpr_write_b32 a17, v55
    v_accvgpr_read_b32 v56, a18
    v_mul_f32 v56, v56, v63
    v_accvgpr_write_b32 a18, v56
    v_accvgpr_read_b32 v57, a19
    v_mul_f32 v57, v57, v63
    v_accvgpr_write_b32 a19, v57
    v_accvgpr_read_b32 v54, a20
    v_mul_f32 v54, v54, v63
    v_accvgpr_write_b32 a20, v54
    v_accvgpr_read_b32 v55, a21
    v_mul_f32 v55, v55, v63
    v_accvgpr_write_b32 a21, v55
    v_accvgpr_read_b32 v56, a22
    v_mul_f32 v56, v56, v63
    v_accvgpr_write_b32 a22, v56
    v_accvgpr_read_b32 v57, a23
    v_mul_f32 v57, v57, v63
    v_accvgpr_write_b32 a23, v57
    v_accvgpr_read_b32 v54, a24
    v_mul_f32 v54, v54, v63
    v_accvgpr_write_b32 a24, v54
    v_accvgpr_read_b32 v55, a25
    v_mul_f32 v55, v55, v63
    v_accvgpr_write_b32 a25, v55
    v_accvgpr_read_b32 v56, a26
    v_mul_f32 v56, v56, v63
    v_accvgpr_write_b32 a26, v56
    v_accvgpr_read_b32 v57, a27
    v_mul_f32 v57, v57, v63
    v_accvgpr_write_b32 a27, v57
    v_accvgpr_read_b32 v54, a28
    v_mul_f32 v54, v54, v63
    v_accvgpr_write_b32 a28, v54
    v_accvgpr_read_b32 v55, a29
    v_mul_f32 v55, v55, v63
    v_accvgpr_write_b32 a29, v55
    v_accvgpr_read_b32 v56, a30
    v_mul_f32 v56, v56, v63
    v_accvgpr_write_b32 a30, v56
    v_accvgpr_read_b32 v57, a31
    v_mul_f32 v57, v57, v63
    v_accvgpr_write_b32 a31, v57
    v_accvgpr_read_b32 v54, a32
    v_mul_f32 v54, v54, v63
    v_accvgpr_write_b32 a32, v54
    v_accvgpr_read_b32 v55, a33
    v_mul_f32 v55, v55, v63
    v_accvgpr_write_b32 a33, v55
    v_accvgpr_read_b32 v56, a34
    v_mul_f32 v56, v56, v63
    v_accvgpr_write_b32 a34, v56
    v_accvgpr_read_b32 v57, a35
    v_mul_f32 v57, v57, v63
    v_accvgpr_write_b32 a35, v57
    v_accvgpr_read_b32 v54, a36
    v_mul_f32 v54, v54, v63
    v_accvgpr_write_b32 a36, v54
    v_accvgpr_read_b32 v55, a37
    v_mul_f32 v55, v55, v63
    v_accvgpr_write_b32 a37, v55
    v_accvgpr_read_b32 v56, a38
    v_mul_f32 v56, v56, v63
    v_accvgpr_write_b32 a38, v56
    v_accvgpr_read_b32 v57, a39
    v_mul_f32 v57, v57, v63
    v_accvgpr_write_b32 a39, v57
    v_accvgpr_read_b32 v54, a40
    v_mul_f32 v54, v54, v63
    v_accvgpr_write_b32 a40, v54
    v_accvgpr_read_b32 v55, a41
    v_mul_f32 v55, v55, v63
    v_accvgpr_write_b32 a41, v55
    v_accvgpr_read_b32 v56, a42
    v_mul_f32 v56, v56, v63
    v_accvgpr_write_b32 a42, v56
    v_accvgpr_read_b32 v57, a43
    v_mul_f32 v57, v57, v63
    v_accvgpr_write_b32 a43, v57
    v_accvgpr_read_b32 v54, a44
    v_mul_f32 v54, v54, v63
    v_accvgpr_write_b32 a44, v54
    v_accvgpr_read_b32 v55, a45
    v_mul_f32 v55, v55, v63
    v_accvgpr_write_b32 a45, v55
    v_accvgpr_read_b32 v56, a46
    v_mul_f32 v56, v56, v63
    v_accvgpr_write_b32 a46, v56
    v_accvgpr_read_b32 v57, a47
    v_mul_f32 v57, v57, v63
    v_accvgpr_write_b32 a47, v57
    v_accvgpr_read_b32 v54, a48
    v_mul_f32 v54, v54, v63
    v_accvgpr_write_b32 a48, v54
    v_accvgpr_read_b32 v55, a49
    v_mul_f32 v55, v55, v63
    v_accvgpr_write_b32 a49, v55
    v_accvgpr_read_b32 v56, a50
    v_mul_f32 v56, v56, v63
    v_accvgpr_write_b32 a50, v56
    v_accvgpr_read_b32 v57, a51
    v_mul_f32 v57, v57, v63
    v_accvgpr_write_b32 a51, v57
    v_accvgpr_read_b32 v54, a52
    v_mul_f32 v54, v54, v63
    v_accvgpr_write_b32 a52, v54
    v_accvgpr_read_b32 v55, a53
    v_mul_f32 v55, v55, v63
    v_accvgpr_write_b32 a53, v55
    v_accvgpr_read_b32 v56, a54
    v_mul_f32 v56, v56, v63
    v_accvgpr_write_b32 a54, v56
    v_accvgpr_read_b32 v57, a55
    v_mul_f32 v57, v57, v63
    v_accvgpr_write_b32 a55, v57
    v_accvgpr_read_b32 v54, a56
    v_mul_f32 v54, v54, v63
    v_accvgpr_write_b32 a56, v54
    v_accvgpr_read_b32 v55, a57
    v_mul_f32 v55, v55, v63
    v_accvgpr_write_b32 a57, v55
    v_accvgpr_read_b32 v56, a58
    v_mul_f32 v56, v56, v63
    v_accvgpr_write_b32 a58, v56
    v_accvgpr_read_b32 v57, a59
    v_mul_f32 v57, v57, v63
    v_accvgpr_write_b32 a59, v57
    v_accvgpr_read_b32 v54, a60
    v_mul_f32 v54, v54, v63
    v_accvgpr_write_b32 a60, v54
    v_accvgpr_read_b32 v55, a61
    v_mul_f32 v55, v55, v63
    v_accvgpr_write_b32 a61, v55
    v_accvgpr_read_b32 v56, a62
    v_mul_f32 v56, v56, v63
    v_accvgpr_write_b32 a62, v56
    v_accvgpr_read_b32 v57, a63
    v_mul_f32 v57, v57, v63
    v_accvgpr_write_b32 a63, v57
    v_mov_b32 v47, 0
    v_exp_f32 v54, v64
    v_exp_f32 v55, v65
    v_add_f32 v47, v47, v54
    v_add_f32 v47, v47, v55
    v_cvt_pk_bf16_f32 v128, v54, v55
    v_exp_f32 v54, v66
    v_exp_f32 v55, v67
    v_add_f32 v47, v47, v54
    v_add_f32 v47, v47, v55
    v_cvt_pk_bf16_f32 v129, v54, v55
    v_exp_f32 v54, v68
    v_exp_f32 v55, v69
    v_add_f32 v47, v47, v54
    v_add_f32 v47, v47, v55
    v_cvt_pk_bf16_f32 v130, v54, v55
    v_exp_f32 v54, v70
    v_exp_f32 v55, v71
    v_add_f32 v47, v47, v54
    v_add_f32 v47, v47, v55
    v_cvt_pk_bf16_f32 v131, v54, v55
    v_exp_f32 v54, v72
    v_exp_f32 v55, v73
    v_add_f32 v47, v47, v54
    v_add_f32 v47, v47, v55
    v_cvt_pk_bf16_f32 v132, v54, v55
    v_exp_f32 v54, v74
    v_exp_f32 v55, v75
    v_add_f32 v47, v47, v54
    v_add_f32 v47, v47, v55
    v_cvt_pk_bf16_f32 v133, v54, v55
    v_exp_f32 v54, v76
    v_exp_f32 v55, v77
    v_add_f32 v47, v47, v54
    v_add_f32 v47, v47, v55
    v_cvt_pk_bf16_f32 v134, v54, v55
    v_exp_f32 v54, v78
    v_exp_f32 v55, v79
    v_add_f32 v47, v47, v54
    v_add_f32 v47, v47, v55
    v_cvt_pk_bf16_f32 v135, v54, v55
    s_nop 3
    s_setpc_b64 s[60:61]

L_rare01:
    s_nop 15
    v_max3_f32 v62, v80, v81, 0
    v_max3_f32 v62, v82, v83, v62
    v_max3_f32 v62, v84, v85, v62
    v_max3_f32 v62, v86, v87, v62
    v_max3_f32 v62, v88, v89, v62
    v_max3_f32 v62, v90, v91, v62
    v_max3_f32 v62, v92, v93, v62
    v_max3_f32 v62, v94, v95, v62
    v_mov_b32 v63, v62
    s_nop 1
    v_permlane32_swap_b32 v62, v63
    v_max_f32 v62, v62, v63
    v_exp_f32 v63, -v62
    v_sub_f32 v80, v80, v62
    v_sub_f32 v112, v112, v62
    v_sub_f32 v176, v176, v62
    v_sub_f32 v81, v81, v62
    v_sub_f32 v113, v113, v62
    v_sub_f32 v177, v177, v62
    v_sub_f32 v82, v82, v62
    v_sub_f32 v114, v114, v62
    v_sub_f32 v178, v178, v62
    v_sub_f32 v83, v83, v62
    v_sub_f32 v115, v115, v62
    v_sub_f32 v179, v179, v62
    v_sub_f32 v84, v84, v62
    v_sub_f32 v116, v116, v62
    v_sub_f32 v180, v180, v62
    v_sub_f32 v85, v85, v62
    v_sub_f32 v117, v117, v62
    v_sub_f32 v181, v181, v62
    v_sub_f32 v86, v86, v62
    v_sub_f32 v118, v118, v62
    v_sub_f32 v182, v182, v62
    v_sub_f32 v87, v87, v62
    v_sub_f32 v119, v119, v62
    v_sub_f32 v183, v183, v62
    v_sub_f32 v88, v88, v62
    v_sub_f32 v120, v120, v62
    v_sub_f32 v184, v184, v62
    v_sub_f32 v89, v89, v62
    v_sub_f32 v121, v121, v62
    v_sub_f32 v185, v185, v62
    v_sub_f32 v90, v90, v62
    v_sub_f32 v122, v122, v62
    v_sub_f32 v186, v186, v62
    v_sub_f32 v91, v91, v62
    v_sub_f32 v123, v123, v62
    v_sub_f32 v187, v187, v62
    v_sub_f32 v92, v92, v62
    v_sub_f32 v124, v124, v62
    v_sub_f32 v188, v188, v62
    v_sub_f32 v93, v93, v62
    v_sub_f32 v125, v125, v62
    v_sub_f32 v189, v189, v62
    v_sub_f32 v94, v94, v62
    v_sub_f32 v126, v126, v62
    v_sub_f32 v190, v190, v62
    v_sub_f32 v95, v95, v62
    v_sub_f32 v127, v127, v62
    v_sub_f32 v191, v191, v62
    v_mul_f32 v46, v46, v63
    v_accvgpr_read_b32 v54, a64
    v_mul_f32 v54, v54, v63
    v_accvgpr_write_b32 a64, v54
    v_accvgpr_read_b32 v55, a65
    v_mul_f32 v55, v55, v63
    v_accvgpr_write_b32 a65, v55
    v_accvgpr_read_b32 v56, a66
    v_mul_f32 v56, v56, v63
    v_accvgpr_write_b32 a66, v56
    v_accvgpr_read_b32 v57, a67
    v_mul_f32 v57, v57, v63
    v_accvgpr_write_b32 a67, v57
    v_accvgpr_read_b32 v54, a68
    v_mul_f32 v54, v54, v63
    v_accvgpr_write_b32 a68, v54
    v_accvgpr_read_b32 v55, a69
    v_mul_f32 v55, v55, v63
    v_accvgpr_write_b32 a69, v55
    v_accvgpr_read_b32 v56, a70
    v_mul_f32 v56, v56, v63
    v_accvgpr_write_b32 a70, v56
    v_accvgpr_read_b32 v57, a71
    v_mul_f32 v57, v57, v63
    v_accvgpr_write_b32 a71, v57
    v_accvgpr_read_b32 v54, a72
    v_mul_f32 v54, v54, v63
    v_accvgpr_write_b32 a72, v54
    v_accvgpr_read_b32 v55, a73
    v_mul_f32 v55, v55, v63
    v_accvgpr_write_b32 a73, v55
    v_accvgpr_read_b32 v56, a74
    v_mul_f32 v56, v56, v63
    v_accvgpr_write_b32 a74, v56
    v_accvgpr_read_b32 v57, a75
    v_mul_f32 v57, v57, v63
    v_accvgpr_write_b32 a75, v57
    v_accvgpr_read_b32 v54, a76
    v_mul_f32 v54, v54, v63
    v_accvgpr_write_b32 a76, v54
    v_accvgpr_read_b32 v55, a77
    v_mul_f32 v55, v55, v63
    v_accvgpr_write_b32 a77, v55
    v_accvgpr_read_b32 v56, a78
    v_mul_f32 v56, v56, v63
    v_accvgpr_write_b32 a78, v56
    v_accvgpr_read_b32 v57, a79
    v_mul_f32 v57, v57, v63
    v_accvgpr_write_b32 a79, v57
    v_accvgpr_read_b32 v54, a80
    v_mul_f32 v54, v54, v63
    v_accvgpr_write_b32 a80, v54
    v_accvgpr_read_b32 v55, a81
    v_mul_f32 v55, v55, v63
    v_accvgpr_write_b32 a81, v55
    v_accvgpr_read_b32 v56, a82
    v_mul_f32 v56, v56, v63
    v_accvgpr_write_b32 a82, v56
    v_accvgpr_read_b32 v57, a83
    v_mul_f32 v57, v57, v63
    v_accvgpr_write_b32 a83, v57
    v_accvgpr_read_b32 v54, a84
    v_mul_f32 v54, v54, v63
    v_accvgpr_write_b32 a84, v54
    v_accvgpr_read_b32 v55, a85
    v_mul_f32 v55, v55, v63
    v_accvgpr_write_b32 a85, v55
    v_accvgpr_read_b32 v56, a86
    v_mul_f32 v56, v56, v63
    v_accvgpr_write_b32 a86, v56
    v_accvgpr_read_b32 v57, a87
    v_mul_f32 v57, v57, v63
    v_accvgpr_write_b32 a87, v57
    v_accvgpr_read_b32 v54, a88
    v_mul_f32 v54, v54, v63
    v_accvgpr_write_b32 a88, v54
    v_accvgpr_read_b32 v55, a89
    v_mul_f32 v55, v55, v63
    v_accvgpr_write_b32 a89, v55
    v_accvgpr_read_b32 v56, a90
    v_mul_f32 v56, v56, v63
    v_accvgpr_write_b32 a90, v56
    v_accvgpr_read_b32 v57, a91
    v_mul_f32 v57, v57, v63
    v_accvgpr_write_b32 a91, v57
    v_accvgpr_read_b32 v54, a92
    v_mul_f32 v54, v54, v63
    v_accvgpr_write_b32 a92, v54
    v_accvgpr_read_b32 v55, a93
    v_mul_f32 v55, v55, v63
    v_accvgpr_write_b32 a93, v55
    v_accvgpr_read_b32 v56, a94
    v_mul_f32 v56, v56, v63
    v_accvgpr_write_b32 a94, v56
    v_accvgpr_read_b32 v57, a95
    v_mul_f32 v57, v57, v63
    v_accvgpr_write_b32 a95, v57
    v_accvgpr_read_b32 v54, a96
    v_mul_f32 v54, v54, v63
    v_accvgpr_write_b32 a96, v54
    v_accvgpr_read_b32 v55, a97
    v_mul_f32 v55, v55, v63
    v_accvgpr_write_b32 a97, v55
    v_accvgpr_read_b32 v56, a98
    v_mul_f32 v56, v56, v63
    v_accvgpr_write_b32 a98, v56
    v_accvgpr_read_b32 v57, a99
    v_mul_f32 v57, v57, v63
    v_accvgpr_write_b32 a99, v57
    v_accvgpr_read_b32 v54, a100
    v_mul_f32 v54, v54, v63
    v_accvgpr_write_b32 a100, v54
    v_accvgpr_read_b32 v55, a101
    v_mul_f32 v55, v55, v63
    v_accvgpr_write_b32 a101, v55
    v_accvgpr_read_b32 v56, a102
    v_mul_f32 v56, v56, v63
    v_accvgpr_write_b32 a102, v56
    v_accvgpr_read_b32 v57, a103
    v_mul_f32 v57, v57, v63
    v_accvgpr_write_b32 a103, v57
    v_accvgpr_read_b32 v54, a104
    v_mul_f32 v54, v54, v63
    v_accvgpr_write_b32 a104, v54
    v_accvgpr_read_b32 v55, a105
    v_mul_f32 v55, v55, v63
    v_accvgpr_write_b32 a105, v55
    v_accvgpr_read_b32 v56, a106
    v_mul_f32 v56, v56, v63
    v_accvgpr_write_b32 a106, v56
    v_accvgpr_read_b32 v57, a107
    v_mul_f32 v57, v57, v63
    v_accvgpr_write_b32 a107, v57
    v_accvgpr_read_b32 v54, a108
    v_mul_f32 v54, v54, v63
    v_accvgpr_write_b32 a108, v54
    v_accvgpr_read_b32 v55, a109
    v_mul_f32 v55, v55, v63
    v_accvgpr_write_b32 a109, v55
    v_accvgpr_read_b32 v56, a110
    v_mul_f32 v56, v56, v63
    v_accvgpr_write_b32 a110, v56
    v_accvgpr_read_b32 v57, a111
    v_mul_f32 v57, v57, v63
    v_accvgpr_write_b32 a111, v57
    v_accvgpr_read_b32 v54, a112
    v_mul_f32 v54, v54, v63
    v_accvgpr_write_b32 a112, v54
    v_accvgpr_read_b32 v55, a113
    v_mul_f32 v55, v55, v63
    v_accvgpr_write_b32 a113, v55
    v_accvgpr_read_b32 v56, a114
    v_mul_f32 v56, v56, v63
    v_accvgpr_write_b32 a114, v56
    v_accvgpr_read_b32 v57, a115
    v_mul_f32 v57, v57, v63
    v_accvgpr_write_b32 a115, v57
    v_accvgpr_read_b32 v54, a116
    v_mul_f32 v54, v54, v63
    v_accvgpr_write_b32 a116, v54
    v_accvgpr_read_b32 v55, a117
    v_mul_f32 v55, v55, v63
    v_accvgpr_write_b32 a117, v55
    v_accvgpr_read_b32 v56, a118
    v_mul_f32 v56, v56, v63
    v_accvgpr_write_b32 a118, v56
    v_accvgpr_read_b32 v57, a119
    v_mul_f32 v57, v57, v63
    v_accvgpr_write_b32 a119, v57
    v_accvgpr_read_b32 v54, a120
    v_mul_f32 v54, v54, v63
    v_accvgpr_write_b32 a120, v54
    v_accvgpr_read_b32 v55, a121
    v_mul_f32 v55, v55, v63
    v_accvgpr_write_b32 a121, v55
    v_accvgpr_read_b32 v56, a122
    v_mul_f32 v56, v56, v63
    v_accvgpr_write_b32 a122, v56
    v_accvgpr_read_b32 v57, a123
    v_mul_f32 v57, v57, v63
    v_accvgpr_write_b32 a123, v57
    v_accvgpr_read_b32 v54, a124
    v_mul_f32 v54, v54, v63
    v_accvgpr_write_b32 a124, v54
    v_accvgpr_read_b32 v55, a125
    v_mul_f32 v55, v55, v63
    v_accvgpr_write_b32 a125, v55
    v_accvgpr_read_b32 v56, a126
    v_mul_f32 v56, v56, v63
    v_accvgpr_write_b32 a126, v56
    v_accvgpr_read_b32 v57, a127
    v_mul_f32 v57, v57, v63
    v_accvgpr_write_b32 a127, v57
    v_mov_b32 v48, 0
    v_exp_f32 v54, v80
    v_exp_f32 v55, v81
    v_add_f32 v48, v48, v54
    v_add_f32 v48, v48, v55
    v_cvt_pk_bf16_f32 v136, v54, v55
    v_exp_f32 v54, v82
    v_exp_f32 v55, v83
    v_add_f32 v48, v48, v54
    v_add_f32 v48, v48, v55
    v_cvt_pk_bf16_f32 v137, v54, v55
    v_exp_f32 v54, v84
    v_exp_f32 v55, v85
    v_add_f32 v48, v48, v54
    v_add_f32 v48, v48, v55
    v_cvt_pk_bf16_f32 v138, v54, v55
    v_exp_f32 v54, v86
    v_exp_f32 v55, v87
    v_add_f32 v48, v48, v54
    v_add_f32 v48, v48, v55
    v_cvt_pk_bf16_f32 v139, v54, v55
    v_exp_f32 v54, v88
    v_exp_f32 v55, v89
    v_add_f32 v48, v48, v54
    v_add_f32 v48, v48, v55
    v_cvt_pk_bf16_f32 v140, v54, v55
    v_exp_f32 v54, v90
    v_exp_f32 v55, v91
    v_add_f32 v48, v48, v54
    v_add_f32 v48, v48, v55
    v_cvt_pk_bf16_f32 v141, v54, v55
    v_exp_f32 v54, v92
    v_exp_f32 v55, v93
    v_add_f32 v48, v48, v54
    v_add_f32 v48, v48, v55
    v_cvt_pk_bf16_f32 v142, v54, v55
    v_exp_f32 v54, v94
    v_exp_f32 v55, v95
    v_add_f32 v48, v48, v54
    v_add_f32 v48, v48, v55
    v_cvt_pk_bf16_f32 v143, v54, v55
    s_nop 3
    s_setpc_b64 s[60:61]

L_rare10:
    s_nop 15
    v_max3_f32 v62, v96, v97, 0
    v_max3_f32 v62, v98, v99, v62
    v_max3_f32 v62, v100, v101, v62
    v_max3_f32 v62, v102, v103, v62
    v_max3_f32 v62, v104, v105, v62
    v_max3_f32 v62, v106, v107, v62
    v_max3_f32 v62, v108, v109, v62
    v_max3_f32 v62, v110, v111, v62
    v_mov_b32 v63, v62
    s_nop 1
    v_permlane32_swap_b32 v62, v63
    v_max_f32 v62, v62, v63
    v_exp_f32 v63, -v62
    v_sub_f32 v96, v96, v62
    v_sub_f32 v64, v64, v62
    v_sub_f32 v160, v160, v62
    v_sub_f32 v97, v97, v62
    v_sub_f32 v65, v65, v62
    v_sub_f32 v161, v161, v62
    v_sub_f32 v98, v98, v62
    v_sub_f32 v66, v66, v62
    v_sub_f32 v162, v162, v62
    v_sub_f32 v99, v99, v62
    v_sub_f32 v67, v67, v62
    v_sub_f32 v163, v163, v62
    v_sub_f32 v100, v100, v62
    v_sub_f32 v68, v68, v62
    v_sub_f32 v164, v164, v62
    v_sub_f32 v101, v101, v62
    v_sub_f32 v69, v69, v62
    v_sub_f32 v165, v165, v62
    v_sub_f32 v102, v102, v62
    v_sub_f32 v70, v70, v62
    v_sub_f32 v166, v166, v62
    v_sub_f32 v103, v103, v62
    v_sub_f32 v71, v71, v62
    v_sub_f32 v167, v167, v62
    v_sub_f32 v104, v104, v62
    v_sub_f32 v72, v72, v62
    v_sub_f32 v168, v168, v62
    v_sub_f32 v105, v105, v62
    v_sub_f32 v73, v73, v62
    v_sub_f32 v169, v169, v62
    v_sub_f32 v106, v106, v62
    v_sub_f32 v74, v74, v62
    v_sub_f32 v170, v170, v62
    v_sub_f32 v107, v107, v62
    v_sub_f32 v75, v75, v62
    v_sub_f32 v171, v171, v62
    v_sub_f32 v108, v108, v62
    v_sub_f32 v76, v76, v62
    v_sub_f32 v172, v172, v62
    v_sub_f32 v109, v109, v62
    v_sub_f32 v77, v77, v62
    v_sub_f32 v173, v173, v62
    v_sub_f32 v110, v110, v62
    v_sub_f32 v78, v78, v62
    v_sub_f32 v174, v174, v62
    v_sub_f32 v111, v111, v62
    v_sub_f32 v79, v79, v62
    v_sub_f32 v175, v175, v62
    v_mul_f32 v45, v45, v63
    v_accvgpr_read_b32 v54, a0
    v_mul_f32 v54, v54, v63
    v_accvgpr_write_b32 a0, v54
    v_accvgpr_read_b32 v55, a1
    v_mul_f32 v55, v55, v63
    v_accvgpr_write_b32 a1, v55
    v_accvgpr_read_b32 v56, a2
    v_mul_f32 v56, v56, v63
    v_accvgpr_write_b32 a2, v56
    v_accvgpr_read_b32 v57, a3
    v_mul_f32 v57, v57, v63
    v_accvgpr_write_b32 a3, v57
    v_accvgpr_read_b32 v54, a4
    v_mul_f32 v54, v54, v63
    v_accvgpr_write_b32 a4, v54
    v_accvgpr_read_b32 v55, a5
    v_mul_f32 v55, v55, v63
    v_accvgpr_write_b32 a5, v55
    v_accvgpr_read_b32 v56, a6
    v_mul_f32 v56, v56, v63
    v_accvgpr_write_b32 a6, v56
    v_accvgpr_read_b32 v57, a7
    v_mul_f32 v57, v57, v63
    v_accvgpr_write_b32 a7, v57
    v_accvgpr_read_b32 v54, a8
    v_mul_f32 v54, v54, v63
    v_accvgpr_write_b32 a8, v54
    v_accvgpr_read_b32 v55, a9
    v_mul_f32 v55, v55, v63
    v_accvgpr_write_b32 a9, v55
    v_accvgpr_read_b32 v56, a10
    v_mul_f32 v56, v56, v63
    v_accvgpr_write_b32 a10, v56
    v_accvgpr_read_b32 v57, a11
    v_mul_f32 v57, v57, v63
    v_accvgpr_write_b32 a11, v57
    v_accvgpr_read_b32 v54, a12
    v_mul_f32 v54, v54, v63
    v_accvgpr_write_b32 a12, v54
    v_accvgpr_read_b32 v55, a13
    v_mul_f32 v55, v55, v63
    v_accvgpr_write_b32 a13, v55
    v_accvgpr_read_b32 v56, a14
    v_mul_f32 v56, v56, v63
    v_accvgpr_write_b32 a14, v56
    v_accvgpr_read_b32 v57, a15
    v_mul_f32 v57, v57, v63
    v_accvgpr_write_b32 a15, v57
    v_accvgpr_read_b32 v54, a16
    v_mul_f32 v54, v54, v63
    v_accvgpr_write_b32 a16, v54
    v_accvgpr_read_b32 v55, a17
    v_mul_f32 v55, v55, v63
    v_accvgpr_write_b32 a17, v55
    v_accvgpr_read_b32 v56, a18
    v_mul_f32 v56, v56, v63
    v_accvgpr_write_b32 a18, v56
    v_accvgpr_read_b32 v57, a19
    v_mul_f32 v57, v57, v63
    v_accvgpr_write_b32 a19, v57
    v_accvgpr_read_b32 v54, a20
    v_mul_f32 v54, v54, v63
    v_accvgpr_write_b32 a20, v54
    v_accvgpr_read_b32 v55, a21
    v_mul_f32 v55, v55, v63
    v_accvgpr_write_b32 a21, v55
    v_accvgpr_read_b32 v56, a22
    v_mul_f32 v56, v56, v63
    v_accvgpr_write_b32 a22, v56
    v_accvgpr_read_b32 v57, a23
    v_mul_f32 v57, v57, v63
    v_accvgpr_write_b32 a23, v57
    v_accvgpr_read_b32 v54, a24
    v_mul_f32 v54, v54, v63
    v_accvgpr_write_b32 a24, v54
    v_accvgpr_read_b32 v55, a25
    v_mul_f32 v55, v55, v63
    v_accvgpr_write_b32 a25, v55
    v_accvgpr_read_b32 v56, a26
    v_mul_f32 v56, v56, v63
    v_accvgpr_write_b32 a26, v56
    v_accvgpr_read_b32 v57, a27
    v_mul_f32 v57, v57, v63
    v_accvgpr_write_b32 a27, v57
    v_accvgpr_read_b32 v54, a28
    v_mul_f32 v54, v54, v63
    v_accvgpr_write_b32 a28, v54
    v_accvgpr_read_b32 v55, a29
    v_mul_f32 v55, v55, v63
    v_accvgpr_write_b32 a29, v55
    v_accvgpr_read_b32 v56, a30
    v_mul_f32 v56, v56, v63
    v_accvgpr_write_b32 a30, v56
    v_accvgpr_read_b32 v57, a31
    v_mul_f32 v57, v57, v63
    v_accvgpr_write_b32 a31, v57
    v_accvgpr_read_b32 v54, a32
    v_mul_f32 v54, v54, v63
    v_accvgpr_write_b32 a32, v54
    v_accvgpr_read_b32 v55, a33
    v_mul_f32 v55, v55, v63
    v_accvgpr_write_b32 a33, v55
    v_accvgpr_read_b32 v56, a34
    v_mul_f32 v56, v56, v63
    v_accvgpr_write_b32 a34, v56
    v_accvgpr_read_b32 v57, a35
    v_mul_f32 v57, v57, v63
    v_accvgpr_write_b32 a35, v57
    v_accvgpr_read_b32 v54, a36
    v_mul_f32 v54, v54, v63
    v_accvgpr_write_b32 a36, v54
    v_accvgpr_read_b32 v55, a37
    v_mul_f32 v55, v55, v63
    v_accvgpr_write_b32 a37, v55
    v_accvgpr_read_b32 v56, a38
    v_mul_f32 v56, v56, v63
    v_accvgpr_write_b32 a38, v56
    v_accvgpr_read_b32 v57, a39
    v_mul_f32 v57, v57, v63
    v_accvgpr_write_b32 a39, v57
    v_accvgpr_read_b32 v54, a40
    v_mul_f32 v54, v54, v63
    v_accvgpr_write_b32 a40, v54
    v_accvgpr_read_b32 v55, a41
    v_mul_f32 v55, v55, v63
    v_accvgpr_write_b32 a41, v55
    v_accvgpr_read_b32 v56, a42
    v_mul_f32 v56, v56, v63
    v_accvgpr_write_b32 a42, v56
    v_accvgpr_read_b32 v57, a43
    v_mul_f32 v57, v57, v63
    v_accvgpr_write_b32 a43, v57
    v_accvgpr_read_b32 v54, a44
    v_mul_f32 v54, v54, v63
    v_accvgpr_write_b32 a44, v54
    v_accvgpr_read_b32 v55, a45
    v_mul_f32 v55, v55, v63
    v_accvgpr_write_b32 a45, v55
    v_accvgpr_read_b32 v56, a46
    v_mul_f32 v56, v56, v63
    v_accvgpr_write_b32 a46, v56
    v_accvgpr_read_b32 v57, a47
    v_mul_f32 v57, v57, v63
    v_accvgpr_write_b32 a47, v57
    v_accvgpr_read_b32 v54, a48
    v_mul_f32 v54, v54, v63
    v_accvgpr_write_b32 a48, v54
    v_accvgpr_read_b32 v55, a49
    v_mul_f32 v55, v55, v63
    v_accvgpr_write_b32 a49, v55
    v_accvgpr_read_b32 v56, a50
    v_mul_f32 v56, v56, v63
    v_accvgpr_write_b32 a50, v56
    v_accvgpr_read_b32 v57, a51
    v_mul_f32 v57, v57, v63
    v_accvgpr_write_b32 a51, v57
    v_accvgpr_read_b32 v54, a52
    v_mul_f32 v54, v54, v63
    v_accvgpr_write_b32 a52, v54
    v_accvgpr_read_b32 v55, a53
    v_mul_f32 v55, v55, v63
    v_accvgpr_write_b32 a53, v55
    v_accvgpr_read_b32 v56, a54
    v_mul_f32 v56, v56, v63
    v_accvgpr_write_b32 a54, v56
    v_accvgpr_read_b32 v57, a55
    v_mul_f32 v57, v57, v63
    v_accvgpr_write_b32 a55, v57
    v_accvgpr_read_b32 v54, a56
    v_mul_f32 v54, v54, v63
    v_accvgpr_write_b32 a56, v54
    v_accvgpr_read_b32 v55, a57
    v_mul_f32 v55, v55, v63
    v_accvgpr_write_b32 a57, v55
    v_accvgpr_read_b32 v56, a58
    v_mul_f32 v56, v56, v63
    v_accvgpr_write_b32 a58, v56
    v_accvgpr_read_b32 v57, a59
    v_mul_f32 v57, v57, v63
    v_accvgpr_write_b32 a59, v57
    v_accvgpr_read_b32 v54, a60
    v_mul_f32 v54, v54, v63
    v_accvgpr_write_b32 a60, v54
    v_accvgpr_read_b32 v55, a61
    v_mul_f32 v55, v55, v63
    v_accvgpr_write_b32 a61, v55
    v_accvgpr_read_b32 v56, a62
    v_mul_f32 v56, v56, v63
    v_accvgpr_write_b32 a62, v56
    v_accvgpr_read_b32 v57, a63
    v_mul_f32 v57, v57, v63
    v_accvgpr_write_b32 a63, v57
    v_mov_b32 v47, 0
    v_exp_f32 v54, v96
    v_exp_f32 v55, v97
    v_add_f32 v47, v47, v54
    v_add_f32 v47, v47, v55
    v_cvt_pk_bf16_f32 v144, v54, v55
    v_exp_f32 v54, v98
    v_exp_f32 v55, v99
    v_add_f32 v47, v47, v54
    v_add_f32 v47, v47, v55
    v_cvt_pk_bf16_f32 v145, v54, v55
    v_exp_f32 v54, v100
    v_exp_f32 v55, v101
    v_add_f32 v47, v47, v54
    v_add_f32 v47, v47, v55
    v_cvt_pk_bf16_f32 v146, v54, v55
    v_exp_f32 v54, v102
    v_exp_f32 v55, v103
    v_add_f32 v47, v47, v54
    v_add_f32 v47, v47, v55
    v_cvt_pk_bf16_f32 v147, v54, v55
    v_exp_f32 v54, v104
    v_exp_f32 v55, v105
    v_add_f32 v47, v47, v54
    v_add_f32 v47, v47, v55
    v_cvt_pk_bf16_f32 v148, v54, v55
    v_exp_f32 v54, v106
    v_exp_f32 v55, v107
    v_add_f32 v47, v47, v54
    v_add_f32 v47, v47, v55
    v_cvt_pk_bf16_f32 v149, v54, v55
    v_exp_f32 v54, v108
    v_exp_f32 v55, v109
    v_add_f32 v47, v47, v54
    v_add_f32 v47, v47, v55
    v_cvt_pk_bf16_f32 v150, v54, v55
    v_exp_f32 v54, v110
    v_exp_f32 v55, v111
    v_add_f32 v47, v47, v54
    v_add_f32 v47, v47, v55
    v_cvt_pk_bf16_f32 v151, v54, v55
    s_nop 3
    s_setpc_b64 s[60:61]

L_rare11:
    s_nop 15
    v_max3_f32 v62, v112, v113, 0
    v_max3_f32 v62, v114, v115, v62
    v_max3_f32 v62, v116, v117, v62
    v_max3_f32 v62, v118, v119, v62
    v_max3_f32 v62, v120, v121, v62
    v_max3_f32 v62, v122, v123, v62
    v_max3_f32 v62, v124, v125, v62
    v_max3_f32 v62, v126, v127, v62
    v_mov_b32 v63, v62
    s_nop 1
    v_permlane32_swap_b32 v62, v63
    v_max_f32 v62, v62, v63
    v_exp_f32 v63, -v62
    v_sub_f32 v112, v112, v62
    v_sub_f32 v80, v80, v62
    v_sub_f32 v176, v176, v62
    v_sub_f32 v113, v113, v62
    v_sub_f32 v81, v81, v62
    v_sub_f32 v177, v177, v62
    v_sub_f32 v114, v114, v62
    v_sub_f32 v82, v82, v62
    v_sub_f32 v178, v178, v62
    v_sub_f32 v115, v115, v62
    v_sub_f32 v83, v83, v62
    v_sub_f32 v179, v179, v62
    v_sub_f32 v116, v116, v62
    v_sub_f32 v84, v84, v62
    v_sub_f32 v180, v180, v62
    v_sub_f32 v117, v117, v62
    v_sub_f32 v85, v85, v62
    v_sub_f32 v181, v181, v62
    v_sub_f32 v118, v118, v62
    v_sub_f32 v86, v86, v62
    v_sub_f32 v182, v182, v62
    v_sub_f32 v119, v119, v62
    v_sub_f32 v87, v87, v62
    v_sub_f32 v183, v183, v62
    v_sub_f32 v120, v120, v62
    v_sub_f32 v88, v88, v62
    v_sub_f32 v184, v184, v62
    v_sub_f32 v121, v121, v62
    v_sub_f32 v89, v89, v62
    v_sub_f32 v185, v185, v62
    v_sub_f32 v122, v122, v62
    v_sub_f32 v90, v90, v62
    v_sub_f32 v186, v186, v62
    v_sub_f32 v123, v123, v62
    v_sub_f32 v91, v91, v62
    v_sub_f32 v187, v187, v62
    v_sub_f32 v124, v124, v62
    v_sub_f32 v92, v92, v62
    v_sub_f32 v188, v188, v62
    v_sub_f32 v125, v125, v62
    v_sub_f32 v93, v93, v62
    v_sub_f32 v189, v189, v62
    v_sub_f32 v126, v126, v62
    v_sub_f32 v94, v94, v62
    v_sub_f32 v190, v190, v62
    v_sub_f32 v127, v127, v62
    v_sub_f32 v95, v95, v62
    v_sub_f32 v191, v191, v62
    v_mul_f32 v46, v46, v63
    v_accvgpr_read_b32 v54, a64
    v_mul_f32 v54, v54, v63
    v_accvgpr_write_b32 a64, v54
    v_accvgpr_read_b32 v55, a65
    v_mul_f32 v55, v55, v63
    v_accvgpr_write_b32 a65, v55
    v_accvgpr_read_b32 v56, a66
    v_mul_f32 v56, v56, v63
    v_accvgpr_write_b32 a66, v56
    v_accvgpr_read_b32 v57, a67
    v_mul_f32 v57, v57, v63
    v_accvgpr_write_b32 a67, v57
    v_accvgpr_read_b32 v54, a68
    v_mul_f32 v54, v54, v63
    v_accvgpr_write_b32 a68, v54
    v_accvgpr_read_b32 v55, a69
    v_mul_f32 v55, v55, v63
    v_accvgpr_write_b32 a69, v55
    v_accvgpr_read_b32 v56, a70
    v_mul_f32 v56, v56, v63
    v_accvgpr_write_b32 a70, v56
    v_accvgpr_read_b32 v57, a71
    v_mul_f32 v57, v57, v63
    v_accvgpr_write_b32 a71, v57
    v_accvgpr_read_b32 v54, a72
    v_mul_f32 v54, v54, v63
    v_accvgpr_write_b32 a72, v54
    v_accvgpr_read_b32 v55, a73
    v_mul_f32 v55, v55, v63
    v_accvgpr_write_b32 a73, v55
    v_accvgpr_read_b32 v56, a74
    v_mul_f32 v56, v56, v63
    v_accvgpr_write_b32 a74, v56
    v_accvgpr_read_b32 v57, a75
    v_mul_f32 v57, v57, v63
    v_accvgpr_write_b32 a75, v57
    v_accvgpr_read_b32 v54, a76
    v_mul_f32 v54, v54, v63
    v_accvgpr_write_b32 a76, v54
    v_accvgpr_read_b32 v55, a77
    v_mul_f32 v55, v55, v63
    v_accvgpr_write_b32 a77, v55
    v_accvgpr_read_b32 v56, a78
    v_mul_f32 v56, v56, v63
    v_accvgpr_write_b32 a78, v56
    v_accvgpr_read_b32 v57, a79
    v_mul_f32 v57, v57, v63
    v_accvgpr_write_b32 a79, v57
    v_accvgpr_read_b32 v54, a80
    v_mul_f32 v54, v54, v63
    v_accvgpr_write_b32 a80, v54
    v_accvgpr_read_b32 v55, a81
    v_mul_f32 v55, v55, v63
    v_accvgpr_write_b32 a81, v55
    v_accvgpr_read_b32 v56, a82
    v_mul_f32 v56, v56, v63
    v_accvgpr_write_b32 a82, v56
    v_accvgpr_read_b32 v57, a83
    v_mul_f32 v57, v57, v63
    v_accvgpr_write_b32 a83, v57
    v_accvgpr_read_b32 v54, a84
    v_mul_f32 v54, v54, v63
    v_accvgpr_write_b32 a84, v54
    v_accvgpr_read_b32 v55, a85
    v_mul_f32 v55, v55, v63
    v_accvgpr_write_b32 a85, v55
    v_accvgpr_read_b32 v56, a86
    v_mul_f32 v56, v56, v63
    v_accvgpr_write_b32 a86, v56
    v_accvgpr_read_b32 v57, a87
    v_mul_f32 v57, v57, v63
    v_accvgpr_write_b32 a87, v57
    v_accvgpr_read_b32 v54, a88
    v_mul_f32 v54, v54, v63
    v_accvgpr_write_b32 a88, v54
    v_accvgpr_read_b32 v55, a89
    v_mul_f32 v55, v55, v63
    v_accvgpr_write_b32 a89, v55
    v_accvgpr_read_b32 v56, a90
    v_mul_f32 v56, v56, v63
    v_accvgpr_write_b32 a90, v56
    v_accvgpr_read_b32 v57, a91
    v_mul_f32 v57, v57, v63
    v_accvgpr_write_b32 a91, v57
    v_accvgpr_read_b32 v54, a92
    v_mul_f32 v54, v54, v63
    v_accvgpr_write_b32 a92, v54
    v_accvgpr_read_b32 v55, a93
    v_mul_f32 v55, v55, v63
    v_accvgpr_write_b32 a93, v55
    v_accvgpr_read_b32 v56, a94
    v_mul_f32 v56, v56, v63
    v_accvgpr_write_b32 a94, v56
    v_accvgpr_read_b32 v57, a95
    v_mul_f32 v57, v57, v63
    v_accvgpr_write_b32 a95, v57
    v_accvgpr_read_b32 v54, a96
    v_mul_f32 v54, v54, v63
    v_accvgpr_write_b32 a96, v54
    v_accvgpr_read_b32 v55, a97
    v_mul_f32 v55, v55, v63
    v_accvgpr_write_b32 a97, v55
    v_accvgpr_read_b32 v56, a98
    v_mul_f32 v56, v56, v63
    v_accvgpr_write_b32 a98, v56
    v_accvgpr_read_b32 v57, a99
    v_mul_f32 v57, v57, v63
    v_accvgpr_write_b32 a99, v57
    v_accvgpr_read_b32 v54, a100
    v_mul_f32 v54, v54, v63
    v_accvgpr_write_b32 a100, v54
    v_accvgpr_read_b32 v55, a101
    v_mul_f32 v55, v55, v63
    v_accvgpr_write_b32 a101, v55
    v_accvgpr_read_b32 v56, a102
    v_mul_f32 v56, v56, v63
    v_accvgpr_write_b32 a102, v56
    v_accvgpr_read_b32 v57, a103
    v_mul_f32 v57, v57, v63
    v_accvgpr_write_b32 a103, v57
    v_accvgpr_read_b32 v54, a104
    v_mul_f32 v54, v54, v63
    v_accvgpr_write_b32 a104, v54
    v_accvgpr_read_b32 v55, a105
    v_mul_f32 v55, v55, v63
    v_accvgpr_write_b32 a105, v55
    v_accvgpr_read_b32 v56, a106
    v_mul_f32 v56, v56, v63
    v_accvgpr_write_b32 a106, v56
    v_accvgpr_read_b32 v57, a107
    v_mul_f32 v57, v57, v63
    v_accvgpr_write_b32 a107, v57
    v_accvgpr_read_b32 v54, a108
    v_mul_f32 v54, v54, v63
    v_accvgpr_write_b32 a108, v54
    v_accvgpr_read_b32 v55, a109
    v_mul_f32 v55, v55, v63
    v_accvgpr_write_b32 a109, v55
    v_accvgpr_read_b32 v56, a110
    v_mul_f32 v56, v56, v63
    v_accvgpr_write_b32 a110, v56
    v_accvgpr_read_b32 v57, a111
    v_mul_f32 v57, v57, v63
    v_accvgpr_write_b32 a111, v57
    v_accvgpr_read_b32 v54, a112
    v_mul_f32 v54, v54, v63
    v_accvgpr_write_b32 a112, v54
    v_accvgpr_read_b32 v55, a113
    v_mul_f32 v55, v55, v63
    v_accvgpr_write_b32 a113, v55
    v_accvgpr_read_b32 v56, a114
    v_mul_f32 v56, v56, v63
    v_accvgpr_write_b32 a114, v56
    v_accvgpr_read_b32 v57, a115
    v_mul_f32 v57, v57, v63
    v_accvgpr_write_b32 a115, v57
    v_accvgpr_read_b32 v54, a116
    v_mul_f32 v54, v54, v63
    v_accvgpr_write_b32 a116, v54
    v_accvgpr_read_b32 v55, a117
    v_mul_f32 v55, v55, v63
    v_accvgpr_write_b32 a117, v55
    v_accvgpr_read_b32 v56, a118
    v_mul_f32 v56, v56, v63
    v_accvgpr_write_b32 a118, v56
    v_accvgpr_read_b32 v57, a119
    v_mul_f32 v57, v57, v63
    v_accvgpr_write_b32 a119, v57
    v_accvgpr_read_b32 v54, a120
    v_mul_f32 v54, v54, v63
    v_accvgpr_write_b32 a120, v54
    v_accvgpr_read_b32 v55, a121
    v_mul_f32 v55, v55, v63
    v_accvgpr_write_b32 a121, v55
    v_accvgpr_read_b32 v56, a122
    v_mul_f32 v56, v56, v63
    v_accvgpr_write_b32 a122, v56
    v_accvgpr_read_b32 v57, a123
    v_mul_f32 v57, v57, v63
    v_accvgpr_write_b32 a123, v57
    v_accvgpr_read_b32 v54, a124
    v_mul_f32 v54, v54, v63
    v_accvgpr_write_b32 a124, v54
    v_accvgpr_read_b32 v55, a125
    v_mul_f32 v55, v55, v63
    v_accvgpr_write_b32 a125, v55
    v_accvgpr_read_b32 v56, a126
    v_mul_f32 v56, v56, v63
    v_accvgpr_write_b32 a126, v56
    v_accvgpr_read_b32 v57, a127
    v_mul_f32 v57, v57, v63
    v_accvgpr_write_b32 a127, v57
    v_mov_b32 v48, 0
    v_exp_f32 v54, v112
    v_exp_f32 v55, v113
    v_add_f32 v48, v48, v54
    v_add_f32 v48, v48, v55
    v_cvt_pk_bf16_f32 v152, v54, v55
    v_exp_f32 v54, v114
    v_exp_f32 v55, v115
    v_add_f32 v48, v48, v54
    v_add_f32 v48, v48, v55
    v_cvt_pk_bf16_f32 v153, v54, v55
    v_exp_f32 v54, v116
    v_exp_f32 v55, v117
    v_add_f32 v48, v48, v54
    v_add_f32 v48, v48, v55
    v_cvt_pk_bf16_f32 v154, v54, v55
    v_exp_f32 v54, v118
    v_exp_f32 v55, v119
    v_add_f32 v48, v48, v54
    v_add_f32 v48, v48, v55
    v_cvt_pk_bf16_f32 v155, v54, v55
    v_exp_f32 v54, v120
    v_exp_f32 v55, v121
    v_add_f32 v48, v48, v54
    v_add_f32 v48, v48, v55
    v_cvt_pk_bf16_f32 v156, v54, v55
    v_exp_f32 v54, v122
    v_exp_f32 v55, v123
    v_add_f32 v48, v48, v54
    v_add_f32 v48, v48, v55
    v_cvt_pk_bf16_f32 v157, v54, v55
    v_exp_f32 v54, v124
    v_exp_f32 v55, v125
    v_add_f32 v48, v48, v54
    v_add_f32 v48, v48, v55
    v_cvt_pk_bf16_f32 v158, v54, v55
    v_exp_f32 v54, v126
    v_exp_f32 v55, v127
    v_add_f32 v48, v48, v54
    v_add_f32 v48, v48, v55
    v_cvt_pk_bf16_f32 v159, v54, v55
    s_nop 3
    s_setpc_b64 s[60:61]

L_code_end:
    s_endpgm
.section .rodata,"a"
.p2align 6
.amdhsa_kernel recurrent_scan__sliding_block_cached__moe_arch_mod__prompt_kernel
  .amdhsa_next_free_vgpr 512
  .amdhsa_next_free_sgpr 102
  .amdhsa_accum_offset 256
  .amdhsa_group_segment_fixed_size 0
  .amdhsa_kernarg_size 104
  .amdhsa_user_sgpr_count 2
  .amdhsa_user_sgpr_kernarg_segment_ptr 1
  .amdhsa_system_sgpr_workgroup_id_x 1
.end_amdhsa_kernel
```
